```python
import torch

def _softmax(x, axis=-1):
    return torch.softmax(x, dim=axis)
def _gelu(x):
    return torch.nn.functional.gelu(x, approximate="tanh")
def _silu(x):
    return torch.nn.functional.silu(x)
def _sigmoid(x):
    return torch.sigmoid(x)
def _layernorm(x, axis=-1, eps=1e-5):
    m = x.mean(dim=axis, keepdim=True)
    v = x.var(dim=axis, keepdim=True, unbiased=False)
    return (x - m) / torch.sqrt(v + eps)
def _scatter_add(tgt, idx, src, axis=0):
    return tgt.clone().index_add_(axis, idx, src)
def _segment_sum(src, seg, n):
    out = torch.zeros((n,) + src.shape[1:], dtype=src.dtype)
    return out.index_add_(0, seg, src)
def _pad(x, pw):
    flat = tuple(v for pair in reversed(pw) for v in pair)
    return torch.nn.functional.pad(x, flat)

kernel_name = 'sequential_preLN__sliding_block__geglu_ffn__prompt'

def setup_inputs():

    _w = (lambda a: (lambda t: t.to(torch.bfloat16) if t.is_floating_point() else t)(torch.as_tensor(a)))
    def _A_setup():
        B, S, D = 1, 2048, 640
        return {
            "x": _w((lambda *s: torch.randn(*s, dtype=torch.bfloat16) * 0.05)(B, S, D)),
            "wqkv": _w((lambda *s: torch.randn(*s, dtype=torch.bfloat16) * 0.05)(D, 3 * D)),
            "wo": _w((lambda *s: torch.randn(*s, dtype=torch.bfloat16) * 0.05)(D, D)),
        }
    _A_in = _A_setup()

    def _B_setup():
        B, S, D, F = 1, 2048, 640, 1728
        return {
            "x": _w((lambda *s: torch.randn(*s, dtype=torch.bfloat16) * 0.05)(B, S, D)),
            "w_gate": _w((lambda *s: torch.randn(*s, dtype=torch.bfloat16) * 0.05)(D, F)),
            "w_up": _w((lambda *s: torch.randn(*s, dtype=torch.bfloat16) * 0.05)(D, F)),
            "w_down": _w((lambda *s: torch.randn(*s, dtype=torch.bfloat16) * 0.05)(F, D)),
        }
    _B_in = _B_setup()

    return {
        "A_x": _A_in["x"],
        "A_wqkv": _A_in["wqkv"],
        "A_wo": _A_in["wo"],
        "B_x": _B_in["x"],
        "B_w_gate": _B_in["w_gate"],
        "B_w_up": _B_in["w_up"],
        "B_w_down": _B_in["w_down"],
    }

def reference(A_x, A_wqkv, A_wo, B_x, B_w_gate, B_w_up, B_w_down):
    def _A_ref(x, wqkv, wo):
        B, S, D = x.shape
        H = 32; Dh = D // H; W = 256
        qkv = (lambda x, *d: x.permute(*d))((x @ wqkv).reshape(B, S, 3, H, Dh), 2, 0, 3, 1, 4)
        q, k, v = qkv[0], qkv[1], qkv[2]
        scores = torch.einsum("bhqd,bhkd->bhqk", q, k) * (Dh ** -0.5)
        idx = torch.arange(S)
        mask = (idx[:, None] - idx[None, :] >= 0) & (idx[:, None] - idx[None, :] < W)
        scores = torch.where(mask[None, None], scores, -1e9)
        p = _softmax(scores, axis=-1)
        o = torch.einsum("bhqk,bhkd->bhqd", p, v)
        return (lambda x, *d: x.permute(*d))(o, 0, 2, 1, 3).reshape(B, S, D) @ wo

    def _B_ref(x, w_gate, w_up, w_down):
        return (_gelu(x @ w_gate) * (x @ w_up)) @ w_down

    x = A_x
    h = x + _A_ref(_layernorm(x, axis=-1), A_wqkv, A_wo)
    h2 = h + _B_ref(_layernorm(h, axis=-1), B_w_gate, B_w_up, B_w_down)
    return h2
```

```asm
; @launch grid=(256,1,1) block=(768,1,1) lds=163840
.amdgcn_target "amdgcn-amd-amdhsa--gfx950"
.text
.globl sequential_preLN__sliding_block__geglu_ffn__prompt_kernel
.p2align 8
.type sequential_preLN__sliding_block__geglu_ffn__prompt_kernel,@function
sequential_preLN__sliding_block__geglu_ffn__prompt_kernel:
    s_getpc_b64 s[96:97]
    s_cmp_ge_u32 s2, 256
    s_cbranch_scc1 sequential_preLN__sliding_block__geglu_ffn__prompt_kernel_end
    s_load_dwordx16 s[4:19], s[0:1], 0
    s_load_dwordx4 s[20:23], s[0:1], 64
    s_lshr_b32 s33, s2, 3
    s_mul_i32 s33, s33, 3072
    v_lshl_add_u32 v5, v0, 7, s33
    s_mov_b32 s33, sequential_preLN__sliding_block__geglu_ffn__prompt_kernel_end-sequential_preLN__sliding_block__geglu_ffn__prompt_kernel-4
    v_cmp_ge_u32 vcc, s33, v5
    v_cmp_gt_u32 s[30:31], 24, v0
    s_nop 0
    s_and_b64 exec, vcc, s[30:31]
    s_cbranch_scc0 sequential_preLN__sliding_block__geglu_ffn__prompt_kernel_nocpf1
    global_load_dword v166, v5, s[96:97]
    s_nop 1
sequential_preLN__sliding_block__geglu_ffn__prompt_kernel_nocpf1:
    s_mov_b64 exec, -1
    s_memrealtime s[28:29]
    v_lshrrev_b32 v4, 6, v0
    v_and_b32 v1, 63, v0
    v_readfirstlane_b32 s3, v4
    s_and_b32 s25, s2, 7
    s_lshr_b32 s26, s2, 3
    v_and_b32 v2, 31, v1
    v_lshrrev_b32 v3, 5, v1
    v_lshlrev_b32 v12, 2, v1
    v_lshlrev_b32 v13, 4, v1
    s_mov_b32 s24, 0
    s_waitcnt lgkmcnt(0)
    s_add_u32 s92, s22, 0xcc0000
    s_addc_u32 s93, s23, 0
    s_and_b32 s93, s93, 0xffff
    s_mov_b32 s94, 0x28000
    s_mov_b32 s95, 0x20000
    s_lshl_b32 s33, s2, 4
    s_add_u32 s33, s33, s3
    s_cmp_lg_u32 s33, 11
    s_cbranch_scc1 sequential_preLN__sliding_block__geglu_ffn__prompt_kernel_notok2
    s_mov_b32 s44, s20
    s_and_b32 s45, s21, 0xffff
    s_mov_b32 s46, 0x100
    s_mov_b32 s47, 0x20000
    s_or_b32 s33, s28, 1
    v_mov_b32 v4, s33
    v_mov_b32 v5, 0
    s_mov_b64 exec, 1
    buffer_store_dword v4, v5, s[44:47], 0 offen sc1
    s_mov_b64 exec, -1
    s_nop 1
sequential_preLN__sliding_block__geglu_ffn__prompt_kernel_notok2:
    s_cmp_ge_u32 s2, 240
    s_cbranch_scc1 sequential_preLN__sliding_block__geglu_ffn__prompt_kernel_p1pack3
    s_and_b32 s34, s3, 3
    s_and_b32 s33, s25, 1
    s_mul_i32 s33, s33, 30
    s_add_u32 s36, s26, s33
    s_and_b32 s35, s36, 3
    s_lshr_b32 s36, s36, 2
    s_lshr_b32 s33, s25, 1
    s_lshl_b32 s33, s33, 2
    s_add_u32 s35, s35, s33
    s_lshl_b32 s37, s34, 12
    s_cmp_ge_u32 s3, 8
    s_cbranch_scc1 sequential_preLN__sliding_block__geglu_ffn__prompt_kernel_p1_r7
    s_cmp_ge_u32 s3, 4
    s_cbranch_scc1 sequential_preLN__sliding_block__geglu_ffn__prompt_kernel_p1_r6
    s_mul_i32 s38, s36, 205
    s_lshr_b32 s38, s38, 10
    s_mul_i32 s39, s38, 5
    s_sub_u32 s39, s36, s39
    s_lshl_b32 s40, s35, 2
    s_add_u32 s40, s40, s34
    v_bfe_u32 v4, v1, 1, 3
    v_xor_b32 v4, v4, v3
    v_lshlrev_b32 v4, 4, v4
    v_lshl_add_u32 v4, v2, 7, v4
    v_add_u32 v4, s37, v4
    v_xor_b32 v14, 0, v4
    v_xor_b32 v15, 32, v4
    v_xor_b32 v16, 64, v4
    v_xor_b32 v17, 96, v4
    v_bfe_u32 v4, v1, 2, 2
    v_lshl_add_u32 v5, v3, 3, v4
    v_lshlrev_b32 v5, 8, v5
    v_bfe_u32 v6, v1, 4, 1
    v_lshl_add_u32 v5, v6, 5, v5
    v_and_b32 v7, 15, v1
    v_cmp_eq_u32 vcc, v6, v7
    v_mov_b32 v7, 0x3f803f80
    s_nop 0
    v_cndmask_b32 v36, 0, v7, vcc
    v_cndmask_b32 v37, 0, v7, vcc
    v_cndmask_b32 v38, 0, v7, vcc
    v_cndmask_b32 v39, 0, v7, vcc
    v_and_b32 v6, 3, v1
    v_lshl_add_u32 v5, v6, 3, v5
    v_add_u32 v5, 16384, v5
    s_add_u32 s33, s34, 0
    s_and_b32 s33, s33, 3
    v_xor_b32 v6, s33, v4
    v_lshl_add_u32 v22, v6, 6, v5
    s_add_u32 s33, s34, 1
    s_and_b32 s33, s33, 3
    v_xor_b32 v6, s33, v4
    v_lshl_add_u32 v23, v6, 6, v5
    s_add_u32 s33, s34, 2
    s_and_b32 s33, s33, 3
    v_xor_b32 v6, s33, v4
    v_lshl_add_u32 v24, v6, 6, v5
    s_add_u32 s33, s34, 3
    s_and_b32 s33, s33, 3
    v_xor_b32 v6, s33, v4
    v_lshl_add_u32 v25, v6, 6, v5
    v_add_u32 v18, 65536, v14
    v_add_u32 v26, 65536, v22
    v_add_u32 v19, 65536, v15
    v_add_u32 v27, 65536, v23
    v_add_u32 v20, 65536, v16
    v_add_u32 v28, 65536, v24
    v_add_u32 v21, 65536, v17
    v_add_u32 v29, 65536, v25
    s_mul_i32 s33, s38, 2621440
    s_add_u32 s44, s22, s33
    s_addc_u32 s45, s23, 0
    s_and_b32 s45, s45, 0xffff
    s_mov_b32 s46, 2621440
    s_mov_b32 s47, 0x20000
    s_cmp_ge_u32 s36, 10
    s_cbranch_scc1 sequential_preLN__sliding_block__geglu_ffn__prompt_kernel_p1v9
    v_lshlrev_b32 v30, 4, v2
    v_lshl_add_u32 v30, v3, 9, v30
    s_mul_i32 s42, s40, 80
    s_lshl_b32 s33, s39, 4
    s_add_u32 s42, s42, s33
    s_lshl_b32 s42, s42, 9
    s_barrier
    ds_read_b128 v[44:47], v14 offset:0
    ds_read_b64_tr_b16 v[52:53], v22 offset:0
    ds_read_b64_tr_b16 v[54:55], v22 offset:1024
    ds_read_b64_tr_b16 v[56:57], v23 offset:0
    ds_read_b64_tr_b16 v[58:59], v23 offset:1024
    ds_read_b64_tr_b16 v[60:61], v24 offset:0
    ds_read_b64_tr_b16 v[62:63], v24 offset:1024
    ds_read_b64_tr_b16 v[64:65], v25 offset:0
    ds_read_b64_tr_b16 v[66:67], v25 offset:1024
    s_waitcnt lgkmcnt(6)
    v_mfma_f32_32x32x16_bf16 v[84:99], v[52:55], v[44:47], 0
    ds_read_b128 v[48:51], v15 offset:0
    ds_read_b64_tr_b16 v[68:69], v22 offset:4096
    ds_read_b64_tr_b16 v[70:71], v22 offset:5120
    s_waitcnt lgkmcnt(7)
    v_mfma_f32_32x32x16_bf16 v[100:115], v[56:59], v[44:47], 0
    ds_read_b64_tr_b16 v[72:73], v23 offset:4096
    ds_read_b64_tr_b16 v[74:75], v23 offset:5120
    s_waitcnt lgkmcnt(7)
    v_mfma_f32_32x32x16_bf16 v[116:131], v[60:63], v[44:47], 0
    ds_read_b64_tr_b16 v[76:77], v24 offset:4096
    ds_read_b64_tr_b16 v[78:79], v24 offset:5120
    s_waitcnt lgkmcnt(7)
    v_mfma_f32_32x32x16_bf16 v[132:147], v[64:67], v[44:47], 0
    ds_read_b64_tr_b16 v[80:81], v25 offset:4096
    ds_read_b64_tr_b16 v[82:83], v25 offset:5120
    v_mfma_f32_16x16x32_bf16 v[40:43], v[36:39], v[52:55], 0
    s_waitcnt lgkmcnt(6)
    v_mfma_f32_32x32x16_bf16 v[84:99], v[68:71], v[48:51], v[84:99]
    ds_read_b128 v[44:47], v16 offset:0
    ds_read_b64_tr_b16 v[52:53], v22 offset:8192
    ds_read_b64_tr_b16 v[54:55], v22 offset:9216
    s_waitcnt lgkmcnt(7)
    v_mfma_f32_32x32x16_bf16 v[100:115], v[72:75], v[48:51], v[100:115]
    ds_read_b64_tr_b16 v[56:57], v23 offset:8192
    ds_read_b64_tr_b16 v[58:59], v23 offset:9216
    s_waitcnt lgkmcnt(7)
    v_mfma_f32_32x32x16_bf16 v[116:131], v[76:79], v[48:51], v[116:131]
    ds_read_b64_tr_b16 v[60:61], v24 offset:8192
    ds_read_b64_tr_b16 v[62:63], v24 offset:9216
    s_waitcnt lgkmcnt(7)
    v_mfma_f32_32x32x16_bf16 v[132:147], v[80:83], v[48:51], v[132:147]
    ds_read_b64_tr_b16 v[64:65], v25 offset:8192
    ds_read_b64_tr_b16 v[66:67], v25 offset:9216
    v_mfma_f32_16x16x32_bf16 v[40:43], v[36:39], v[68:71], v[40:43]
    s_waitcnt lgkmcnt(6)
    v_mfma_f32_32x32x16_bf16 v[84:99], v[52:55], v[44:47], v[84:99]
    ds_read_b128 v[48:51], v17 offset:0
    ds_read_b64_tr_b16 v[68:69], v22 offset:12288
    ds_read_b64_tr_b16 v[70:71], v22 offset:13312
    s_waitcnt lgkmcnt(7)
    v_mfma_f32_32x32x16_bf16 v[100:115], v[56:59], v[44:47], v[100:115]
    ds_read_b64_tr_b16 v[72:73], v23 offset:12288
    ds_read_b64_tr_b16 v[74:75], v23 offset:13312
    s_waitcnt lgkmcnt(7)
    v_mfma_f32_32x32x16_bf16 v[116:131], v[60:63], v[44:47], v[116:131]
    ds_read_b64_tr_b16 v[76:77], v24 offset:12288
    ds_read_b64_tr_b16 v[78:79], v24 offset:13312
    s_waitcnt lgkmcnt(7)
    v_mfma_f32_32x32x16_bf16 v[132:147], v[64:67], v[44:47], v[132:147]
    ds_read_b64_tr_b16 v[80:81], v25 offset:12288
    ds_read_b64_tr_b16 v[82:83], v25 offset:13312
    v_mfma_f32_16x16x32_bf16 v[40:43], v[36:39], v[52:55], v[40:43]
    s_waitcnt lgkmcnt(6)
    v_mfma_f32_32x32x16_bf16 v[84:99], v[68:71], v[48:51], v[84:99]
    s_waitcnt lgkmcnt(0)
    s_barrier
    ds_read_b128 v[44:47], v14 offset:32768
    ds_read_b64_tr_b16 v[52:53], v22 offset:32768
    ds_read_b64_tr_b16 v[54:55], v22 offset:33792
    v_mfma_f32_32x32x16_bf16 v[100:115], v[72:75], v[48:51], v[100:115]
    ds_read_b64_tr_b16 v[56:57], v23 offset:32768
    ds_read_b64_tr_b16 v[58:59], v23 offset:33792
    v_mfma_f32_32x32x16_bf16 v[116:131], v[76:79], v[48:51], v[116:131]
    ds_read_b64_tr_b16 v[60:61], v24 offset:32768
    ds_read_b64_tr_b16 v[62:63], v24 offset:33792
    v_mfma_f32_32x32x16_bf16 v[132:147], v[80:83], v[48:51], v[132:147]
    ds_read_b64_tr_b16 v[64:65], v25 offset:32768
    ds_read_b64_tr_b16 v[66:67], v25 offset:33792
    v_mfma_f32_16x16x32_bf16 v[40:43], v[36:39], v[68:71], v[40:43]
    s_waitcnt lgkmcnt(6)
    v_mfma_f32_32x32x16_bf16 v[84:99], v[52:55], v[44:47], v[84:99]
    ds_read_b128 v[48:51], v15 offset:32768
    ds_read_b64_tr_b16 v[68:69], v22 offset:36864
    ds_read_b64_tr_b16 v[70:71], v22 offset:37888
    s_waitcnt lgkmcnt(7)
    v_mfma_f32_32x32x16_bf16 v[100:115], v[56:59], v[44:47], v[100:115]
    ds_read_b64_tr_b16 v[72:73], v23 offset:36864
    ds_read_b64_tr_b16 v[74:75], v23 offset:37888
    s_waitcnt lgkmcnt(7)
    v_mfma_f32_32x32x16_bf16 v[116:131], v[60:63], v[44:47], v[116:131]
    ds_read_b64_tr_b16 v[76:77], v24 offset:36864
    ds_read_b64_tr_b16 v[78:79], v24 offset:37888
    s_waitcnt lgkmcnt(7)
    v_mfma_f32_32x32x16_bf16 v[132:147], v[64:67], v[44:47], v[132:147]
    ds_read_b64_tr_b16 v[80:81], v25 offset:36864
    ds_read_b64_tr_b16 v[82:83], v25 offset:37888
    v_mfma_f32_16x16x32_bf16 v[40:43], v[36:39], v[52:55], v[40:43]
    s_waitcnt lgkmcnt(6)
    v_mfma_f32_32x32x16_bf16 v[84:99], v[68:71], v[48:51], v[84:99]
    ds_read_b128 v[44:47], v16 offset:32768
    ds_read_b64_tr_b16 v[52:53], v22 offset:40960
    ds_read_b64_tr_b16 v[54:55], v22 offset:41984
    s_waitcnt lgkmcnt(7)
    v_mfma_f32_32x32x16_bf16 v[100:115], v[72:75], v[48:51], v[100:115]
    ds_read_b64_tr_b16 v[56:57], v23 offset:40960
    ds_read_b64_tr_b16 v[58:59], v23 offset:41984
    s_waitcnt lgkmcnt(7)
    v_mfma_f32_32x32x16_bf16 v[116:131], v[76:79], v[48:51], v[116:131]
    ds_read_b64_tr_b16 v[60:61], v24 offset:40960
    ds_read_b64_tr_b16 v[62:63], v24 offset:41984
    s_waitcnt lgkmcnt(7)
    v_mfma_f32_32x32x16_bf16 v[132:147], v[80:83], v[48:51], v[132:147]
    ds_read_b64_tr_b16 v[64:65], v25 offset:40960
    ds_read_b64_tr_b16 v[66:67], v25 offset:41984
    v_mfma_f32_16x16x32_bf16 v[40:43], v[36:39], v[68:71], v[40:43]
    s_waitcnt lgkmcnt(6)
    v_mfma_f32_32x32x16_bf16 v[84:99], v[52:55], v[44:47], v[84:99]
    ds_read_b128 v[48:51], v17 offset:32768
    ds_read_b64_tr_b16 v[68:69], v22 offset:45056
    ds_read_b64_tr_b16 v[70:71], v22 offset:46080
    s_waitcnt lgkmcnt(7)
    v_mfma_f32_32x32x16_bf16 v[100:115], v[56:59], v[44:47], v[100:115]
    ds_read_b64_tr_b16 v[72:73], v23 offset:45056
    ds_read_b64_tr_b16 v[74:75], v23 offset:46080
    s_waitcnt lgkmcnt(7)
    v_mfma_f32_32x32x16_bf16 v[116:131], v[60:63], v[44:47], v[116:131]
    ds_read_b64_tr_b16 v[76:77], v24 offset:45056
    ds_read_b64_tr_b16 v[78:79], v24 offset:46080
    s_waitcnt lgkmcnt(7)
    v_mfma_f32_32x32x16_bf16 v[132:147], v[64:67], v[44:47], v[132:147]
    ds_read_b64_tr_b16 v[80:81], v25 offset:45056
    ds_read_b64_tr_b16 v[82:83], v25 offset:46080
    v_mfma_f32_16x16x32_bf16 v[40:43], v[36:39], v[52:55], v[40:43]
    s_waitcnt lgkmcnt(6)
    v_mfma_f32_32x32x16_bf16 v[84:99], v[68:71], v[48:51], v[84:99]
    s_waitcnt lgkmcnt(0)
    s_barrier
    ds_read_b128 v[44:47], v18 offset:0
    ds_read_b64_tr_b16 v[52:53], v26 offset:0
    ds_read_b64_tr_b16 v[54:55], v26 offset:1024
    v_mfma_f32_32x32x16_bf16 v[100:115], v[72:75], v[48:51], v[100:115]
    ds_read_b64_tr_b16 v[56:57], v27 offset:0
    ds_read_b64_tr_b16 v[58:59], v27 offset:1024
    v_mfma_f32_32x32x16_bf16 v[116:131], v[76:79], v[48:51], v[116:131]
    ds_read_b64_tr_b16 v[60:61], v28 offset:0
    ds_read_b64_tr_b16 v[62:63], v28 offset:1024
    v_mfma_f32_32x32x16_bf16 v[132:147], v[80:83], v[48:51], v[132:147]
    ds_read_b64_tr_b16 v[64:65], v29 offset:0
    ds_read_b64_tr_b16 v[66:67], v29 offset:1024
    v_mfma_f32_16x16x32_bf16 v[40:43], v[36:39], v[68:71], v[40:43]
    s_waitcnt lgkmcnt(6)
    v_mfma_f32_32x32x16_bf16 v[84:99], v[52:55], v[44:47], v[84:99]
    ds_read_b128 v[48:51], v19 offset:0
    ds_read_b64_tr_b16 v[68:69], v26 offset:4096
    ds_read_b64_tr_b16 v[70:71], v26 offset:5120
    s_waitcnt lgkmcnt(7)
    v_mfma_f32_32x32x16_bf16 v[100:115], v[56:59], v[44:47], v[100:115]
    ds_read_b64_tr_b16 v[72:73], v27 offset:4096
    ds_read_b64_tr_b16 v[74:75], v27 offset:5120
    s_waitcnt lgkmcnt(7)
    v_mfma_f32_32x32x16_bf16 v[116:131], v[60:63], v[44:47], v[116:131]
    ds_read_b64_tr_b16 v[76:77], v28 offset:4096
    ds_read_b64_tr_b16 v[78:79], v28 offset:5120
    s_waitcnt lgkmcnt(7)
    v_mfma_f32_32x32x16_bf16 v[132:147], v[64:67], v[44:47], v[132:147]
    ds_read_b64_tr_b16 v[80:81], v29 offset:4096
    ds_read_b64_tr_b16 v[82:83], v29 offset:5120
    v_mfma_f32_16x16x32_bf16 v[40:43], v[36:39], v[52:55], v[40:43]
    s_waitcnt lgkmcnt(6)
    v_mfma_f32_32x32x16_bf16 v[84:99], v[68:71], v[48:51], v[84:99]
    ds_read_b128 v[44:47], v20 offset:0
    ds_read_b64_tr_b16 v[52:53], v26 offset:8192
    ds_read_b64_tr_b16 v[54:55], v26 offset:9216
    s_waitcnt lgkmcnt(7)
    v_mfma_f32_32x32x16_bf16 v[100:115], v[72:75], v[48:51], v[100:115]
    ds_read_b64_tr_b16 v[56:57], v27 offset:8192
    ds_read_b64_tr_b16 v[58:59], v27 offset:9216
    s_waitcnt lgkmcnt(7)
    v_mfma_f32_32x32x16_bf16 v[116:131], v[76:79], v[48:51], v[116:131]
    ds_read_b64_tr_b16 v[60:61], v28 offset:8192
    ds_read_b64_tr_b16 v[62:63], v28 offset:9216
    s_waitcnt lgkmcnt(7)
    v_mfma_f32_32x32x16_bf16 v[132:147], v[80:83], v[48:51], v[132:147]
    ds_read_b64_tr_b16 v[64:65], v29 offset:8192
    ds_read_b64_tr_b16 v[66:67], v29 offset:9216
    v_mfma_f32_16x16x32_bf16 v[40:43], v[36:39], v[68:71], v[40:43]
    s_waitcnt lgkmcnt(6)
    v_mfma_f32_32x32x16_bf16 v[84:99], v[52:55], v[44:47], v[84:99]
    ds_read_b128 v[48:51], v21 offset:0
    ds_read_b64_tr_b16 v[68:69], v26 offset:12288
    ds_read_b64_tr_b16 v[70:71], v26 offset:13312
    s_waitcnt lgkmcnt(7)
    v_mfma_f32_32x32x16_bf16 v[100:115], v[56:59], v[44:47], v[100:115]
    ds_read_b64_tr_b16 v[72:73], v27 offset:12288
    ds_read_b64_tr_b16 v[74:75], v27 offset:13312
    s_waitcnt lgkmcnt(7)
    v_mfma_f32_32x32x16_bf16 v[116:131], v[60:63], v[44:47], v[116:131]
    ds_read_b64_tr_b16 v[76:77], v28 offset:12288
    ds_read_b64_tr_b16 v[78:79], v28 offset:13312
    s_waitcnt lgkmcnt(7)
    v_mfma_f32_32x32x16_bf16 v[132:147], v[64:67], v[44:47], v[132:147]
    ds_read_b64_tr_b16 v[80:81], v29 offset:12288
    ds_read_b64_tr_b16 v[82:83], v29 offset:13312
    v_mfma_f32_16x16x32_bf16 v[40:43], v[36:39], v[52:55], v[40:43]
    s_waitcnt lgkmcnt(6)
    v_mfma_f32_32x32x16_bf16 v[84:99], v[68:71], v[48:51], v[84:99]
    s_waitcnt lgkmcnt(0)
    s_barrier
    ds_read_b128 v[44:47], v18 offset:32768
    ds_read_b64_tr_b16 v[52:53], v26 offset:32768
    ds_read_b64_tr_b16 v[54:55], v26 offset:33792
    v_mfma_f32_32x32x16_bf16 v[100:115], v[72:75], v[48:51], v[100:115]
    ds_read_b64_tr_b16 v[56:57], v27 offset:32768
    ds_read_b64_tr_b16 v[58:59], v27 offset:33792
    v_mfma_f32_32x32x16_bf16 v[116:131], v[76:79], v[48:51], v[116:131]
    ds_read_b64_tr_b16 v[60:61], v28 offset:32768
    ds_read_b64_tr_b16 v[62:63], v28 offset:33792
    v_mfma_f32_32x32x16_bf16 v[132:147], v[80:83], v[48:51], v[132:147]
    ds_read_b64_tr_b16 v[64:65], v29 offset:32768
    ds_read_b64_tr_b16 v[66:67], v29 offset:33792
    v_mfma_f32_16x16x32_bf16 v[40:43], v[36:39], v[68:71], v[40:43]
    s_waitcnt lgkmcnt(6)
    v_mfma_f32_32x32x16_bf16 v[84:99], v[52:55], v[44:47], v[84:99]
    ds_read_b128 v[48:51], v19 offset:32768
    ds_read_b64_tr_b16 v[68:69], v26 offset:36864
    ds_read_b64_tr_b16 v[70:71], v26 offset:37888
    s_waitcnt lgkmcnt(7)
    v_mfma_f32_32x32x16_bf16 v[100:115], v[56:59], v[44:47], v[100:115]
    ds_read_b64_tr_b16 v[72:73], v27 offset:36864
    ds_read_b64_tr_b16 v[74:75], v27 offset:37888
    s_waitcnt lgkmcnt(7)
    v_mfma_f32_32x32x16_bf16 v[116:131], v[60:63], v[44:47], v[116:131]
    ds_read_b64_tr_b16 v[76:77], v28 offset:36864
    ds_read_b64_tr_b16 v[78:79], v28 offset:37888
    s_waitcnt lgkmcnt(7)
    v_mfma_f32_32x32x16_bf16 v[132:147], v[64:67], v[44:47], v[132:147]
    ds_read_b64_tr_b16 v[80:81], v29 offset:36864
    ds_read_b64_tr_b16 v[82:83], v29 offset:37888
    v_mfma_f32_16x16x32_bf16 v[40:43], v[36:39], v[52:55], v[40:43]
    s_waitcnt lgkmcnt(6)
    v_mfma_f32_32x32x16_bf16 v[84:99], v[68:71], v[48:51], v[84:99]
    ds_read_b128 v[44:47], v20 offset:32768
    ds_read_b64_tr_b16 v[52:53], v26 offset:40960
    ds_read_b64_tr_b16 v[54:55], v26 offset:41984
    s_waitcnt lgkmcnt(7)
    v_mfma_f32_32x32x16_bf16 v[100:115], v[72:75], v[48:51], v[100:115]
    ds_read_b64_tr_b16 v[56:57], v27 offset:40960
    ds_read_b64_tr_b16 v[58:59], v27 offset:41984
    s_waitcnt lgkmcnt(7)
    v_mfma_f32_32x32x16_bf16 v[116:131], v[76:79], v[48:51], v[116:131]
    ds_read_b64_tr_b16 v[60:61], v28 offset:40960
    ds_read_b64_tr_b16 v[62:63], v28 offset:41984
    s_waitcnt lgkmcnt(7)
    v_mfma_f32_32x32x16_bf16 v[132:147], v[80:83], v[48:51], v[132:147]
    ds_read_b64_tr_b16 v[64:65], v29 offset:40960
    ds_read_b64_tr_b16 v[66:67], v29 offset:41984
    v_mfma_f32_16x16x32_bf16 v[40:43], v[36:39], v[68:71], v[40:43]
    s_waitcnt lgkmcnt(6)
    v_mfma_f32_32x32x16_bf16 v[84:99], v[52:55], v[44:47], v[84:99]
    ds_read_b128 v[48:51], v21 offset:32768
    ds_read_b64_tr_b16 v[68:69], v26 offset:45056
    ds_read_b64_tr_b16 v[70:71], v26 offset:46080
    s_waitcnt lgkmcnt(7)
    v_mfma_f32_32x32x16_bf16 v[100:115], v[56:59], v[44:47], v[100:115]
    ds_read_b64_tr_b16 v[72:73], v27 offset:45056
    ds_read_b64_tr_b16 v[74:75], v27 offset:46080
    s_waitcnt lgkmcnt(7)
    v_mfma_f32_32x32x16_bf16 v[116:131], v[60:63], v[44:47], v[116:131]
    ds_read_b64_tr_b16 v[76:77], v28 offset:45056
    ds_read_b64_tr_b16 v[78:79], v28 offset:46080
    s_waitcnt lgkmcnt(7)
    v_mfma_f32_32x32x16_bf16 v[132:147], v[64:67], v[44:47], v[132:147]
    ds_read_b64_tr_b16 v[80:81], v29 offset:45056
    ds_read_b64_tr_b16 v[82:83], v29 offset:46080
    v_mfma_f32_16x16x32_bf16 v[40:43], v[36:39], v[52:55], v[40:43]
    s_waitcnt lgkmcnt(6)
    v_mfma_f32_32x32x16_bf16 v[84:99], v[68:71], v[48:51], v[84:99]
    s_waitcnt lgkmcnt(0)
    s_barrier
    ds_read_b128 v[44:47], v14 offset:0
    ds_read_b64_tr_b16 v[52:53], v22 offset:0
    ds_read_b64_tr_b16 v[54:55], v22 offset:1024
    v_mfma_f32_32x32x16_bf16 v[100:115], v[72:75], v[48:51], v[100:115]
    ds_read_b64_tr_b16 v[56:57], v23 offset:0
    ds_read_b64_tr_b16 v[58:59], v23 offset:1024
    v_mfma_f32_32x32x16_bf16 v[116:131], v[76:79], v[48:51], v[116:131]
    ds_read_b64_tr_b16 v[60:61], v24 offset:0
    ds_read_b64_tr_b16 v[62:63], v24 offset:1024
    v_mfma_f32_32x32x16_bf16 v[132:147], v[80:83], v[48:51], v[132:147]
    ds_read_b64_tr_b16 v[64:65], v25 offset:0
    ds_read_b64_tr_b16 v[66:67], v25 offset:1024
    v_mfma_f32_16x16x32_bf16 v[40:43], v[36:39], v[68:71], v[40:43]
    s_waitcnt lgkmcnt(6)
    v_mfma_f32_32x32x16_bf16 v[84:99], v[52:55], v[44:47], v[84:99]
    ds_read_b128 v[48:51], v15 offset:0
    ds_read_b64_tr_b16 v[68:69], v22 offset:4096
    ds_read_b64_tr_b16 v[70:71], v22 offset:5120
    s_waitcnt lgkmcnt(7)
    v_mfma_f32_32x32x16_bf16 v[100:115], v[56:59], v[44:47], v[100:115]
    ds_read_b64_tr_b16 v[72:73], v23 offset:4096
    ds_read_b64_tr_b16 v[74:75], v23 offset:5120
    s_waitcnt lgkmcnt(7)
    v_mfma_f32_32x32x16_bf16 v[116:131], v[60:63], v[44:47], v[116:131]
    ds_read_b64_tr_b16 v[76:77], v24 offset:4096
    ds_read_b64_tr_b16 v[78:79], v24 offset:5120
    s_waitcnt lgkmcnt(7)
    v_mfma_f32_32x32x16_bf16 v[132:147], v[64:67], v[44:47], v[132:147]
    ds_read_b64_tr_b16 v[80:81], v25 offset:4096
    ds_read_b64_tr_b16 v[82:83], v25 offset:5120
    v_mfma_f32_16x16x32_bf16 v[40:43], v[36:39], v[52:55], v[40:43]
    s_waitcnt lgkmcnt(6)
    v_mfma_f32_32x32x16_bf16 v[84:99], v[68:71], v[48:51], v[84:99]
    ds_read_b128 v[44:47], v16 offset:0
    ds_read_b64_tr_b16 v[52:53], v22 offset:8192
    ds_read_b64_tr_b16 v[54:55], v22 offset:9216
    s_waitcnt lgkmcnt(7)
    v_mfma_f32_32x32x16_bf16 v[100:115], v[72:75], v[48:51], v[100:115]
    ds_read_b64_tr_b16 v[56:57], v23 offset:8192
    ds_read_b64_tr_b16 v[58:59], v23 offset:9216
    s_waitcnt lgkmcnt(7)
    v_mfma_f32_32x32x16_bf16 v[116:131], v[76:79], v[48:51], v[116:131]
    ds_read_b64_tr_b16 v[60:61], v24 offset:8192
    ds_read_b64_tr_b16 v[62:63], v24 offset:9216
    s_waitcnt lgkmcnt(7)
    v_mfma_f32_32x32x16_bf16 v[132:147], v[80:83], v[48:51], v[132:147]
    ds_read_b64_tr_b16 v[64:65], v25 offset:8192
    ds_read_b64_tr_b16 v[66:67], v25 offset:9216
    v_mfma_f32_16x16x32_bf16 v[40:43], v[36:39], v[68:71], v[40:43]
    s_waitcnt lgkmcnt(6)
    v_mfma_f32_32x32x16_bf16 v[84:99], v[52:55], v[44:47], v[84:99]
    ds_read_b128 v[48:51], v17 offset:0
    ds_read_b64_tr_b16 v[68:69], v22 offset:12288
    ds_read_b64_tr_b16 v[70:71], v22 offset:13312
    s_waitcnt lgkmcnt(7)
    v_mfma_f32_32x32x16_bf16 v[100:115], v[56:59], v[44:47], v[100:115]
    ds_read_b64_tr_b16 v[72:73], v23 offset:12288
    ds_read_b64_tr_b16 v[74:75], v23 offset:13312
    s_waitcnt lgkmcnt(7)
    v_mfma_f32_32x32x16_bf16 v[116:131], v[60:63], v[44:47], v[116:131]
    ds_read_b64_tr_b16 v[76:77], v24 offset:12288
    ds_read_b64_tr_b16 v[78:79], v24 offset:13312
    s_waitcnt lgkmcnt(7)
    v_mfma_f32_32x32x16_bf16 v[132:147], v[64:67], v[44:47], v[132:147]
    ds_read_b64_tr_b16 v[80:81], v25 offset:12288
    ds_read_b64_tr_b16 v[82:83], v25 offset:13312
    v_mfma_f32_16x16x32_bf16 v[40:43], v[36:39], v[52:55], v[40:43]
    s_waitcnt lgkmcnt(6)
    v_mfma_f32_32x32x16_bf16 v[84:99], v[68:71], v[48:51], v[84:99]
    s_waitcnt lgkmcnt(0)
    s_barrier
    ds_read_b128 v[44:47], v14 offset:32768
    ds_read_b64_tr_b16 v[52:53], v22 offset:32768
    ds_read_b64_tr_b16 v[54:55], v22 offset:33792
    v_mfma_f32_32x32x16_bf16 v[100:115], v[72:75], v[48:51], v[100:115]
    ds_read_b64_tr_b16 v[56:57], v23 offset:32768
    ds_read_b64_tr_b16 v[58:59], v23 offset:33792
    v_mfma_f32_32x32x16_bf16 v[116:131], v[76:79], v[48:51], v[116:131]
    ds_read_b64_tr_b16 v[60:61], v24 offset:32768
    ds_read_b64_tr_b16 v[62:63], v24 offset:33792
    v_mfma_f32_32x32x16_bf16 v[132:147], v[80:83], v[48:51], v[132:147]
    ds_read_b64_tr_b16 v[64:65], v25 offset:32768
    ds_read_b64_tr_b16 v[66:67], v25 offset:33792
    v_mfma_f32_16x16x32_bf16 v[40:43], v[36:39], v[68:71], v[40:43]
    s_waitcnt lgkmcnt(6)
    v_mfma_f32_32x32x16_bf16 v[84:99], v[52:55], v[44:47], v[84:99]
    ds_read_b128 v[48:51], v15 offset:32768
    ds_read_b64_tr_b16 v[68:69], v22 offset:36864
    ds_read_b64_tr_b16 v[70:71], v22 offset:37888
    s_waitcnt lgkmcnt(7)
    v_mfma_f32_32x32x16_bf16 v[100:115], v[56:59], v[44:47], v[100:115]
    ds_read_b64_tr_b16 v[72:73], v23 offset:36864
    ds_read_b64_tr_b16 v[74:75], v23 offset:37888
    s_waitcnt lgkmcnt(7)
    v_mfma_f32_32x32x16_bf16 v[116:131], v[60:63], v[44:47], v[116:131]
    ds_read_b64_tr_b16 v[76:77], v24 offset:36864
    ds_read_b64_tr_b16 v[78:79], v24 offset:37888
    s_waitcnt lgkmcnt(7)
    v_mfma_f32_32x32x16_bf16 v[132:147], v[64:67], v[44:47], v[132:147]
    ds_read_b64_tr_b16 v[80:81], v25 offset:36864
    ds_read_b64_tr_b16 v[82:83], v25 offset:37888
    v_mfma_f32_16x16x32_bf16 v[40:43], v[36:39], v[52:55], v[40:43]
    s_waitcnt lgkmcnt(6)
    v_mfma_f32_32x32x16_bf16 v[84:99], v[68:71], v[48:51], v[84:99]
    ds_read_b128 v[44:47], v16 offset:32768
    ds_read_b64_tr_b16 v[52:53], v22 offset:40960
    ds_read_b64_tr_b16 v[54:55], v22 offset:41984
    s_waitcnt lgkmcnt(7)
    v_mfma_f32_32x32x16_bf16 v[100:115], v[72:75], v[48:51], v[100:115]
    ds_read_b64_tr_b16 v[56:57], v23 offset:40960
    ds_read_b64_tr_b16 v[58:59], v23 offset:41984
    s_waitcnt lgkmcnt(7)
    v_mfma_f32_32x32x16_bf16 v[116:131], v[76:79], v[48:51], v[116:131]
    ds_read_b64_tr_b16 v[60:61], v24 offset:40960
    ds_read_b64_tr_b16 v[62:63], v24 offset:41984
    s_waitcnt lgkmcnt(7)
    v_mfma_f32_32x32x16_bf16 v[132:147], v[80:83], v[48:51], v[132:147]
    ds_read_b64_tr_b16 v[64:65], v25 offset:40960
    ds_read_b64_tr_b16 v[66:67], v25 offset:41984
    v_mfma_f32_16x16x32_bf16 v[40:43], v[36:39], v[68:71], v[40:43]
    s_waitcnt lgkmcnt(6)
    v_mfma_f32_32x32x16_bf16 v[84:99], v[52:55], v[44:47], v[84:99]
    ds_read_b128 v[48:51], v17 offset:32768
    ds_read_b64_tr_b16 v[68:69], v22 offset:45056
    ds_read_b64_tr_b16 v[70:71], v22 offset:46080
    s_waitcnt lgkmcnt(7)
    v_mfma_f32_32x32x16_bf16 v[100:115], v[56:59], v[44:47], v[100:115]
    ds_read_b64_tr_b16 v[72:73], v23 offset:45056
    ds_read_b64_tr_b16 v[74:75], v23 offset:46080
    s_waitcnt lgkmcnt(7)
    v_mfma_f32_32x32x16_bf16 v[116:131], v[60:63], v[44:47], v[116:131]
    ds_read_b64_tr_b16 v[76:77], v24 offset:45056
    ds_read_b64_tr_b16 v[78:79], v24 offset:46080
    s_waitcnt lgkmcnt(7)
    v_mfma_f32_32x32x16_bf16 v[132:147], v[64:67], v[44:47], v[132:147]
    ds_read_b64_tr_b16 v[80:81], v25 offset:45056
    ds_read_b64_tr_b16 v[82:83], v25 offset:46080
    v_mfma_f32_16x16x32_bf16 v[40:43], v[36:39], v[52:55], v[40:43]
    s_waitcnt lgkmcnt(6)
    v_mfma_f32_32x32x16_bf16 v[84:99], v[68:71], v[48:51], v[84:99]
    s_waitcnt lgkmcnt(0)
    s_barrier
    ds_read_b128 v[44:47], v18 offset:0
    ds_read_b64_tr_b16 v[52:53], v26 offset:0
    ds_read_b64_tr_b16 v[54:55], v26 offset:1024
    v_mfma_f32_32x32x16_bf16 v[100:115], v[72:75], v[48:51], v[100:115]
    ds_read_b64_tr_b16 v[56:57], v27 offset:0
    ds_read_b64_tr_b16 v[58:59], v27 offset:1024
    v_mfma_f32_32x32x16_bf16 v[116:131], v[76:79], v[48:51], v[116:131]
    ds_read_b64_tr_b16 v[60:61], v28 offset:0
    ds_read_b64_tr_b16 v[62:63], v28 offset:1024
    v_mfma_f32_32x32x16_bf16 v[132:147], v[80:83], v[48:51], v[132:147]
    ds_read_b64_tr_b16 v[64:65], v29 offset:0
    ds_read_b64_tr_b16 v[66:67], v29 offset:1024
    v_mfma_f32_16x16x32_bf16 v[40:43], v[36:39], v[68:71], v[40:43]
    s_waitcnt lgkmcnt(6)
    v_mfma_f32_32x32x16_bf16 v[84:99], v[52:55], v[44:47], v[84:99]
    ds_read_b128 v[48:51], v19 offset:0
    ds_read_b64_tr_b16 v[68:69], v26 offset:4096
    ds_read_b64_tr_b16 v[70:71], v26 offset:5120
    s_waitcnt lgkmcnt(7)
    v_mfma_f32_32x32x16_bf16 v[100:115], v[56:59], v[44:47], v[100:115]
    ds_read_b64_tr_b16 v[72:73], v27 offset:4096
    ds_read_b64_tr_b16 v[74:75], v27 offset:5120
    s_waitcnt lgkmcnt(7)
    v_mfma_f32_32x32x16_bf16 v[116:131], v[60:63], v[44:47], v[116:131]
    ds_read_b64_tr_b16 v[76:77], v28 offset:4096
    ds_read_b64_tr_b16 v[78:79], v28 offset:5120
    s_waitcnt lgkmcnt(7)
    v_mfma_f32_32x32x16_bf16 v[132:147], v[64:67], v[44:47], v[132:147]
    ds_read_b64_tr_b16 v[80:81], v29 offset:4096
    ds_read_b64_tr_b16 v[82:83], v29 offset:5120
    v_mfma_f32_16x16x32_bf16 v[40:43], v[36:39], v[52:55], v[40:43]
    s_waitcnt lgkmcnt(6)
    v_mfma_f32_32x32x16_bf16 v[84:99], v[68:71], v[48:51], v[84:99]
    ds_read_b128 v[44:47], v20 offset:0
    ds_read_b64_tr_b16 v[52:53], v26 offset:8192
    ds_read_b64_tr_b16 v[54:55], v26 offset:9216
    s_waitcnt lgkmcnt(7)
    v_mfma_f32_32x32x16_bf16 v[100:115], v[72:75], v[48:51], v[100:115]
    ds_read_b64_tr_b16 v[56:57], v27 offset:8192
    ds_read_b64_tr_b16 v[58:59], v27 offset:9216
    s_waitcnt lgkmcnt(7)
    v_mfma_f32_32x32x16_bf16 v[116:131], v[76:79], v[48:51], v[116:131]
    ds_read_b64_tr_b16 v[60:61], v28 offset:8192
    ds_read_b64_tr_b16 v[62:63], v28 offset:9216
    s_waitcnt lgkmcnt(7)
    v_mfma_f32_32x32x16_bf16 v[132:147], v[80:83], v[48:51], v[132:147]
    ds_read_b64_tr_b16 v[64:65], v29 offset:8192
    ds_read_b64_tr_b16 v[66:67], v29 offset:9216
    v_mfma_f32_16x16x32_bf16 v[40:43], v[36:39], v[68:71], v[40:43]
    s_waitcnt lgkmcnt(6)
    v_mfma_f32_32x32x16_bf16 v[84:99], v[52:55], v[44:47], v[84:99]
    ds_read_b128 v[48:51], v21 offset:0
    ds_read_b64_tr_b16 v[68:69], v26 offset:12288
    ds_read_b64_tr_b16 v[70:71], v26 offset:13312
    s_waitcnt lgkmcnt(7)
    v_mfma_f32_32x32x16_bf16 v[100:115], v[56:59], v[44:47], v[100:115]
    ds_read_b64_tr_b16 v[72:73], v27 offset:12288
    ds_read_b64_tr_b16 v[74:75], v27 offset:13312
    s_waitcnt lgkmcnt(7)
    v_mfma_f32_32x32x16_bf16 v[116:131], v[60:63], v[44:47], v[116:131]
    ds_read_b64_tr_b16 v[76:77], v28 offset:12288
    ds_read_b64_tr_b16 v[78:79], v28 offset:13312
    s_waitcnt lgkmcnt(7)
    v_mfma_f32_32x32x16_bf16 v[132:147], v[64:67], v[44:47], v[132:147]
    ds_read_b64_tr_b16 v[80:81], v29 offset:12288
    ds_read_b64_tr_b16 v[82:83], v29 offset:13312
    v_mfma_f32_16x16x32_bf16 v[40:43], v[36:39], v[52:55], v[40:43]
    s_waitcnt lgkmcnt(6)
    v_mfma_f32_32x32x16_bf16 v[84:99], v[68:71], v[48:51], v[84:99]
    s_waitcnt lgkmcnt(0)
    s_barrier
    ds_read_b128 v[44:47], v18 offset:32768
    ds_read_b64_tr_b16 v[52:53], v26 offset:32768
    ds_read_b64_tr_b16 v[54:55], v26 offset:33792
    v_mfma_f32_32x32x16_bf16 v[100:115], v[72:75], v[48:51], v[100:115]
    ds_read_b64_tr_b16 v[56:57], v27 offset:32768
    ds_read_b64_tr_b16 v[58:59], v27 offset:33792
    v_mfma_f32_32x32x16_bf16 v[116:131], v[76:79], v[48:51], v[116:131]
    ds_read_b64_tr_b16 v[60:61], v28 offset:32768
    ds_read_b64_tr_b16 v[62:63], v28 offset:33792
    v_mfma_f32_32x32x16_bf16 v[132:147], v[80:83], v[48:51], v[132:147]
    ds_read_b64_tr_b16 v[64:65], v29 offset:32768
    ds_read_b64_tr_b16 v[66:67], v29 offset:33792
    v_mfma_f32_16x16x32_bf16 v[40:43], v[36:39], v[68:71], v[40:43]
    s_waitcnt lgkmcnt(6)
    v_mfma_f32_32x32x16_bf16 v[84:99], v[52:55], v[44:47], v[84:99]
    ds_read_b128 v[48:51], v19 offset:32768
    ds_read_b64_tr_b16 v[68:69], v26 offset:36864
    ds_read_b64_tr_b16 v[70:71], v26 offset:37888
    s_waitcnt lgkmcnt(7)
    v_mfma_f32_32x32x16_bf16 v[100:115], v[56:59], v[44:47], v[100:115]
    ds_read_b64_tr_b16 v[72:73], v27 offset:36864
    ds_read_b64_tr_b16 v[74:75], v27 offset:37888
    s_waitcnt lgkmcnt(7)
    v_mfma_f32_32x32x16_bf16 v[116:131], v[60:63], v[44:47], v[116:131]
    ds_read_b64_tr_b16 v[76:77], v28 offset:36864
    ds_read_b64_tr_b16 v[78:79], v28 offset:37888
    s_waitcnt lgkmcnt(7)
    v_mfma_f32_32x32x16_bf16 v[132:147], v[64:67], v[44:47], v[132:147]
    ds_read_b64_tr_b16 v[80:81], v29 offset:36864
    ds_read_b64_tr_b16 v[82:83], v29 offset:37888
    v_mfma_f32_16x16x32_bf16 v[40:43], v[36:39], v[52:55], v[40:43]
    s_waitcnt lgkmcnt(6)
    v_mfma_f32_32x32x16_bf16 v[84:99], v[68:71], v[48:51], v[84:99]
    ds_read_b128 v[44:47], v20 offset:32768
    ds_read_b64_tr_b16 v[52:53], v26 offset:40960
    ds_read_b64_tr_b16 v[54:55], v26 offset:41984
    s_waitcnt lgkmcnt(7)
    v_mfma_f32_32x32x16_bf16 v[100:115], v[72:75], v[48:51], v[100:115]
    ds_read_b64_tr_b16 v[56:57], v27 offset:40960
    ds_read_b64_tr_b16 v[58:59], v27 offset:41984
    s_waitcnt lgkmcnt(7)
    v_mfma_f32_32x32x16_bf16 v[116:131], v[76:79], v[48:51], v[116:131]
    ds_read_b64_tr_b16 v[60:61], v28 offset:40960
    ds_read_b64_tr_b16 v[62:63], v28 offset:41984
    s_waitcnt lgkmcnt(7)
    v_mfma_f32_32x32x16_bf16 v[132:147], v[80:83], v[48:51], v[132:147]
    ds_read_b64_tr_b16 v[64:65], v29 offset:40960
    ds_read_b64_tr_b16 v[66:67], v29 offset:41984
    v_mfma_f32_16x16x32_bf16 v[40:43], v[36:39], v[68:71], v[40:43]
    s_waitcnt lgkmcnt(6)
    v_mfma_f32_32x32x16_bf16 v[84:99], v[52:55], v[44:47], v[84:99]
    ds_read_b128 v[48:51], v21 offset:32768
    ds_read_b64_tr_b16 v[68:69], v26 offset:45056
    ds_read_b64_tr_b16 v[70:71], v26 offset:46080
    s_waitcnt lgkmcnt(7)
    v_mfma_f32_32x32x16_bf16 v[100:115], v[56:59], v[44:47], v[100:115]
    ds_read_b64_tr_b16 v[72:73], v27 offset:45056
    ds_read_b64_tr_b16 v[74:75], v27 offset:46080
    s_waitcnt lgkmcnt(7)
    v_mfma_f32_32x32x16_bf16 v[116:131], v[60:63], v[44:47], v[116:131]
    ds_read_b64_tr_b16 v[76:77], v28 offset:45056
    ds_read_b64_tr_b16 v[78:79], v28 offset:46080
    s_waitcnt lgkmcnt(7)
    v_mfma_f32_32x32x16_bf16 v[132:147], v[64:67], v[44:47], v[132:147]
    ds_read_b64_tr_b16 v[80:81], v29 offset:45056
    ds_read_b64_tr_b16 v[82:83], v29 offset:46080
    v_mfma_f32_16x16x32_bf16 v[40:43], v[36:39], v[52:55], v[40:43]
    s_waitcnt lgkmcnt(6)
    v_mfma_f32_32x32x16_bf16 v[84:99], v[68:71], v[48:51], v[84:99]
    s_waitcnt lgkmcnt(0)
    s_barrier
    ds_read_b128 v[44:47], v14 offset:0
    ds_read_b64_tr_b16 v[52:53], v22 offset:0
    ds_read_b64_tr_b16 v[54:55], v22 offset:1024
    v_mfma_f32_32x32x16_bf16 v[100:115], v[72:75], v[48:51], v[100:115]
    ds_read_b64_tr_b16 v[56:57], v23 offset:0
    ds_read_b64_tr_b16 v[58:59], v23 offset:1024
    v_mfma_f32_32x32x16_bf16 v[116:131], v[76:79], v[48:51], v[116:131]
    ds_read_b64_tr_b16 v[60:61], v24 offset:0
    ds_read_b64_tr_b16 v[62:63], v24 offset:1024
    v_mfma_f32_32x32x16_bf16 v[132:147], v[80:83], v[48:51], v[132:147]
    ds_read_b64_tr_b16 v[64:65], v25 offset:0
    ds_read_b64_tr_b16 v[66:67], v25 offset:1024
    v_mfma_f32_16x16x32_bf16 v[40:43], v[36:39], v[68:71], v[40:43]
    s_waitcnt lgkmcnt(6)
    v_mfma_f32_32x32x16_bf16 v[84:99], v[52:55], v[44:47], v[84:99]
    ds_read_b128 v[48:51], v15 offset:0
    ds_read_b64_tr_b16 v[68:69], v22 offset:4096
    ds_read_b64_tr_b16 v[70:71], v22 offset:5120
    s_waitcnt lgkmcnt(7)
    v_mfma_f32_32x32x16_bf16 v[100:115], v[56:59], v[44:47], v[100:115]
    ds_read_b64_tr_b16 v[72:73], v23 offset:4096
    ds_read_b64_tr_b16 v[74:75], v23 offset:5120
    s_waitcnt lgkmcnt(7)
    v_mfma_f32_32x32x16_bf16 v[116:131], v[60:63], v[44:47], v[116:131]
    ds_read_b64_tr_b16 v[76:77], v24 offset:4096
    ds_read_b64_tr_b16 v[78:79], v24 offset:5120
    s_waitcnt lgkmcnt(7)
    v_mfma_f32_32x32x16_bf16 v[132:147], v[64:67], v[44:47], v[132:147]
    ds_read_b64_tr_b16 v[80:81], v25 offset:4096
    ds_read_b64_tr_b16 v[82:83], v25 offset:5120
    v_mfma_f32_16x16x32_bf16 v[40:43], v[36:39], v[52:55], v[40:43]
    s_waitcnt lgkmcnt(6)
    v_mfma_f32_32x32x16_bf16 v[84:99], v[68:71], v[48:51], v[84:99]
    ds_read_b128 v[44:47], v16 offset:0
    ds_read_b64_tr_b16 v[52:53], v22 offset:8192
    ds_read_b64_tr_b16 v[54:55], v22 offset:9216
    s_waitcnt lgkmcnt(7)
    v_mfma_f32_32x32x16_bf16 v[100:115], v[72:75], v[48:51], v[100:115]
    ds_read_b64_tr_b16 v[56:57], v23 offset:8192
    ds_read_b64_tr_b16 v[58:59], v23 offset:9216
    s_waitcnt lgkmcnt(7)
    v_mfma_f32_32x32x16_bf16 v[116:131], v[76:79], v[48:51], v[116:131]
    ds_read_b64_tr_b16 v[60:61], v24 offset:8192
    ds_read_b64_tr_b16 v[62:63], v24 offset:9216
    s_waitcnt lgkmcnt(7)
    v_mfma_f32_32x32x16_bf16 v[132:147], v[80:83], v[48:51], v[132:147]
    ds_read_b64_tr_b16 v[64:65], v25 offset:8192
    ds_read_b64_tr_b16 v[66:67], v25 offset:9216
    v_mfma_f32_16x16x32_bf16 v[40:43], v[36:39], v[68:71], v[40:43]
    s_waitcnt lgkmcnt(6)
    v_mfma_f32_32x32x16_bf16 v[84:99], v[52:55], v[44:47], v[84:99]
    ds_read_b128 v[48:51], v17 offset:0
    ds_read_b64_tr_b16 v[68:69], v22 offset:12288
    ds_read_b64_tr_b16 v[70:71], v22 offset:13312
    s_waitcnt lgkmcnt(7)
    v_mfma_f32_32x32x16_bf16 v[100:115], v[56:59], v[44:47], v[100:115]
    ds_read_b64_tr_b16 v[72:73], v23 offset:12288
    ds_read_b64_tr_b16 v[74:75], v23 offset:13312
    s_waitcnt lgkmcnt(7)
    v_mfma_f32_32x32x16_bf16 v[116:131], v[60:63], v[44:47], v[116:131]
    ds_read_b64_tr_b16 v[76:77], v24 offset:12288
    ds_read_b64_tr_b16 v[78:79], v24 offset:13312
    s_waitcnt lgkmcnt(7)
    v_mfma_f32_32x32x16_bf16 v[132:147], v[64:67], v[44:47], v[132:147]
    ds_read_b64_tr_b16 v[80:81], v25 offset:12288
    ds_read_b64_tr_b16 v[82:83], v25 offset:13312
    v_mfma_f32_16x16x32_bf16 v[40:43], v[36:39], v[52:55], v[40:43]
    s_waitcnt lgkmcnt(6)
    v_mfma_f32_32x32x16_bf16 v[84:99], v[68:71], v[48:51], v[84:99]
    s_waitcnt lgkmcnt(0)
    s_barrier
    ds_read_b128 v[44:47], v14 offset:32768
    ds_read_b64_tr_b16 v[52:53], v22 offset:32768
    ds_read_b64_tr_b16 v[54:55], v22 offset:33792
    v_mfma_f32_32x32x16_bf16 v[100:115], v[72:75], v[48:51], v[100:115]
    ds_read_b64_tr_b16 v[56:57], v23 offset:32768
    ds_read_b64_tr_b16 v[58:59], v23 offset:33792
    v_mfma_f32_32x32x16_bf16 v[116:131], v[76:79], v[48:51], v[116:131]
    ds_read_b64_tr_b16 v[60:61], v24 offset:32768
    ds_read_b64_tr_b16 v[62:63], v24 offset:33792
    v_mfma_f32_32x32x16_bf16 v[132:147], v[80:83], v[48:51], v[132:147]
    ds_read_b64_tr_b16 v[64:65], v25 offset:32768
    ds_read_b64_tr_b16 v[66:67], v25 offset:33792
    v_mfma_f32_16x16x32_bf16 v[40:43], v[36:39], v[68:71], v[40:43]
    s_waitcnt lgkmcnt(6)
    v_mfma_f32_32x32x16_bf16 v[84:99], v[52:55], v[44:47], v[84:99]
    ds_read_b128 v[48:51], v15 offset:32768
    ds_read_b64_tr_b16 v[68:69], v22 offset:36864
    ds_read_b64_tr_b16 v[70:71], v22 offset:37888
    s_waitcnt lgkmcnt(7)
    v_mfma_f32_32x32x16_bf16 v[100:115], v[56:59], v[44:47], v[100:115]
    ds_read_b64_tr_b16 v[72:73], v23 offset:36864
    ds_read_b64_tr_b16 v[74:75], v23 offset:37888
    s_waitcnt lgkmcnt(7)
    v_mfma_f32_32x32x16_bf16 v[116:131], v[60:63], v[44:47], v[116:131]
    ds_read_b64_tr_b16 v[76:77], v24 offset:36864
    ds_read_b64_tr_b16 v[78:79], v24 offset:37888
    s_waitcnt lgkmcnt(7)
    v_mfma_f32_32x32x16_bf16 v[132:147], v[64:67], v[44:47], v[132:147]
    ds_read_b64_tr_b16 v[80:81], v25 offset:36864
    ds_read_b64_tr_b16 v[82:83], v25 offset:37888
    v_mfma_f32_16x16x32_bf16 v[40:43], v[36:39], v[52:55], v[40:43]
    s_waitcnt lgkmcnt(6)
    v_mfma_f32_32x32x16_bf16 v[84:99], v[68:71], v[48:51], v[84:99]
    ds_read_b128 v[44:47], v16 offset:32768
    ds_read_b64_tr_b16 v[52:53], v22 offset:40960
    ds_read_b64_tr_b16 v[54:55], v22 offset:41984
    s_waitcnt lgkmcnt(7)
    v_mfma_f32_32x32x16_bf16 v[100:115], v[72:75], v[48:51], v[100:115]
    ds_read_b64_tr_b16 v[56:57], v23 offset:40960
    ds_read_b64_tr_b16 v[58:59], v23 offset:41984
    s_waitcnt lgkmcnt(7)
    v_mfma_f32_32x32x16_bf16 v[116:131], v[76:79], v[48:51], v[116:131]
    ds_read_b64_tr_b16 v[60:61], v24 offset:40960
    ds_read_b64_tr_b16 v[62:63], v24 offset:41984
    s_waitcnt lgkmcnt(7)
    v_mfma_f32_32x32x16_bf16 v[132:147], v[80:83], v[48:51], v[132:147]
    ds_read_b64_tr_b16 v[64:65], v25 offset:40960
    ds_read_b64_tr_b16 v[66:67], v25 offset:41984
    v_mfma_f32_16x16x32_bf16 v[40:43], v[36:39], v[68:71], v[40:43]
    s_waitcnt lgkmcnt(6)
    v_mfma_f32_32x32x16_bf16 v[84:99], v[52:55], v[44:47], v[84:99]
    ds_read_b128 v[48:51], v17 offset:32768
    ds_read_b64_tr_b16 v[68:69], v22 offset:45056
    ds_read_b64_tr_b16 v[70:71], v22 offset:46080
    s_waitcnt lgkmcnt(7)
    v_mfma_f32_32x32x16_bf16 v[100:115], v[56:59], v[44:47], v[100:115]
    ds_read_b64_tr_b16 v[72:73], v23 offset:45056
    ds_read_b64_tr_b16 v[74:75], v23 offset:46080
    s_waitcnt lgkmcnt(7)
    v_mfma_f32_32x32x16_bf16 v[116:131], v[60:63], v[44:47], v[116:131]
    ds_read_b64_tr_b16 v[76:77], v24 offset:45056
    ds_read_b64_tr_b16 v[78:79], v24 offset:46080
    s_waitcnt lgkmcnt(7)
    v_mfma_f32_32x32x16_bf16 v[132:147], v[64:67], v[44:47], v[132:147]
    ds_read_b64_tr_b16 v[80:81], v25 offset:45056
    ds_read_b64_tr_b16 v[82:83], v25 offset:46080
    v_mfma_f32_16x16x32_bf16 v[40:43], v[36:39], v[52:55], v[40:43]
    s_waitcnt lgkmcnt(6)
    v_mfma_f32_32x32x16_bf16 v[84:99], v[68:71], v[48:51], v[84:99]
    s_waitcnt lgkmcnt(4)
    v_mfma_f32_32x32x16_bf16 v[100:115], v[72:75], v[48:51], v[100:115]
    s_waitcnt lgkmcnt(2)
    v_mfma_f32_32x32x16_bf16 v[116:131], v[76:79], v[48:51], v[116:131]
    s_waitcnt lgkmcnt(0)
    v_mfma_f32_32x32x16_bf16 v[132:147], v[80:83], v[48:51], v[132:147]
    v_mfma_f32_16x16x32_bf16 v[40:43], v[36:39], v[68:71], v[40:43]
    s_lshl_b32 s33, s34, 7
    s_add_u32 s33, s33, 131072
    v_add_u32 v6, s33, v12
    s_mov_b64 exec, 0xffff
    s_nop 3
    ds_write2_b32 v6, v40, v41 offset0:0 offset1:16
    s_mov_b64 exec, -1
    s_lshl_b32 s41, s34, 8
    s_add_u32 s41, s41, 132096
    s_waitcnt lgkmcnt(0)
    s_barrier
    v_lshl_add_u32 v6, v2, 2, s41
    ds_read2_b32 v[4:5], v6 offset0:0 offset1:32
    v_lshlrev_b32 v6, 4, v3
    s_cmp_eq_u32 s38, 0
    s_cselect_b32 s43, 0x3ea52b5c, 1.0
    s_add_u32 s33, s34, 0
    s_and_b32 s33, s33, 3
    s_lshl_b32 s33, s33, 7
    s_add_u32 s33, s33, 131072
    v_add_u32 v7, s33, v6
    ds_read_b128 v[52:55], v7 offset:0
    ds_read_b128 v[56:59], v7 offset:32
    ds_read_b128 v[60:63], v7 offset:64
    ds_read_b128 v[64:67], v7 offset:96
    s_waitcnt lgkmcnt(4)
    v_mul_f32 v5, s43, v5
    v_mul_f32 v4, v4, v5
    s_add_u32 s33, s34, 1
    s_and_b32 s33, s33, 3
    s_lshl_b32 s33, s33, 7
    s_add_u32 s33, s33, 131072
    v_add_u32 v7, s33, v6
    ds_read_b128 v[68:71], v7 offset:0
    ds_read_b128 v[72:75], v7 offset:32
    ds_read_b128 v[76:79], v7 offset:64
    ds_read_b128 v[80:83], v7 offset:96
    s_add_u32 s33, s34, 0
    s_and_b32 s33, s33, 3
    s_lshl_b32 s33, s33, 11
    s_add_u32 s48, s33, s42
    s_waitcnt lgkmcnt(7)
    v_mul_f32 v52, v4, v52
    v_mul_f32 v53, v4, v53
    v_mul_f32 v54, v4, v54
    v_mul_f32 v55, v4, v55
    v_fma_f32 v84, v84, v5, -v52
    v_fma_f32 v85, v85, v5, -v53
    v_fma_f32 v86, v86, v5, -v54
    v_fma_f32 v87, v87, v5, -v55
    s_waitcnt lgkmcnt(6)
    v_mul_f32 v56, v4, v56
    v_mul_f32 v57, v4, v57
    v_mul_f32 v58, v4, v58
    v_mul_f32 v59, v4, v59
    v_fma_f32 v88, v88, v5, -v56
    v_fma_f32 v89, v89, v5, -v57
    v_fma_f32 v90, v90, v5, -v58
    v_fma_f32 v91, v91, v5, -v59
    v_cvt_pk_bf16_f32 v84, v84, v85
    v_cvt_pk_bf16_f32 v85, v86, v87
    v_cvt_pk_bf16_f32 v86, v88, v89
    v_cvt_pk_bf16_f32 v87, v90, v91
    s_nop 0
    v_permlane32_swap_b32 v84, v86
    v_permlane32_swap_b32 v85, v87
    buffer_store_dwordx4 v[84:87], v30, s[44:47], s48 offen offset:0 sc1
    s_waitcnt lgkmcnt(5)
    v_mul_f32 v60, v4, v60
    v_mul_f32 v61, v4, v61
    v_mul_f32 v62, v4, v62
    v_mul_f32 v63, v4, v63
    v_fma_f32 v92, v92, v5, -v60
    v_fma_f32 v93, v93, v5, -v61
    v_fma_f32 v94, v94, v5, -v62
    v_fma_f32 v95, v95, v5, -v63
    s_waitcnt lgkmcnt(4)
    v_mul_f32 v64, v4, v64
    v_mul_f32 v65, v4, v65
    v_mul_f32 v66, v4, v66
    v_mul_f32 v67, v4, v67
    v_fma_f32 v96, v96, v5, -v64
    v_fma_f32 v97, v97, v5, -v65
    v_fma_f32 v98, v98, v5, -v66
    v_fma_f32 v99, v99, v5, -v67
    v_cvt_pk_bf16_f32 v92, v92, v93
    v_cvt_pk_bf16_f32 v93, v94, v95
    v_cvt_pk_bf16_f32 v94, v96, v97
    v_cvt_pk_bf16_f32 v95, v98, v99
    s_nop 0
    v_permlane32_swap_b32 v92, v94
    v_permlane32_swap_b32 v93, v95
    buffer_store_dwordx4 v[92:95], v30, s[44:47], s48 offen offset:1024 sc1
    s_add_u32 s33, s34, 2
    s_and_b32 s33, s33, 3
    s_lshl_b32 s33, s33, 7
    s_add_u32 s33, s33, 131072
    v_add_u32 v7, s33, v6
    ds_read_b128 v[52:55], v7 offset:0
    ds_read_b128 v[56:59], v7 offset:32
    ds_read_b128 v[60:63], v7 offset:64
    ds_read_b128 v[64:67], v7 offset:96
    s_add_u32 s33, s34, 1
    s_and_b32 s33, s33, 3
    s_lshl_b32 s33, s33, 11
    s_add_u32 s48, s33, s42
    s_waitcnt lgkmcnt(7)
    v_mul_f32 v68, v4, v68
    v_mul_f32 v69, v4, v69
    v_mul_f32 v70, v4, v70
    v_mul_f32 v71, v4, v71
    v_fma_f32 v100, v100, v5, -v68
    v_fma_f32 v101, v101, v5, -v69
    v_fma_f32 v102, v102, v5, -v70
    v_fma_f32 v103, v103, v5, -v71
    s_waitcnt lgkmcnt(6)
    v_mul_f32 v72, v4, v72
    v_mul_f32 v73, v4, v73
    v_mul_f32 v74, v4, v74
    v_mul_f32 v75, v4, v75
    v_fma_f32 v104, v104, v5, -v72
    v_fma_f32 v105, v105, v5, -v73
    v_fma_f32 v106, v106, v5, -v74
    v_fma_f32 v107, v107, v5, -v75
    v_cvt_pk_bf16_f32 v100, v100, v101
    v_cvt_pk_bf16_f32 v101, v102, v103
    v_cvt_pk_bf16_f32 v102, v104, v105
    v_cvt_pk_bf16_f32 v103, v106, v107
    s_nop 0
    v_permlane32_swap_b32 v100, v102
    v_permlane32_swap_b32 v101, v103
    buffer_store_dwordx4 v[100:103], v30, s[44:47], s48 offen offset:0 sc1
    s_waitcnt lgkmcnt(5)
    v_mul_f32 v76, v4, v76
    v_mul_f32 v77, v4, v77
    v_mul_f32 v78, v4, v78
    v_mul_f32 v79, v4, v79
    v_fma_f32 v108, v108, v5, -v76
    v_fma_f32 v109, v109, v5, -v77
    v_fma_f32 v110, v110, v5, -v78
    v_fma_f32 v111, v111, v5, -v79
    s_waitcnt lgkmcnt(4)
    v_mul_f32 v80, v4, v80
    v_mul_f32 v81, v4, v81
    v_mul_f32 v82, v4, v82
    v_mul_f32 v83, v4, v83
    v_fma_f32 v112, v112, v5, -v80
    v_fma_f32 v113, v113, v5, -v81
    v_fma_f32 v114, v114, v5, -v82
    v_fma_f32 v115, v115, v5, -v83
    v_cvt_pk_bf16_f32 v108, v108, v109
    v_cvt_pk_bf16_f32 v109, v110, v111
    v_cvt_pk_bf16_f32 v110, v112, v113
    v_cvt_pk_bf16_f32 v111, v114, v115
    s_nop 0
    v_permlane32_swap_b32 v108, v110
    v_permlane32_swap_b32 v109, v111
    buffer_store_dwordx4 v[108:111], v30, s[44:47], s48 offen offset:1024 sc1
    s_add_u32 s33, s34, 3
    s_and_b32 s33, s33, 3
    s_lshl_b32 s33, s33, 7
    s_add_u32 s33, s33, 131072
    v_add_u32 v7, s33, v6
    ds_read_b128 v[68:71], v7 offset:0
    ds_read_b128 v[72:75], v7 offset:32
    ds_read_b128 v[76:79], v7 offset:64
    ds_read_b128 v[80:83], v7 offset:96
    s_add_u32 s33, s34, 2
    s_and_b32 s33, s33, 3
    s_lshl_b32 s33, s33, 11
    s_add_u32 s48, s33, s42
    s_waitcnt lgkmcnt(7)
    v_mul_f32 v52, v4, v52
    v_mul_f32 v53, v4, v53
    v_mul_f32 v54, v4, v54
    v_mul_f32 v55, v4, v55
    v_fma_f32 v116, v116, v5, -v52
    v_fma_f32 v117, v117, v5, -v53
    v_fma_f32 v118, v118, v5, -v54
    v_fma_f32 v119, v119, v5, -v55
    s_waitcnt lgkmcnt(6)
    v_mul_f32 v56, v4, v56
    v_mul_f32 v57, v4, v57
    v_mul_f32 v58, v4, v58
    v_mul_f32 v59, v4, v59
    v_fma_f32 v120, v120, v5, -v56
    v_fma_f32 v121, v121, v5, -v57
    v_fma_f32 v122, v122, v5, -v58
    v_fma_f32 v123, v123, v5, -v59
    v_cvt_pk_bf16_f32 v116, v116, v117
    v_cvt_pk_bf16_f32 v117, v118, v119
    v_cvt_pk_bf16_f32 v118, v120, v121
    v_cvt_pk_bf16_f32 v119, v122, v123
    s_nop 0
    v_permlane32_swap_b32 v116, v118
    v_permlane32_swap_b32 v117, v119
    buffer_store_dwordx4 v[116:119], v30, s[44:47], s48 offen offset:0 sc1
    s_waitcnt lgkmcnt(5)
    v_mul_f32 v60, v4, v60
    v_mul_f32 v61, v4, v61
    v_mul_f32 v62, v4, v62
    v_mul_f32 v63, v4, v63
    v_fma_f32 v124, v124, v5, -v60
    v_fma_f32 v125, v125, v5, -v61
    v_fma_f32 v126, v126, v5, -v62
    v_fma_f32 v127, v127, v5, -v63
    s_waitcnt lgkmcnt(4)
    v_mul_f32 v64, v4, v64
    v_mul_f32 v65, v4, v65
    v_mul_f32 v66, v4, v66
    v_mul_f32 v67, v4, v67
    v_fma_f32 v128, v128, v5, -v64
    v_fma_f32 v129, v129, v5, -v65
    v_fma_f32 v130, v130, v5, -v66
    v_fma_f32 v131, v131, v5, -v67
    v_cvt_pk_bf16_f32 v124, v124, v125
    v_cvt_pk_bf16_f32 v125, v126, v127
    v_cvt_pk_bf16_f32 v126, v128, v129
    v_cvt_pk_bf16_f32 v127, v130, v131
    s_nop 0
    v_permlane32_swap_b32 v124, v126
    v_permlane32_swap_b32 v125, v127
    buffer_store_dwordx4 v[124:127], v30, s[44:47], s48 offen offset:1024 sc1
    s_add_u32 s33, s34, 3
    s_and_b32 s33, s33, 3
    s_lshl_b32 s33, s33, 11
    s_add_u32 s48, s33, s42
    s_waitcnt lgkmcnt(3)
    v_mul_f32 v68, v4, v68
    v_mul_f32 v69, v4, v69
    v_mul_f32 v70, v4, v70
    v_mul_f32 v71, v4, v71
    v_fma_f32 v132, v132, v5, -v68
    v_fma_f32 v133, v133, v5, -v69
    v_fma_f32 v134, v134, v5, -v70
    v_fma_f32 v135, v135, v5, -v71
    s_waitcnt lgkmcnt(2)
    v_mul_f32 v72, v4, v72
    v_mul_f32 v73, v4, v73
    v_mul_f32 v74, v4, v74
    v_mul_f32 v75, v4, v75
    v_fma_f32 v136, v136, v5, -v72
    v_fma_f32 v137, v137, v5, -v73
    v_fma_f32 v138, v138, v5, -v74
    v_fma_f32 v139, v139, v5, -v75
    v_cvt_pk_bf16_f32 v132, v132, v133
    v_cvt_pk_bf16_f32 v133, v134, v135
    v_cvt_pk_bf16_f32 v134, v136, v137
    v_cvt_pk_bf16_f32 v135, v138, v139
    s_nop 0
    v_permlane32_swap_b32 v132, v134
    v_permlane32_swap_b32 v133, v135
    buffer_store_dwordx4 v[132:135], v30, s[44:47], s48 offen offset:0 sc1
    s_waitcnt lgkmcnt(1)
    v_mul_f32 v76, v4, v76
    v_mul_f32 v77, v4, v77
    v_mul_f32 v78, v4, v78
    v_mul_f32 v79, v4, v79
    v_fma_f32 v140, v140, v5, -v76
    v_fma_f32 v141, v141, v5, -v77
    v_fma_f32 v142, v142, v5, -v78
    v_fma_f32 v143, v143, v5, -v79
    s_waitcnt lgkmcnt(0)
    v_mul_f32 v80, v4, v80
    v_mul_f32 v81, v4, v81
    v_mul_f32 v82, v4, v82
    v_mul_f32 v83, v4, v83
    v_fma_f32 v144, v144, v5, -v80
    v_fma_f32 v145, v145, v5, -v81
    v_fma_f32 v146, v146, v5, -v82
    v_fma_f32 v147, v147, v5, -v83
    v_cvt_pk_bf16_f32 v140, v140, v141
    v_cvt_pk_bf16_f32 v141, v142, v143
    v_cvt_pk_bf16_f32 v142, v144, v145
    v_cvt_pk_bf16_f32 v143, v146, v147
    s_nop 0
    v_permlane32_swap_b32 v140, v142
    v_permlane32_swap_b32 v141, v143
    buffer_store_dwordx4 v[140:143], v30, s[44:47], s48 offen offset:1024 sc1
    s_branch sequential_preLN__sliding_block__geglu_ffn__prompt_kernel_p1j10
    s_nop 2
sequential_preLN__sliding_block__geglu_ffn__prompt_kernel_p1v9:
    s_mul_i32 s42, s40, 1280
    s_add_u32 s33, s34, 0
    s_and_b32 s33, s33, 3
    s_lshl_b32 s33, s33, 5
    s_lshl_b32 s43, s39, 7
    s_add_u32 s43, s33, s43
    v_add_u32 v4, s43, v2
    v_mul_u32_u24 v5, 3277, v4
    v_lshrrev_b32 v5, 16, v5
    v_mul_u32_u24 v6, 20, v5
    v_sub_u32 v6, v4, v6
    v_mul_u32_u24 v7, 320, v3
    v_lshl_add_u32 v7, v6, 4, v7
    s_mov_b32 s33, 81920
    v_mad_u32_u24 v30, v5, s33, v7
    s_add_u32 s33, s34, 1
    s_and_b32 s33, s33, 3
    s_lshl_b32 s33, s33, 5
    s_lshl_b32 s43, s39, 7
    s_add_u32 s43, s33, s43
    v_add_u32 v4, s43, v2
    v_mul_u32_u24 v5, 3277, v4
    v_lshrrev_b32 v5, 16, v5
    v_mul_u32_u24 v6, 20, v5
    v_sub_u32 v6, v4, v6
    v_mul_u32_u24 v7, 320, v3
    v_lshl_add_u32 v7, v6, 4, v7
    s_mov_b32 s33, 81920
    v_mad_u32_u24 v31, v5, s33, v7
    s_add_u32 s33, s34, 2
    s_and_b32 s33, s33, 3
    s_lshl_b32 s33, s33, 5
    s_lshl_b32 s43, s39, 7
    s_add_u32 s43, s33, s43
    v_add_u32 v4, s43, v2
    v_mul_u32_u24 v5, 3277, v4
    v_lshrrev_b32 v5, 16, v5
    v_mul_u32_u24 v6, 20, v5
    v_sub_u32 v6, v4, v6
    v_mul_u32_u24 v7, 320, v3
    v_lshl_add_u32 v7, v6, 4, v7
    s_mov_b32 s33, 81920
    v_mad_u32_u24 v32, v5, s33, v7
    s_add_u32 s33, s34, 3
    s_and_b32 s33, s33, 3
    s_lshl_b32 s33, s33, 5
    s_lshl_b32 s43, s39, 7
    s_add_u32 s43, s33, s43
    v_add_u32 v4, s43, v2
    v_mul_u32_u24 v5, 3277, v4
    v_lshrrev_b32 v5, 16, v5
    v_mul_u32_u24 v6, 20, v5
    v_sub_u32 v6, v4, v6
    v_mul_u32_u24 v7, 320, v3
    v_lshl_add_u32 v7, v6, 4, v7
    s_mov_b32 s33, 81920
    v_mad_u32_u24 v33, v5, s33, v7
    s_barrier
    ds_read_b128 v[44:47], v14 offset:0
    ds_read_b64_tr_b16 v[52:53], v22 offset:0
    ds_read_b64_tr_b16 v[54:55], v22 offset:1024
    ds_read_b64_tr_b16 v[56:57], v23 offset:0
    ds_read_b64_tr_b16 v[58:59], v23 offset:1024
    ds_read_b64_tr_b16 v[60:61], v24 offset:0
    ds_read_b64_tr_b16 v[62:63], v24 offset:1024
    ds_read_b64_tr_b16 v[64:65], v25 offset:0
    ds_read_b64_tr_b16 v[66:67], v25 offset:1024
    s_waitcnt lgkmcnt(6)
    v_mfma_f32_32x32x16_bf16 v[84:99], v[44:47], v[52:55], 0
    ds_read_b128 v[48:51], v15 offset:0
    ds_read_b64_tr_b16 v[68:69], v22 offset:4096
    ds_read_b64_tr_b16 v[70:71], v22 offset:5120
    s_waitcnt lgkmcnt(7)
    v_mfma_f32_32x32x16_bf16 v[100:115], v[44:47], v[56:59], 0
    ds_read_b64_tr_b16 v[72:73], v23 offset:4096
    ds_read_b64_tr_b16 v[74:75], v23 offset:5120
    s_waitcnt lgkmcnt(7)
    v_mfma_f32_32x32x16_bf16 v[116:131], v[44:47], v[60:63], 0
    ds_read_b64_tr_b16 v[76:77], v24 offset:4096
    ds_read_b64_tr_b16 v[78:79], v24 offset:5120
    s_waitcnt lgkmcnt(7)
    v_mfma_f32_32x32x16_bf16 v[132:147], v[44:47], v[64:67], 0
    ds_read_b64_tr_b16 v[80:81], v25 offset:4096
    ds_read_b64_tr_b16 v[82:83], v25 offset:5120
    v_mfma_f32_16x16x32_bf16 v[40:43], v[36:39], v[52:55], 0
    s_waitcnt lgkmcnt(6)
    v_mfma_f32_32x32x16_bf16 v[84:99], v[48:51], v[68:71], v[84:99]
    ds_read_b128 v[44:47], v16 offset:0
    ds_read_b64_tr_b16 v[52:53], v22 offset:8192
    ds_read_b64_tr_b16 v[54:55], v22 offset:9216
    s_waitcnt lgkmcnt(7)
    v_mfma_f32_32x32x16_bf16 v[100:115], v[48:51], v[72:75], v[100:115]
    ds_read_b64_tr_b16 v[56:57], v23 offset:8192
    ds_read_b64_tr_b16 v[58:59], v23 offset:9216
    s_waitcnt lgkmcnt(7)
    v_mfma_f32_32x32x16_bf16 v[116:131], v[48:51], v[76:79], v[116:131]
    ds_read_b64_tr_b16 v[60:61], v24 offset:8192
    ds_read_b64_tr_b16 v[62:63], v24 offset:9216
    s_waitcnt lgkmcnt(7)
    v_mfma_f32_32x32x16_bf16 v[132:147], v[48:51], v[80:83], v[132:147]
    ds_read_b64_tr_b16 v[64:65], v25 offset:8192
    ds_read_b64_tr_b16 v[66:67], v25 offset:9216
    v_mfma_f32_16x16x32_bf16 v[40:43], v[36:39], v[68:71], v[40:43]
    s_waitcnt lgkmcnt(6)
    v_mfma_f32_32x32x16_bf16 v[84:99], v[44:47], v[52:55], v[84:99]
    ds_read_b128 v[48:51], v17 offset:0
    ds_read_b64_tr_b16 v[68:69], v22 offset:12288
    ds_read_b64_tr_b16 v[70:71], v22 offset:13312
    s_waitcnt lgkmcnt(7)
    v_mfma_f32_32x32x16_bf16 v[100:115], v[44:47], v[56:59], v[100:115]
    ds_read_b64_tr_b16 v[72:73], v23 offset:12288
    ds_read_b64_tr_b16 v[74:75], v23 offset:13312
    s_waitcnt lgkmcnt(7)
    v_mfma_f32_32x32x16_bf16 v[116:131], v[44:47], v[60:63], v[116:131]
    ds_read_b64_tr_b16 v[76:77], v24 offset:12288
    ds_read_b64_tr_b16 v[78:79], v24 offset:13312
    s_waitcnt lgkmcnt(7)
    v_mfma_f32_32x32x16_bf16 v[132:147], v[44:47], v[64:67], v[132:147]
    ds_read_b64_tr_b16 v[80:81], v25 offset:12288
    ds_read_b64_tr_b16 v[82:83], v25 offset:13312
    v_mfma_f32_16x16x32_bf16 v[40:43], v[36:39], v[52:55], v[40:43]
    s_waitcnt lgkmcnt(6)
    v_mfma_f32_32x32x16_bf16 v[84:99], v[48:51], v[68:71], v[84:99]
    s_waitcnt lgkmcnt(0)
    s_barrier
    ds_read_b128 v[44:47], v14 offset:32768
    ds_read_b64_tr_b16 v[52:53], v22 offset:32768
    ds_read_b64_tr_b16 v[54:55], v22 offset:33792
    v_mfma_f32_32x32x16_bf16 v[100:115], v[48:51], v[72:75], v[100:115]
    ds_read_b64_tr_b16 v[56:57], v23 offset:32768
    ds_read_b64_tr_b16 v[58:59], v23 offset:33792
    v_mfma_f32_32x32x16_bf16 v[116:131], v[48:51], v[76:79], v[116:131]
    ds_read_b64_tr_b16 v[60:61], v24 offset:32768
    ds_read_b64_tr_b16 v[62:63], v24 offset:33792
    v_mfma_f32_32x32x16_bf16 v[132:147], v[48:51], v[80:83], v[132:147]
    ds_read_b64_tr_b16 v[64:65], v25 offset:32768
    ds_read_b64_tr_b16 v[66:67], v25 offset:33792
    v_mfma_f32_16x16x32_bf16 v[40:43], v[36:39], v[68:71], v[40:43]
    s_waitcnt lgkmcnt(6)
    v_mfma_f32_32x32x16_bf16 v[84:99], v[44:47], v[52:55], v[84:99]
    ds_read_b128 v[48:51], v15 offset:32768
    ds_read_b64_tr_b16 v[68:69], v22 offset:36864
    ds_read_b64_tr_b16 v[70:71], v22 offset:37888
    s_waitcnt lgkmcnt(7)
    v_mfma_f32_32x32x16_bf16 v[100:115], v[44:47], v[56:59], v[100:115]
    ds_read_b64_tr_b16 v[72:73], v23 offset:36864
    ds_read_b64_tr_b16 v[74:75], v23 offset:37888
    s_waitcnt lgkmcnt(7)
    v_mfma_f32_32x32x16_bf16 v[116:131], v[44:47], v[60:63], v[116:131]
    ds_read_b64_tr_b16 v[76:77], v24 offset:36864
    ds_read_b64_tr_b16 v[78:79], v24 offset:37888
    s_waitcnt lgkmcnt(7)
    v_mfma_f32_32x32x16_bf16 v[132:147], v[44:47], v[64:67], v[132:147]
    ds_read_b64_tr_b16 v[80:81], v25 offset:36864
    ds_read_b64_tr_b16 v[82:83], v25 offset:37888
    v_mfma_f32_16x16x32_bf16 v[40:43], v[36:39], v[52:55], v[40:43]
    s_waitcnt lgkmcnt(6)
    v_mfma_f32_32x32x16_bf16 v[84:99], v[48:51], v[68:71], v[84:99]
    ds_read_b128 v[44:47], v16 offset:32768
    ds_read_b64_tr_b16 v[52:53], v22 offset:40960
    ds_read_b64_tr_b16 v[54:55], v22 offset:41984
    s_waitcnt lgkmcnt(7)
    v_mfma_f32_32x32x16_bf16 v[100:115], v[48:51], v[72:75], v[100:115]
    ds_read_b64_tr_b16 v[56:57], v23 offset:40960
    ds_read_b64_tr_b16 v[58:59], v23 offset:41984
    s_waitcnt lgkmcnt(7)
    v_mfma_f32_32x32x16_bf16 v[116:131], v[48:51], v[76:79], v[116:131]
    ds_read_b64_tr_b16 v[60:61], v24 offset:40960
    ds_read_b64_tr_b16 v[62:63], v24 offset:41984
    s_waitcnt lgkmcnt(7)
    v_mfma_f32_32x32x16_bf16 v[132:147], v[48:51], v[80:83], v[132:147]
    ds_read_b64_tr_b16 v[64:65], v25 offset:40960
    ds_read_b64_tr_b16 v[66:67], v25 offset:41984
    v_mfma_f32_16x16x32_bf16 v[40:43], v[36:39], v[68:71], v[40:43]
    s_waitcnt lgkmcnt(6)
    v_mfma_f32_32x32x16_bf16 v[84:99], v[44:47], v[52:55], v[84:99]
    ds_read_b128 v[48:51], v17 offset:32768
    ds_read_b64_tr_b16 v[68:69], v22 offset:45056
    ds_read_b64_tr_b16 v[70:71], v22 offset:46080
    s_waitcnt lgkmcnt(7)
    v_mfma_f32_32x32x16_bf16 v[100:115], v[44:47], v[56:59], v[100:115]
    ds_read_b64_tr_b16 v[72:73], v23 offset:45056
    ds_read_b64_tr_b16 v[74:75], v23 offset:46080
    s_waitcnt lgkmcnt(7)
    v_mfma_f32_32x32x16_bf16 v[116:131], v[44:47], v[60:63], v[116:131]
    ds_read_b64_tr_b16 v[76:77], v24 offset:45056
    ds_read_b64_tr_b16 v[78:79], v24 offset:46080
    s_waitcnt lgkmcnt(7)
    v_mfma_f32_32x32x16_bf16 v[132:147], v[44:47], v[64:67], v[132:147]
    ds_read_b64_tr_b16 v[80:81], v25 offset:45056
    ds_read_b64_tr_b16 v[82:83], v25 offset:46080
    v_mfma_f32_16x16x32_bf16 v[40:43], v[36:39], v[52:55], v[40:43]
    s_waitcnt lgkmcnt(6)
    v_mfma_f32_32x32x16_bf16 v[84:99], v[48:51], v[68:71], v[84:99]
    s_waitcnt lgkmcnt(0)
    s_barrier
    ds_read_b128 v[44:47], v18 offset:0
    ds_read_b64_tr_b16 v[52:53], v26 offset:0
    ds_read_b64_tr_b16 v[54:55], v26 offset:1024
    v_mfma_f32_32x32x16_bf16 v[100:115], v[48:51], v[72:75], v[100:115]
    ds_read_b64_tr_b16 v[56:57], v27 offset:0
    ds_read_b64_tr_b16 v[58:59], v27 offset:1024
    v_mfma_f32_32x32x16_bf16 v[116:131], v[48:51], v[76:79], v[116:131]
    ds_read_b64_tr_b16 v[60:61], v28 offset:0
    ds_read_b64_tr_b16 v[62:63], v28 offset:1024
    v_mfma_f32_32x32x16_bf16 v[132:147], v[48:51], v[80:83], v[132:147]
    ds_read_b64_tr_b16 v[64:65], v29 offset:0
    ds_read_b64_tr_b16 v[66:67], v29 offset:1024
    v_mfma_f32_16x16x32_bf16 v[40:43], v[36:39], v[68:71], v[40:43]
    s_waitcnt lgkmcnt(6)
    v_mfma_f32_32x32x16_bf16 v[84:99], v[44:47], v[52:55], v[84:99]
    ds_read_b128 v[48:51], v19 offset:0
    ds_read_b64_tr_b16 v[68:69], v26 offset:4096
    ds_read_b64_tr_b16 v[70:71], v26 offset:5120
    s_waitcnt lgkmcnt(7)
    v_mfma_f32_32x32x16_bf16 v[100:115], v[44:47], v[56:59], v[100:115]
    ds_read_b64_tr_b16 v[72:73], v27 offset:4096
    ds_read_b64_tr_b16 v[74:75], v27 offset:5120
    s_waitcnt lgkmcnt(7)
    v_mfma_f32_32x32x16_bf16 v[116:131], v[44:47], v[60:63], v[116:131]
    ds_read_b64_tr_b16 v[76:77], v28 offset:4096
    ds_read_b64_tr_b16 v[78:79], v28 offset:5120
    s_waitcnt lgkmcnt(7)
    v_mfma_f32_32x32x16_bf16 v[132:147], v[44:47], v[64:67], v[132:147]
    ds_read_b64_tr_b16 v[80:81], v29 offset:4096
    ds_read_b64_tr_b16 v[82:83], v29 offset:5120
    v_mfma_f32_16x16x32_bf16 v[40:43], v[36:39], v[52:55], v[40:43]
    s_waitcnt lgkmcnt(6)
    v_mfma_f32_32x32x16_bf16 v[84:99], v[48:51], v[68:71], v[84:99]
    ds_read_b128 v[44:47], v20 offset:0
    ds_read_b64_tr_b16 v[52:53], v26 offset:8192
    ds_read_b64_tr_b16 v[54:55], v26 offset:9216
    s_waitcnt lgkmcnt(7)
    v_mfma_f32_32x32x16_bf16 v[100:115], v[48:51], v[72:75], v[100:115]
    ds_read_b64_tr_b16 v[56:57], v27 offset:8192
    ds_read_b64_tr_b16 v[58:59], v27 offset:9216
    s_waitcnt lgkmcnt(7)
    v_mfma_f32_32x32x16_bf16 v[116:131], v[48:51], v[76:79], v[116:131]
    ds_read_b64_tr_b16 v[60:61], v28 offset:8192
    ds_read_b64_tr_b16 v[62:63], v28 offset:9216
    s_waitcnt lgkmcnt(7)
    v_mfma_f32_32x32x16_bf16 v[132:147], v[48:51], v[80:83], v[132:147]
    ds_read_b64_tr_b16 v[64:65], v29 offset:8192
    ds_read_b64_tr_b16 v[66:67], v29 offset:9216
    v_mfma_f32_16x16x32_bf16 v[40:43], v[36:39], v[68:71], v[40:43]
    s_waitcnt lgkmcnt(6)
    v_mfma_f32_32x32x16_bf16 v[84:99], v[44:47], v[52:55], v[84:99]
    ds_read_b128 v[48:51], v21 offset:0
    ds_read_b64_tr_b16 v[68:69], v26 offset:12288
    ds_read_b64_tr_b16 v[70:71], v26 offset:13312
    s_waitcnt lgkmcnt(7)
    v_mfma_f32_32x32x16_bf16 v[100:115], v[44:47], v[56:59], v[100:115]
    ds_read_b64_tr_b16 v[72:73], v27 offset:12288
    ds_read_b64_tr_b16 v[74:75], v27 offset:13312
    s_waitcnt lgkmcnt(7)
    v_mfma_f32_32x32x16_bf16 v[116:131], v[44:47], v[60:63], v[116:131]
    ds_read_b64_tr_b16 v[76:77], v28 offset:12288
    ds_read_b64_tr_b16 v[78:79], v28 offset:13312
    s_waitcnt lgkmcnt(7)
    v_mfma_f32_32x32x16_bf16 v[132:147], v[44:47], v[64:67], v[132:147]
    ds_read_b64_tr_b16 v[80:81], v29 offset:12288
    ds_read_b64_tr_b16 v[82:83], v29 offset:13312
    v_mfma_f32_16x16x32_bf16 v[40:43], v[36:39], v[52:55], v[40:43]
    s_waitcnt lgkmcnt(6)
    v_mfma_f32_32x32x16_bf16 v[84:99], v[48:51], v[68:71], v[84:99]
    s_waitcnt lgkmcnt(0)
    s_barrier
    ds_read_b128 v[44:47], v18 offset:32768
    ds_read_b64_tr_b16 v[52:53], v26 offset:32768
    ds_read_b64_tr_b16 v[54:55], v26 offset:33792
    v_mfma_f32_32x32x16_bf16 v[100:115], v[48:51], v[72:75], v[100:115]
    ds_read_b64_tr_b16 v[56:57], v27 offset:32768
    ds_read_b64_tr_b16 v[58:59], v27 offset:33792
    v_mfma_f32_32x32x16_bf16 v[116:131], v[48:51], v[76:79], v[116:131]
    ds_read_b64_tr_b16 v[60:61], v28 offset:32768
    ds_read_b64_tr_b16 v[62:63], v28 offset:33792
    v_mfma_f32_32x32x16_bf16 v[132:147], v[48:51], v[80:83], v[132:147]
    ds_read_b64_tr_b16 v[64:65], v29 offset:32768
    ds_read_b64_tr_b16 v[66:67], v29 offset:33792
    v_mfma_f32_16x16x32_bf16 v[40:43], v[36:39], v[68:71], v[40:43]
    s_waitcnt lgkmcnt(6)
    v_mfma_f32_32x32x16_bf16 v[84:99], v[44:47], v[52:55], v[84:99]
    ds_read_b128 v[48:51], v19 offset:32768
    ds_read_b64_tr_b16 v[68:69], v26 offset:36864
    ds_read_b64_tr_b16 v[70:71], v26 offset:37888
    s_waitcnt lgkmcnt(7)
    v_mfma_f32_32x32x16_bf16 v[100:115], v[44:47], v[56:59], v[100:115]
    ds_read_b64_tr_b16 v[72:73], v27 offset:36864
    ds_read_b64_tr_b16 v[74:75], v27 offset:37888
    s_waitcnt lgkmcnt(7)
    v_mfma_f32_32x32x16_bf16 v[116:131], v[44:47], v[60:63], v[116:131]
    ds_read_b64_tr_b16 v[76:77], v28 offset:36864
    ds_read_b64_tr_b16 v[78:79], v28 offset:37888
    s_waitcnt lgkmcnt(7)
    v_mfma_f32_32x32x16_bf16 v[132:147], v[44:47], v[64:67], v[132:147]
    ds_read_b64_tr_b16 v[80:81], v29 offset:36864
    ds_read_b64_tr_b16 v[82:83], v29 offset:37888
    v_mfma_f32_16x16x32_bf16 v[40:43], v[36:39], v[52:55], v[40:43]
    s_waitcnt lgkmcnt(6)
    v_mfma_f32_32x32x16_bf16 v[84:99], v[48:51], v[68:71], v[84:99]
    ds_read_b128 v[44:47], v20 offset:32768
    ds_read_b64_tr_b16 v[52:53], v26 offset:40960
    ds_read_b64_tr_b16 v[54:55], v26 offset:41984
    s_waitcnt lgkmcnt(7)
    v_mfma_f32_32x32x16_bf16 v[100:115], v[48:51], v[72:75], v[100:115]
    ds_read_b64_tr_b16 v[56:57], v27 offset:40960
    ds_read_b64_tr_b16 v[58:59], v27 offset:41984
    s_waitcnt lgkmcnt(7)
    v_mfma_f32_32x32x16_bf16 v[116:131], v[48:51], v[76:79], v[116:131]
    ds_read_b64_tr_b16 v[60:61], v28 offset:40960
    ds_read_b64_tr_b16 v[62:63], v28 offset:41984
    s_waitcnt lgkmcnt(7)
    v_mfma_f32_32x32x16_bf16 v[132:147], v[48:51], v[80:83], v[132:147]
    ds_read_b64_tr_b16 v[64:65], v29 offset:40960
    ds_read_b64_tr_b16 v[66:67], v29 offset:41984
    v_mfma_f32_16x16x32_bf16 v[40:43], v[36:39], v[68:71], v[40:43]
    s_waitcnt lgkmcnt(6)
    v_mfma_f32_32x32x16_bf16 v[84:99], v[44:47], v[52:55], v[84:99]
    ds_read_b128 v[48:51], v21 offset:32768
    ds_read_b64_tr_b16 v[68:69], v26 offset:45056
    ds_read_b64_tr_b16 v[70:71], v26 offset:46080
    s_waitcnt lgkmcnt(7)
    v_mfma_f32_32x32x16_bf16 v[100:115], v[44:47], v[56:59], v[100:115]
    ds_read_b64_tr_b16 v[72:73], v27 offset:45056
    ds_read_b64_tr_b16 v[74:75], v27 offset:46080
    s_waitcnt lgkmcnt(7)
    v_mfma_f32_32x32x16_bf16 v[116:131], v[44:47], v[60:63], v[116:131]
    ds_read_b64_tr_b16 v[76:77], v28 offset:45056
    ds_read_b64_tr_b16 v[78:79], v28 offset:46080
    s_waitcnt lgkmcnt(7)
    v_mfma_f32_32x32x16_bf16 v[132:147], v[44:47], v[64:67], v[132:147]
    ds_read_b64_tr_b16 v[80:81], v29 offset:45056
    ds_read_b64_tr_b16 v[82:83], v29 offset:46080
    v_mfma_f32_16x16x32_bf16 v[40:43], v[36:39], v[52:55], v[40:43]
    s_waitcnt lgkmcnt(6)
    v_mfma_f32_32x32x16_bf16 v[84:99], v[48:51], v[68:71], v[84:99]
    s_waitcnt lgkmcnt(0)
    s_barrier
    ds_read_b128 v[44:47], v14 offset:0
    ds_read_b64_tr_b16 v[52:53], v22 offset:0
    ds_read_b64_tr_b16 v[54:55], v22 offset:1024
    v_mfma_f32_32x32x16_bf16 v[100:115], v[48:51], v[72:75], v[100:115]
    ds_read_b64_tr_b16 v[56:57], v23 offset:0
    ds_read_b64_tr_b16 v[58:59], v23 offset:1024
    v_mfma_f32_32x32x16_bf16 v[116:131], v[48:51], v[76:79], v[116:131]
    ds_read_b64_tr_b16 v[60:61], v24 offset:0
    ds_read_b64_tr_b16 v[62:63], v24 offset:1024
    v_mfma_f32_32x32x16_bf16 v[132:147], v[48:51], v[80:83], v[132:147]
    ds_read_b64_tr_b16 v[64:65], v25 offset:0
    ds_read_b64_tr_b16 v[66:67], v25 offset:1024
    v_mfma_f32_16x16x32_bf16 v[40:43], v[36:39], v[68:71], v[40:43]
    s_waitcnt lgkmcnt(6)
    v_mfma_f32_32x32x16_bf16 v[84:99], v[44:47], v[52:55], v[84:99]
    ds_read_b128 v[48:51], v15 offset:0
    ds_read_b64_tr_b16 v[68:69], v22 offset:4096
    ds_read_b64_tr_b16 v[70:71], v22 offset:5120
    s_waitcnt lgkmcnt(7)
    v_mfma_f32_32x32x16_bf16 v[100:115], v[44:47], v[56:59], v[100:115]
    ds_read_b64_tr_b16 v[72:73], v23 offset:4096
    ds_read_b64_tr_b16 v[74:75], v23 offset:5120
    s_waitcnt lgkmcnt(7)
    v_mfma_f32_32x32x16_bf16 v[116:131], v[44:47], v[60:63], v[116:131]
    ds_read_b64_tr_b16 v[76:77], v24 offset:4096
    ds_read_b64_tr_b16 v[78:79], v24 offset:5120
    s_waitcnt lgkmcnt(7)
    v_mfma_f32_32x32x16_bf16 v[132:147], v[44:47], v[64:67], v[132:147]
    ds_read_b64_tr_b16 v[80:81], v25 offset:4096
    ds_read_b64_tr_b16 v[82:83], v25 offset:5120
    v_mfma_f32_16x16x32_bf16 v[40:43], v[36:39], v[52:55], v[40:43]
    s_waitcnt lgkmcnt(6)
    v_mfma_f32_32x32x16_bf16 v[84:99], v[48:51], v[68:71], v[84:99]
    ds_read_b128 v[44:47], v16 offset:0
    ds_read_b64_tr_b16 v[52:53], v22 offset:8192
    ds_read_b64_tr_b16 v[54:55], v22 offset:9216
    s_waitcnt lgkmcnt(7)
    v_mfma_f32_32x32x16_bf16 v[100:115], v[48:51], v[72:75], v[100:115]
    ds_read_b64_tr_b16 v[56:57], v23 offset:8192
    ds_read_b64_tr_b16 v[58:59], v23 offset:9216
    s_waitcnt lgkmcnt(7)
    v_mfma_f32_32x32x16_bf16 v[116:131], v[48:51], v[76:79], v[116:131]
    ds_read_b64_tr_b16 v[60:61], v24 offset:8192
    ds_read_b64_tr_b16 v[62:63], v24 offset:9216
    s_waitcnt lgkmcnt(7)
    v_mfma_f32_32x32x16_bf16 v[132:147], v[48:51], v[80:83], v[132:147]
    ds_read_b64_tr_b16 v[64:65], v25 offset:8192
    ds_read_b64_tr_b16 v[66:67], v25 offset:9216
    v_mfma_f32_16x16x32_bf16 v[40:43], v[36:39], v[68:71], v[40:43]
    s_waitcnt lgkmcnt(6)
    v_mfma_f32_32x32x16_bf16 v[84:99], v[44:47], v[52:55], v[84:99]
    ds_read_b128 v[48:51], v17 offset:0
    ds_read_b64_tr_b16 v[68:69], v22 offset:12288
    ds_read_b64_tr_b16 v[70:71], v22 offset:13312
    s_waitcnt lgkmcnt(7)
    v_mfma_f32_32x32x16_bf16 v[100:115], v[44:47], v[56:59], v[100:115]
    ds_read_b64_tr_b16 v[72:73], v23 offset:12288
    ds_read_b64_tr_b16 v[74:75], v23 offset:13312
    s_waitcnt lgkmcnt(7)
    v_mfma_f32_32x32x16_bf16 v[116:131], v[44:47], v[60:63], v[116:131]
    ds_read_b64_tr_b16 v[76:77], v24 offset:12288
    ds_read_b64_tr_b16 v[78:79], v24 offset:13312
    s_waitcnt lgkmcnt(7)
    v_mfma_f32_32x32x16_bf16 v[132:147], v[44:47], v[64:67], v[132:147]
    ds_read_b64_tr_b16 v[80:81], v25 offset:12288
    ds_read_b64_tr_b16 v[82:83], v25 offset:13312
    v_mfma_f32_16x16x32_bf16 v[40:43], v[36:39], v[52:55], v[40:43]
    s_waitcnt lgkmcnt(6)
    v_mfma_f32_32x32x16_bf16 v[84:99], v[48:51], v[68:71], v[84:99]
    s_waitcnt lgkmcnt(0)
    s_barrier
    ds_read_b128 v[44:47], v14 offset:32768
    ds_read_b64_tr_b16 v[52:53], v22 offset:32768
    ds_read_b64_tr_b16 v[54:55], v22 offset:33792
    v_mfma_f32_32x32x16_bf16 v[100:115], v[48:51], v[72:75], v[100:115]
    ds_read_b64_tr_b16 v[56:57], v23 offset:32768
    ds_read_b64_tr_b16 v[58:59], v23 offset:33792
    v_mfma_f32_32x32x16_bf16 v[116:131], v[48:51], v[76:79], v[116:131]
    ds_read_b64_tr_b16 v[60:61], v24 offset:32768
    ds_read_b64_tr_b16 v[62:63], v24 offset:33792
    v_mfma_f32_32x32x16_bf16 v[132:147], v[48:51], v[80:83], v[132:147]
    ds_read_b64_tr_b16 v[64:65], v25 offset:32768
    ds_read_b64_tr_b16 v[66:67], v25 offset:33792
    v_mfma_f32_16x16x32_bf16 v[40:43], v[36:39], v[68:71], v[40:43]
    s_waitcnt lgkmcnt(6)
    v_mfma_f32_32x32x16_bf16 v[84:99], v[44:47], v[52:55], v[84:99]
    ds_read_b128 v[48:51], v15 offset:32768
    ds_read_b64_tr_b16 v[68:69], v22 offset:36864
    ds_read_b64_tr_b16 v[70:71], v22 offset:37888
    s_waitcnt lgkmcnt(7)
    v_mfma_f32_32x32x16_bf16 v[100:115], v[44:47], v[56:59], v[100:115]
    ds_read_b64_tr_b16 v[72:73], v23 offset:36864
    ds_read_b64_tr_b16 v[74:75], v23 offset:37888
    s_waitcnt lgkmcnt(7)
    v_mfma_f32_32x32x16_bf16 v[116:131], v[44:47], v[60:63], v[116:131]
    ds_read_b64_tr_b16 v[76:77], v24 offset:36864
    ds_read_b64_tr_b16 v[78:79], v24 offset:37888
    s_waitcnt lgkmcnt(7)
    v_mfma_f32_32x32x16_bf16 v[132:147], v[44:47], v[64:67], v[132:147]
    ds_read_b64_tr_b16 v[80:81], v25 offset:36864
    ds_read_b64_tr_b16 v[82:83], v25 offset:37888
    v_mfma_f32_16x16x32_bf16 v[40:43], v[36:39], v[52:55], v[40:43]
    s_waitcnt lgkmcnt(6)
    v_mfma_f32_32x32x16_bf16 v[84:99], v[48:51], v[68:71], v[84:99]
    ds_read_b128 v[44:47], v16 offset:32768
    ds_read_b64_tr_b16 v[52:53], v22 offset:40960
    ds_read_b64_tr_b16 v[54:55], v22 offset:41984
    s_waitcnt lgkmcnt(7)
    v_mfma_f32_32x32x16_bf16 v[100:115], v[48:51], v[72:75], v[100:115]
    ds_read_b64_tr_b16 v[56:57], v23 offset:40960
    ds_read_b64_tr_b16 v[58:59], v23 offset:41984
    s_waitcnt lgkmcnt(7)
    v_mfma_f32_32x32x16_bf16 v[116:131], v[48:51], v[76:79], v[116:131]
    ds_read_b64_tr_b16 v[60:61], v24 offset:40960
    ds_read_b64_tr_b16 v[62:63], v24 offset:41984
    s_waitcnt lgkmcnt(7)
    v_mfma_f32_32x32x16_bf16 v[132:147], v[48:51], v[80:83], v[132:147]
    ds_read_b64_tr_b16 v[64:65], v25 offset:40960
    ds_read_b64_tr_b16 v[66:67], v25 offset:41984
    v_mfma_f32_16x16x32_bf16 v[40:43], v[36:39], v[68:71], v[40:43]
    s_waitcnt lgkmcnt(6)
    v_mfma_f32_32x32x16_bf16 v[84:99], v[44:47], v[52:55], v[84:99]
    ds_read_b128 v[48:51], v17 offset:32768
    ds_read_b64_tr_b16 v[68:69], v22 offset:45056
    ds_read_b64_tr_b16 v[70:71], v22 offset:46080
    s_waitcnt lgkmcnt(7)
    v_mfma_f32_32x32x16_bf16 v[100:115], v[44:47], v[56:59], v[100:115]
    ds_read_b64_tr_b16 v[72:73], v23 offset:45056
    ds_read_b64_tr_b16 v[74:75], v23 offset:46080
    s_waitcnt lgkmcnt(7)
    v_mfma_f32_32x32x16_bf16 v[116:131], v[44:47], v[60:63], v[116:131]
    ds_read_b64_tr_b16 v[76:77], v24 offset:45056
    ds_read_b64_tr_b16 v[78:79], v24 offset:46080
    s_waitcnt lgkmcnt(7)
    v_mfma_f32_32x32x16_bf16 v[132:147], v[44:47], v[64:67], v[132:147]
    ds_read_b64_tr_b16 v[80:81], v25 offset:45056
    ds_read_b64_tr_b16 v[82:83], v25 offset:46080
    v_mfma_f32_16x16x32_bf16 v[40:43], v[36:39], v[52:55], v[40:43]
    s_waitcnt lgkmcnt(6)
    v_mfma_f32_32x32x16_bf16 v[84:99], v[48:51], v[68:71], v[84:99]
    s_waitcnt lgkmcnt(0)
    s_barrier
    ds_read_b128 v[44:47], v18 offset:0
    ds_read_b64_tr_b16 v[52:53], v26 offset:0
    ds_read_b64_tr_b16 v[54:55], v26 offset:1024
    v_mfma_f32_32x32x16_bf16 v[100:115], v[48:51], v[72:75], v[100:115]
    ds_read_b64_tr_b16 v[56:57], v27 offset:0
    ds_read_b64_tr_b16 v[58:59], v27 offset:1024
    v_mfma_f32_32x32x16_bf16 v[116:131], v[48:51], v[76:79], v[116:131]
    ds_read_b64_tr_b16 v[60:61], v28 offset:0
    ds_read_b64_tr_b16 v[62:63], v28 offset:1024
    v_mfma_f32_32x32x16_bf16 v[132:147], v[48:51], v[80:83], v[132:147]
    ds_read_b64_tr_b16 v[64:65], v29 offset:0
    ds_read_b64_tr_b16 v[66:67], v29 offset:1024
    v_mfma_f32_16x16x32_bf16 v[40:43], v[36:39], v[68:71], v[40:43]
    s_waitcnt lgkmcnt(6)
    v_mfma_f32_32x32x16_bf16 v[84:99], v[44:47], v[52:55], v[84:99]
    ds_read_b128 v[48:51], v19 offset:0
    ds_read_b64_tr_b16 v[68:69], v26 offset:4096
    ds_read_b64_tr_b16 v[70:71], v26 offset:5120
    s_waitcnt lgkmcnt(7)
    v_mfma_f32_32x32x16_bf16 v[100:115], v[44:47], v[56:59], v[100:115]
    ds_read_b64_tr_b16 v[72:73], v27 offset:4096
    ds_read_b64_tr_b16 v[74:75], v27 offset:5120
    s_waitcnt lgkmcnt(7)
    v_mfma_f32_32x32x16_bf16 v[116:131], v[44:47], v[60:63], v[116:131]
    ds_read_b64_tr_b16 v[76:77], v28 offset:4096
    ds_read_b64_tr_b16 v[78:79], v28 offset:5120
    s_waitcnt lgkmcnt(7)
    v_mfma_f32_32x32x16_bf16 v[132:147], v[44:47], v[64:67], v[132:147]
    ds_read_b64_tr_b16 v[80:81], v29 offset:4096
    ds_read_b64_tr_b16 v[82:83], v29 offset:5120
    v_mfma_f32_16x16x32_bf16 v[40:43], v[36:39], v[52:55], v[40:43]
    s_waitcnt lgkmcnt(6)
    v_mfma_f32_32x32x16_bf16 v[84:99], v[48:51], v[68:71], v[84:99]
    ds_read_b128 v[44:47], v20 offset:0
    ds_read_b64_tr_b16 v[52:53], v26 offset:8192
    ds_read_b64_tr_b16 v[54:55], v26 offset:9216
    s_waitcnt lgkmcnt(7)
    v_mfma_f32_32x32x16_bf16 v[100:115], v[48:51], v[72:75], v[100:115]
    ds_read_b64_tr_b16 v[56:57], v27 offset:8192
    ds_read_b64_tr_b16 v[58:59], v27 offset:9216
    s_waitcnt lgkmcnt(7)
    v_mfma_f32_32x32x16_bf16 v[116:131], v[48:51], v[76:79], v[116:131]
    ds_read_b64_tr_b16 v[60:61], v28 offset:8192
    ds_read_b64_tr_b16 v[62:63], v28 offset:9216
    s_waitcnt lgkmcnt(7)
    v_mfma_f32_32x32x16_bf16 v[132:147], v[48:51], v[80:83], v[132:147]
    ds_read_b64_tr_b16 v[64:65], v29 offset:8192
    ds_read_b64_tr_b16 v[66:67], v29 offset:9216
    v_mfma_f32_16x16x32_bf16 v[40:43], v[36:39], v[68:71], v[40:43]
    s_waitcnt lgkmcnt(6)
    v_mfma_f32_32x32x16_bf16 v[84:99], v[44:47], v[52:55], v[84:99]
    ds_read_b128 v[48:51], v21 offset:0
    ds_read_b64_tr_b16 v[68:69], v26 offset:12288
    ds_read_b64_tr_b16 v[70:71], v26 offset:13312
    s_waitcnt lgkmcnt(7)
    v_mfma_f32_32x32x16_bf16 v[100:115], v[44:47], v[56:59], v[100:115]
    ds_read_b64_tr_b16 v[72:73], v27 offset:12288
    ds_read_b64_tr_b16 v[74:75], v27 offset:13312
    s_waitcnt lgkmcnt(7)
    v_mfma_f32_32x32x16_bf16 v[116:131], v[44:47], v[60:63], v[116:131]
    ds_read_b64_tr_b16 v[76:77], v28 offset:12288
    ds_read_b64_tr_b16 v[78:79], v28 offset:13312
    s_waitcnt lgkmcnt(7)
    v_mfma_f32_32x32x16_bf16 v[132:147], v[44:47], v[64:67], v[132:147]
    ds_read_b64_tr_b16 v[80:81], v29 offset:12288
    ds_read_b64_tr_b16 v[82:83], v29 offset:13312
    v_mfma_f32_16x16x32_bf16 v[40:43], v[36:39], v[52:55], v[40:43]
    s_waitcnt lgkmcnt(6)
    v_mfma_f32_32x32x16_bf16 v[84:99], v[48:51], v[68:71], v[84:99]
    s_waitcnt lgkmcnt(0)
    s_barrier
    ds_read_b128 v[44:47], v18 offset:32768
    ds_read_b64_tr_b16 v[52:53], v26 offset:32768
    ds_read_b64_tr_b16 v[54:55], v26 offset:33792
    v_mfma_f32_32x32x16_bf16 v[100:115], v[48:51], v[72:75], v[100:115]
    ds_read_b64_tr_b16 v[56:57], v27 offset:32768
    ds_read_b64_tr_b16 v[58:59], v27 offset:33792
    v_mfma_f32_32x32x16_bf16 v[116:131], v[48:51], v[76:79], v[116:131]
    ds_read_b64_tr_b16 v[60:61], v28 offset:32768
    ds_read_b64_tr_b16 v[62:63], v28 offset:33792
    v_mfma_f32_32x32x16_bf16 v[132:147], v[48:51], v[80:83], v[132:147]
    ds_read_b64_tr_b16 v[64:65], v29 offset:32768
    ds_read_b64_tr_b16 v[66:67], v29 offset:33792
    v_mfma_f32_16x16x32_bf16 v[40:43], v[36:39], v[68:71], v[40:43]
    s_waitcnt lgkmcnt(6)
    v_mfma_f32_32x32x16_bf16 v[84:99], v[44:47], v[52:55], v[84:99]
    ds_read_b128 v[48:51], v19 offset:32768
    ds_read_b64_tr_b16 v[68:69], v26 offset:36864
    ds_read_b64_tr_b16 v[70:71], v26 offset:37888
    s_waitcnt lgkmcnt(7)
    v_mfma_f32_32x32x16_bf16 v[100:115], v[44:47], v[56:59], v[100:115]
    ds_read_b64_tr_b16 v[72:73], v27 offset:36864
    ds_read_b64_tr_b16 v[74:75], v27 offset:37888
    s_waitcnt lgkmcnt(7)
    v_mfma_f32_32x32x16_bf16 v[116:131], v[44:47], v[60:63], v[116:131]
    ds_read_b64_tr_b16 v[76:77], v28 offset:36864
    ds_read_b64_tr_b16 v[78:79], v28 offset:37888
    s_waitcnt lgkmcnt(7)
    v_mfma_f32_32x32x16_bf16 v[132:147], v[44:47], v[64:67], v[132:147]
    ds_read_b64_tr_b16 v[80:81], v29 offset:36864
    ds_read_b64_tr_b16 v[82:83], v29 offset:37888
    v_mfma_f32_16x16x32_bf16 v[40:43], v[36:39], v[52:55], v[40:43]
    s_waitcnt lgkmcnt(6)
    v_mfma_f32_32x32x16_bf16 v[84:99], v[48:51], v[68:71], v[84:99]
    ds_read_b128 v[44:47], v20 offset:32768
    ds_read_b64_tr_b16 v[52:53], v26 offset:40960
    ds_read_b64_tr_b16 v[54:55], v26 offset:41984
    s_waitcnt lgkmcnt(7)
    v_mfma_f32_32x32x16_bf16 v[100:115], v[48:51], v[72:75], v[100:115]
    ds_read_b64_tr_b16 v[56:57], v27 offset:40960
    ds_read_b64_tr_b16 v[58:59], v27 offset:41984
    s_waitcnt lgkmcnt(7)
    v_mfma_f32_32x32x16_bf16 v[116:131], v[48:51], v[76:79], v[116:131]
    ds_read_b64_tr_b16 v[60:61], v28 offset:40960
    ds_read_b64_tr_b16 v[62:63], v28 offset:41984
    s_waitcnt lgkmcnt(7)
    v_mfma_f32_32x32x16_bf16 v[132:147], v[48:51], v[80:83], v[132:147]
    ds_read_b64_tr_b16 v[64:65], v29 offset:40960
    ds_read_b64_tr_b16 v[66:67], v29 offset:41984
    v_mfma_f32_16x16x32_bf16 v[40:43], v[36:39], v[68:71], v[40:43]
    s_waitcnt lgkmcnt(6)
    v_mfma_f32_32x32x16_bf16 v[84:99], v[44:47], v[52:55], v[84:99]
    ds_read_b128 v[48:51], v21 offset:32768
    ds_read_b64_tr_b16 v[68:69], v26 offset:45056
    ds_read_b64_tr_b16 v[70:71], v26 offset:46080
    s_waitcnt lgkmcnt(7)
    v_mfma_f32_32x32x16_bf16 v[100:115], v[44:47], v[56:59], v[100:115]
    ds_read_b64_tr_b16 v[72:73], v27 offset:45056
    ds_read_b64_tr_b16 v[74:75], v27 offset:46080
    s_waitcnt lgkmcnt(7)
    v_mfma_f32_32x32x16_bf16 v[116:131], v[44:47], v[60:63], v[116:131]
    ds_read_b64_tr_b16 v[76:77], v28 offset:45056
    ds_read_b64_tr_b16 v[78:79], v28 offset:46080
    s_waitcnt lgkmcnt(7)
    v_mfma_f32_32x32x16_bf16 v[132:147], v[44:47], v[64:67], v[132:147]
    ds_read_b64_tr_b16 v[80:81], v29 offset:45056
    ds_read_b64_tr_b16 v[82:83], v29 offset:46080
    v_mfma_f32_16x16x32_bf16 v[40:43], v[36:39], v[52:55], v[40:43]
    s_waitcnt lgkmcnt(6)
    v_mfma_f32_32x32x16_bf16 v[84:99], v[48:51], v[68:71], v[84:99]
    s_waitcnt lgkmcnt(0)
    s_barrier
    ds_read_b128 v[44:47], v14 offset:0
    ds_read_b64_tr_b16 v[52:53], v22 offset:0
    ds_read_b64_tr_b16 v[54:55], v22 offset:1024
    v_mfma_f32_32x32x16_bf16 v[100:115], v[48:51], v[72:75], v[100:115]
    ds_read_b64_tr_b16 v[56:57], v23 offset:0
    ds_read_b64_tr_b16 v[58:59], v23 offset:1024
    v_mfma_f32_32x32x16_bf16 v[116:131], v[48:51], v[76:79], v[116:131]
    ds_read_b64_tr_b16 v[60:61], v24 offset:0
    ds_read_b64_tr_b16 v[62:63], v24 offset:1024
    v_mfma_f32_32x32x16_bf16 v[132:147], v[48:51], v[80:83], v[132:147]
    ds_read_b64_tr_b16 v[64:65], v25 offset:0
    ds_read_b64_tr_b16 v[66:67], v25 offset:1024
    v_mfma_f32_16x16x32_bf16 v[40:43], v[36:39], v[68:71], v[40:43]
    s_waitcnt lgkmcnt(6)
    v_mfma_f32_32x32x16_bf16 v[84:99], v[44:47], v[52:55], v[84:99]
    ds_read_b128 v[48:51], v15 offset:0
    ds_read_b64_tr_b16 v[68:69], v22 offset:4096
    ds_read_b64_tr_b16 v[70:71], v22 offset:5120
    s_waitcnt lgkmcnt(7)
    v_mfma_f32_32x32x16_bf16 v[100:115], v[44:47], v[56:59], v[100:115]
    ds_read_b64_tr_b16 v[72:73], v23 offset:4096
    ds_read_b64_tr_b16 v[74:75], v23 offset:5120
    s_waitcnt lgkmcnt(7)
    v_mfma_f32_32x32x16_bf16 v[116:131], v[44:47], v[60:63], v[116:131]
    ds_read_b64_tr_b16 v[76:77], v24 offset:4096
    ds_read_b64_tr_b16 v[78:79], v24 offset:5120
    s_waitcnt lgkmcnt(7)
    v_mfma_f32_32x32x16_bf16 v[132:147], v[44:47], v[64:67], v[132:147]
    ds_read_b64_tr_b16 v[80:81], v25 offset:4096
    ds_read_b64_tr_b16 v[82:83], v25 offset:5120
    v_mfma_f32_16x16x32_bf16 v[40:43], v[36:39], v[52:55], v[40:43]
    s_waitcnt lgkmcnt(6)
    v_mfma_f32_32x32x16_bf16 v[84:99], v[48:51], v[68:71], v[84:99]
    ds_read_b128 v[44:47], v16 offset:0
    ds_read_b64_tr_b16 v[52:53], v22 offset:8192
    ds_read_b64_tr_b16 v[54:55], v22 offset:9216
    s_waitcnt lgkmcnt(7)
    v_mfma_f32_32x32x16_bf16 v[100:115], v[48:51], v[72:75], v[100:115]
    ds_read_b64_tr_b16 v[56:57], v23 offset:8192
    ds_read_b64_tr_b16 v[58:59], v23 offset:9216
    s_waitcnt lgkmcnt(7)
    v_mfma_f32_32x32x16_bf16 v[116:131], v[48:51], v[76:79], v[116:131]
    ds_read_b64_tr_b16 v[60:61], v24 offset:8192
    ds_read_b64_tr_b16 v[62:63], v24 offset:9216
    s_waitcnt lgkmcnt(7)
    v_mfma_f32_32x32x16_bf16 v[132:147], v[48:51], v[80:83], v[132:147]
    ds_read_b64_tr_b16 v[64:65], v25 offset:8192
    ds_read_b64_tr_b16 v[66:67], v25 offset:9216
    v_mfma_f32_16x16x32_bf16 v[40:43], v[36:39], v[68:71], v[40:43]
    s_waitcnt lgkmcnt(6)
    v_mfma_f32_32x32x16_bf16 v[84:99], v[44:47], v[52:55], v[84:99]
    ds_read_b128 v[48:51], v17 offset:0
    ds_read_b64_tr_b16 v[68:69], v22 offset:12288
    ds_read_b64_tr_b16 v[70:71], v22 offset:13312
    s_waitcnt lgkmcnt(7)
    v_mfma_f32_32x32x16_bf16 v[100:115], v[44:47], v[56:59], v[100:115]
    ds_read_b64_tr_b16 v[72:73], v23 offset:12288
    ds_read_b64_tr_b16 v[74:75], v23 offset:13312
    s_waitcnt lgkmcnt(7)
    v_mfma_f32_32x32x16_bf16 v[116:131], v[44:47], v[60:63], v[116:131]
    ds_read_b64_tr_b16 v[76:77], v24 offset:12288
    ds_read_b64_tr_b16 v[78:79], v24 offset:13312
    s_waitcnt lgkmcnt(7)
    v_mfma_f32_32x32x16_bf16 v[132:147], v[44:47], v[64:67], v[132:147]
    ds_read_b64_tr_b16 v[80:81], v25 offset:12288
    ds_read_b64_tr_b16 v[82:83], v25 offset:13312
    v_mfma_f32_16x16x32_bf16 v[40:43], v[36:39], v[52:55], v[40:43]
    s_waitcnt lgkmcnt(6)
    v_mfma_f32_32x32x16_bf16 v[84:99], v[48:51], v[68:71], v[84:99]
    s_waitcnt lgkmcnt(0)
    s_barrier
    ds_read_b128 v[44:47], v14 offset:32768
    ds_read_b64_tr_b16 v[52:53], v22 offset:32768
    ds_read_b64_tr_b16 v[54:55], v22 offset:33792
    v_mfma_f32_32x32x16_bf16 v[100:115], v[48:51], v[72:75], v[100:115]
    ds_read_b64_tr_b16 v[56:57], v23 offset:32768
    ds_read_b64_tr_b16 v[58:59], v23 offset:33792
    v_mfma_f32_32x32x16_bf16 v[116:131], v[48:51], v[76:79], v[116:131]
    ds_read_b64_tr_b16 v[60:61], v24 offset:32768
    ds_read_b64_tr_b16 v[62:63], v24 offset:33792
    v_mfma_f32_32x32x16_bf16 v[132:147], v[48:51], v[80:83], v[132:147]
    ds_read_b64_tr_b16 v[64:65], v25 offset:32768
    ds_read_b64_tr_b16 v[66:67], v25 offset:33792
    v_mfma_f32_16x16x32_bf16 v[40:43], v[36:39], v[68:71], v[40:43]
    s_waitcnt lgkmcnt(6)
    v_mfma_f32_32x32x16_bf16 v[84:99], v[44:47], v[52:55], v[84:99]
    ds_read_b128 v[48:51], v15 offset:32768
    ds_read_b64_tr_b16 v[68:69], v22 offset:36864
    ds_read_b64_tr_b16 v[70:71], v22 offset:37888
    s_waitcnt lgkmcnt(7)
    v_mfma_f32_32x32x16_bf16 v[100:115], v[44:47], v[56:59], v[100:115]
    ds_read_b64_tr_b16 v[72:73], v23 offset:36864
    ds_read_b64_tr_b16 v[74:75], v23 offset:37888
    s_waitcnt lgkmcnt(7)
    v_mfma_f32_32x32x16_bf16 v[116:131], v[44:47], v[60:63], v[116:131]
    ds_read_b64_tr_b16 v[76:77], v24 offset:36864
    ds_read_b64_tr_b16 v[78:79], v24 offset:37888
    s_waitcnt lgkmcnt(7)
    v_mfma_f32_32x32x16_bf16 v[132:147], v[44:47], v[64:67], v[132:147]
    ds_read_b64_tr_b16 v[80:81], v25 offset:36864
    ds_read_b64_tr_b16 v[82:83], v25 offset:37888
    v_mfma_f32_16x16x32_bf16 v[40:43], v[36:39], v[52:55], v[40:43]
    s_waitcnt lgkmcnt(6)
    v_mfma_f32_32x32x16_bf16 v[84:99], v[48:51], v[68:71], v[84:99]
    ds_read_b128 v[44:47], v16 offset:32768
    ds_read_b64_tr_b16 v[52:53], v22 offset:40960
    ds_read_b64_tr_b16 v[54:55], v22 offset:41984
    s_waitcnt lgkmcnt(7)
    v_mfma_f32_32x32x16_bf16 v[100:115], v[48:51], v[72:75], v[100:115]
    ds_read_b64_tr_b16 v[56:57], v23 offset:40960
    ds_read_b64_tr_b16 v[58:59], v23 offset:41984
    s_waitcnt lgkmcnt(7)
    v_mfma_f32_32x32x16_bf16 v[116:131], v[48:51], v[76:79], v[116:131]
    ds_read_b64_tr_b16 v[60:61], v24 offset:40960
    ds_read_b64_tr_b16 v[62:63], v24 offset:41984
    s_waitcnt lgkmcnt(7)
    v_mfma_f32_32x32x16_bf16 v[132:147], v[48:51], v[80:83], v[132:147]
    ds_read_b64_tr_b16 v[64:65], v25 offset:40960
    ds_read_b64_tr_b16 v[66:67], v25 offset:41984
    v_mfma_f32_16x16x32_bf16 v[40:43], v[36:39], v[68:71], v[40:43]
    s_waitcnt lgkmcnt(6)
    v_mfma_f32_32x32x16_bf16 v[84:99], v[44:47], v[52:55], v[84:99]
    ds_read_b128 v[48:51], v17 offset:32768
    ds_read_b64_tr_b16 v[68:69], v22 offset:45056
    ds_read_b64_tr_b16 v[70:71], v22 offset:46080
    s_waitcnt lgkmcnt(7)
    v_mfma_f32_32x32x16_bf16 v[100:115], v[44:47], v[56:59], v[100:115]
    ds_read_b64_tr_b16 v[72:73], v23 offset:45056
    ds_read_b64_tr_b16 v[74:75], v23 offset:46080
    s_waitcnt lgkmcnt(7)
    v_mfma_f32_32x32x16_bf16 v[116:131], v[44:47], v[60:63], v[116:131]
    ds_read_b64_tr_b16 v[76:77], v24 offset:45056
    ds_read_b64_tr_b16 v[78:79], v24 offset:46080
    s_waitcnt lgkmcnt(7)
    v_mfma_f32_32x32x16_bf16 v[132:147], v[44:47], v[64:67], v[132:147]
    ds_read_b64_tr_b16 v[80:81], v25 offset:45056
    ds_read_b64_tr_b16 v[82:83], v25 offset:46080
    v_mfma_f32_16x16x32_bf16 v[40:43], v[36:39], v[52:55], v[40:43]
    s_waitcnt lgkmcnt(6)
    v_mfma_f32_32x32x16_bf16 v[84:99], v[48:51], v[68:71], v[84:99]
    s_waitcnt lgkmcnt(4)
    v_mfma_f32_32x32x16_bf16 v[100:115], v[48:51], v[72:75], v[100:115]
    s_waitcnt lgkmcnt(2)
    v_mfma_f32_32x32x16_bf16 v[116:131], v[48:51], v[76:79], v[116:131]
    s_waitcnt lgkmcnt(0)
    v_mfma_f32_32x32x16_bf16 v[132:147], v[48:51], v[80:83], v[132:147]
    v_mfma_f32_16x16x32_bf16 v[40:43], v[36:39], v[68:71], v[40:43]
    s_lshl_b32 s33, s34, 7
    s_add_u32 s33, s33, 131072
    v_add_u32 v6, s33, v12
    s_mov_b64 exec, 0xffff
    s_nop 3
    ds_write2_b32 v6, v40, v41 offset0:0 offset1:16
    s_mov_b64 exec, -1
    s_lshl_b32 s41, s34, 8
    s_add_u32 s41, s41, 132096
    s_waitcnt lgkmcnt(0)
    s_barrier
    v_lshl_add_u32 v6, v3, 4, s41
    ds_read_b128 v[52:55], v6 offset:0
    ds_read_b128 v[68:71], v6 offset:128
    ds_read_b128 v[56:59], v6 offset:32
    ds_read_b128 v[72:75], v6 offset:160
    ds_read_b128 v[60:63], v6 offset:64
    ds_read_b128 v[76:79], v6 offset:192
    ds_read_b128 v[64:67], v6 offset:96
    ds_read_b128 v[80:83], v6 offset:224
    s_add_u32 s33, s34, 0
    s_and_b32 s33, s33, 3
    s_lshl_b32 s33, s33, 7
    s_add_u32 s33, s33, 131072
    v_lshl_add_u32 v7, v2, 2, s33
    ds_read_b32 v4, v7
    s_add_u32 s33, s34, 1
    s_and_b32 s33, s33, 3
    s_lshl_b32 s33, s33, 7
    s_add_u32 s33, s33, 131072
    v_lshl_add_u32 v7, v2, 2, s33
    ds_read_b32 v5, v7
    s_add_u32 s33, s34, 2
    s_and_b32 s33, s33, 3
    s_lshl_b32 s33, s33, 7
    s_add_u32 s33, s33, 131072
    v_lshl_add_u32 v7, v2, 2, s33
    ds_read_b32 v8, v7
    s_add_u32 s33, s34, 3
    s_and_b32 s33, s33, 3
    s_lshl_b32 s33, s33, 7
    s_add_u32 s33, s33, 131072
    v_lshl_add_u32 v7, v2, 2, s33
    ds_read_b32 v9, v7
    s_waitcnt lgkmcnt(0)
    v_fma_f32 v84, -v52, v4, v84
    v_fma_f32 v85, -v53, v4, v85
    v_fma_f32 v86, -v54, v4, v86
    v_fma_f32 v87, -v55, v4, v87
    v_fma_f32 v88, -v56, v4, v88
    v_fma_f32 v89, -v57, v4, v89
    v_fma_f32 v90, -v58, v4, v90
    v_fma_f32 v91, -v59, v4, v91
    v_fma_f32 v92, -v60, v4, v92
    v_fma_f32 v93, -v61, v4, v93
    v_fma_f32 v94, -v62, v4, v94
    v_fma_f32 v95, -v63, v4, v95
    v_fma_f32 v96, -v64, v4, v96
    v_fma_f32 v97, -v65, v4, v97
    v_fma_f32 v98, -v66, v4, v98
    v_fma_f32 v99, -v67, v4, v99
    v_mul_f32 v84, v68, v84
    v_mul_f32 v85, v69, v85
    v_mul_f32 v86, v70, v86
    v_mul_f32 v87, v71, v87
    v_mul_f32 v88, v72, v88
    v_mul_f32 v89, v73, v89
    v_mul_f32 v90, v74, v90
    v_mul_f32 v91, v75, v91
    v_mul_f32 v92, v76, v92
    v_mul_f32 v93, v77, v93
    v_mul_f32 v94, v78, v94
    v_mul_f32 v95, v79, v95
    v_mul_f32 v96, v80, v96
    v_mul_f32 v97, v81, v97
    v_mul_f32 v98, v82, v98
    v_mul_f32 v99, v83, v99
    v_cvt_pk_bf16_f32 v84, v84, v85
    v_cvt_pk_bf16_f32 v85, v86, v87
    v_cvt_pk_bf16_f32 v86, v88, v89
    v_cvt_pk_bf16_f32 v87, v90, v91
    v_cvt_pk_bf16_f32 v88, v92, v93
    v_cvt_pk_bf16_f32 v89, v94, v95
    v_cvt_pk_bf16_f32 v90, v96, v97
    v_cvt_pk_bf16_f32 v91, v98, v99
    buffer_store_dwordx4 v[84:87], v30, s[44:47], s42 offen sc1
    buffer_store_dwordx4 v[88:91], v30, s[44:47], s42 offen offset:640 sc1
    v_fma_f32 v100, -v52, v5, v100
    v_fma_f32 v101, -v53, v5, v101
    v_fma_f32 v102, -v54, v5, v102
    v_fma_f32 v103, -v55, v5, v103
    v_fma_f32 v104, -v56, v5, v104
    v_fma_f32 v105, -v57, v5, v105
    v_fma_f32 v106, -v58, v5, v106
    v_fma_f32 v107, -v59, v5, v107
    v_fma_f32 v108, -v60, v5, v108
    v_fma_f32 v109, -v61, v5, v109
    v_fma_f32 v110, -v62, v5, v110
    v_fma_f32 v111, -v63, v5, v111
    v_fma_f32 v112, -v64, v5, v112
    v_fma_f32 v113, -v65, v5, v113
    v_fma_f32 v114, -v66, v5, v114
    v_fma_f32 v115, -v67, v5, v115
    v_mul_f32 v100, v68, v100
    v_mul_f32 v101, v69, v101
    v_mul_f32 v102, v70, v102
    v_mul_f32 v103, v71, v103
    v_mul_f32 v104, v72, v104
    v_mul_f32 v105, v73, v105
    v_mul_f32 v106, v74, v106
    v_mul_f32 v107, v75, v107
    v_mul_f32 v108, v76, v108
    v_mul_f32 v109, v77, v109
    v_mul_f32 v110, v78, v110
    v_mul_f32 v111, v79, v111
    v_mul_f32 v112, v80, v112
    v_mul_f32 v113, v81, v113
    v_mul_f32 v114, v82, v114
    v_mul_f32 v115, v83, v115
    v_cvt_pk_bf16_f32 v100, v100, v101
    v_cvt_pk_bf16_f32 v101, v102, v103
    v_cvt_pk_bf16_f32 v102, v104, v105
    v_cvt_pk_bf16_f32 v103, v106, v107
    v_cvt_pk_bf16_f32 v104, v108, v109
    v_cvt_pk_bf16_f32 v105, v110, v111
    v_cvt_pk_bf16_f32 v106, v112, v113
    v_cvt_pk_bf16_f32 v107, v114, v115
    buffer_store_dwordx4 v[100:103], v31, s[44:47], s42 offen sc1
    buffer_store_dwordx4 v[104:107], v31, s[44:47], s42 offen offset:640 sc1
    v_fma_f32 v116, -v52, v8, v116
    v_fma_f32 v117, -v53, v8, v117
    v_fma_f32 v118, -v54, v8, v118
    v_fma_f32 v119, -v55, v8, v119
    v_fma_f32 v120, -v56, v8, v120
    v_fma_f32 v121, -v57, v8, v121
    v_fma_f32 v122, -v58, v8, v122
    v_fma_f32 v123, -v59, v8, v123
    v_fma_f32 v124, -v60, v8, v124
    v_fma_f32 v125, -v61, v8, v125
    v_fma_f32 v126, -v62, v8, v126
    v_fma_f32 v127, -v63, v8, v127
    v_fma_f32 v128, -v64, v8, v128
    v_fma_f32 v129, -v65, v8, v129
    v_fma_f32 v130, -v66, v8, v130
    v_fma_f32 v131, -v67, v8, v131
    v_mul_f32 v116, v68, v116
    v_mul_f32 v117, v69, v117
    v_mul_f32 v118, v70, v118
    v_mul_f32 v119, v71, v119
    v_mul_f32 v120, v72, v120
    v_mul_f32 v121, v73, v121
    v_mul_f32 v122, v74, v122
    v_mul_f32 v123, v75, v123
    v_mul_f32 v124, v76, v124
    v_mul_f32 v125, v77, v125
    v_mul_f32 v126, v78, v126
    v_mul_f32 v127, v79, v127
    v_mul_f32 v128, v80, v128
    v_mul_f32 v129, v81, v129
    v_mul_f32 v130, v82, v130
    v_mul_f32 v131, v83, v131
    v_cvt_pk_bf16_f32 v116, v116, v117
    v_cvt_pk_bf16_f32 v117, v118, v119
    v_cvt_pk_bf16_f32 v118, v120, v121
    v_cvt_pk_bf16_f32 v119, v122, v123
    v_cvt_pk_bf16_f32 v120, v124, v125
    v_cvt_pk_bf16_f32 v121, v126, v127
    v_cvt_pk_bf16_f32 v122, v128, v129
    v_cvt_pk_bf16_f32 v123, v130, v131
    buffer_store_dwordx4 v[116:119], v32, s[44:47], s42 offen sc1
    buffer_store_dwordx4 v[120:123], v32, s[44:47], s42 offen offset:640 sc1
    v_fma_f32 v132, -v52, v9, v132
    v_fma_f32 v133, -v53, v9, v133
    v_fma_f32 v134, -v54, v9, v134
    v_fma_f32 v135, -v55, v9, v135
    v_fma_f32 v136, -v56, v9, v136
    v_fma_f32 v137, -v57, v9, v137
    v_fma_f32 v138, -v58, v9, v138
    v_fma_f32 v139, -v59, v9, v139
    v_fma_f32 v140, -v60, v9, v140
    v_fma_f32 v141, -v61, v9, v141
    v_fma_f32 v142, -v62, v9, v142
    v_fma_f32 v143, -v63, v9, v143
    v_fma_f32 v144, -v64, v9, v144
    v_fma_f32 v145, -v65, v9, v145
    v_fma_f32 v146, -v66, v9, v146
    v_fma_f32 v147, -v67, v9, v147
    v_mul_f32 v132, v68, v132
    v_mul_f32 v133, v69, v133
    v_mul_f32 v134, v70, v134
    v_mul_f32 v135, v71, v135
    v_mul_f32 v136, v72, v136
    v_mul_f32 v137, v73, v137
    v_mul_f32 v138, v74, v138
    v_mul_f32 v139, v75, v139
    v_mul_f32 v140, v76, v140
    v_mul_f32 v141, v77, v141
    v_mul_f32 v142, v78, v142
    v_mul_f32 v143, v79, v143
    v_mul_f32 v144, v80, v144
    v_mul_f32 v145, v81, v145
    v_mul_f32 v146, v82, v146
    v_mul_f32 v147, v83, v147
    v_cvt_pk_bf16_f32 v132, v132, v133
    v_cvt_pk_bf16_f32 v133, v134, v135
    v_cvt_pk_bf16_f32 v134, v136, v137
    v_cvt_pk_bf16_f32 v135, v138, v139
    v_cvt_pk_bf16_f32 v136, v140, v141
    v_cvt_pk_bf16_f32 v137, v142, v143
    v_cvt_pk_bf16_f32 v138, v144, v145
    v_cvt_pk_bf16_f32 v139, v146, v147
    buffer_store_dwordx4 v[132:135], v33, s[44:47], s42 offen sc1
    buffer_store_dwordx4 v[136:139], v33, s[44:47], s42 offen offset:640 sc1
    s_nop 2
sequential_preLN__sliding_block__geglu_ffn__prompt_kernel_p1j10:
    s_waitcnt vmcnt(0)
    s_barrier
    s_branch sequential_preLN__sliding_block__geglu_ffn__prompt_kernel_p1_join8
    s_nop 0
sequential_preLN__sliding_block__geglu_ffn__prompt_kernel_p1_r6:
    s_lshl_b32 s38, s35, 7
    s_lshl_b32 s33, s34, 5
    s_add_u32 s38, s38, s33
    s_mul_i32 s38, s38, 1280
    s_mul_i32 s39, s34, 61440
    s_lshl_b32 s33, s36, 8
    s_add_u32 s39, s39, s33
    v_lshrrev_b32 v4, 3, v1
    v_lshrrev_b32 v5, 4, v1
    v_and_b32 v6, 7, v1
    v_mul_u32_u24 v4, 1280, v4
    v_xor_b32 v7, v6, v5
    v_lshl_add_u32 v14, v7, 4, v4
    v_xor_b32 v7, 4, v7
    v_lshl_add_u32 v15, v7, 4, v4
    v_and_b32 v6, 15, v1
    v_lshlrev_b32 v7, 2, v5
    v_xor_b32 v7, v6, v7
    v_mul_u32_u24 v4, 3840, v5
    v_lshl_add_u32 v16, v7, 4, v4
    s_mov_b32 s44, s4
    s_and_b32 s45, s5, 0xffff
    s_mov_b32 s46, 0x280000
    s_mov_b32 s47, 0x20000
    s_mov_b32 s48, s6
    s_and_b32 s49, s7, 0xffff
    s_mov_b32 s50, 0x258000
    s_mov_b32 s51, 0x20000
    s_add_u32 m0, s37, 0
    s_add_u32 s33, s38, 0
    buffer_load_dwordx4 v14, s[44:47], s33 offen lds
    s_add_u32 m0, s37, 16384
    s_add_u32 s33, s39, 0
    buffer_load_dwordx4 v16, s[48:51], s33 offen lds
    s_add_u32 m0, s37, 1024
    s_add_u32 s33, s38, 10240
    buffer_load_dwordx4 v15, s[44:47], s33 offen lds
    s_add_u32 m0, s37, 17408
    s_add_u32 s33, s39, 15360
    buffer_load_dwordx4 v16, s[48:51], s33 offen lds
    s_add_u32 m0, s37, 2048
    s_add_u32 s33, s38, 20480
    buffer_load_dwordx4 v14, s[44:47], s33 offen lds
    s_add_u32 m0, s37, 18432
    s_add_u32 s33, s39, 30720
    buffer_load_dwordx4 v16, s[48:51], s33 offen lds
    s_add_u32 m0, s37, 3072
    s_add_u32 s33, s38, 30720
    buffer_load_dwordx4 v15, s[44:47], s33 offen lds
    s_add_u32 m0, s37, 19456
    s_add_u32 s33, s39, 46080
    buffer_load_dwordx4 v16, s[48:51], s33 offen lds
    s_add_u32 m0, s37, 32768
    s_add_u32 s33, s38, 128
    buffer_load_dwordx4 v14, s[44:47], s33 offen lds
    s_add_u32 m0, s37, 49152
    s_add_u32 s33, s39, 245760
    buffer_load_dwordx4 v16, s[48:51], s33 offen lds
    s_add_u32 m0, s37, 33792
    s_add_u32 s33, s38, 10368
    buffer_load_dwordx4 v15, s[44:47], s33 offen lds
    s_add_u32 m0, s37, 50176
    s_add_u32 s33, s39, 261120
    buffer_load_dwordx4 v16, s[48:51], s33 offen lds
    s_add_u32 m0, s37, 34816
    s_add_u32 s33, s38, 20608
    buffer_load_dwordx4 v14, s[44:47], s33 offen lds
    s_add_u32 m0, s37, 51200
    s_add_u32 s33, s39, 276480
    buffer_load_dwordx4 v16, s[48:51], s33 offen lds
    s_add_u32 m0, s37, 35840
    s_add_u32 s33, s38, 30848
    buffer_load_dwordx4 v15, s[44:47], s33 offen lds
    s_add_u32 m0, s37, 52224
    s_add_u32 s33, s39, 291840
    buffer_load_dwordx4 v16, s[48:51], s33 offen lds
    s_waitcnt vmcnt(8)
    s_barrier
    s_add_u32 m0, s37, 65536
    s_add_u32 s33, s38, 256
    buffer_load_dwordx4 v14, s[44:47], s33 offen lds
    s_add_u32 m0, s37, 81920
    s_add_u32 s33, s39, 491520
    buffer_load_dwordx4 v16, s[48:51], s33 offen lds
    s_add_u32 m0, s37, 66560
    s_add_u32 s33, s38, 10496
    buffer_load_dwordx4 v15, s[44:47], s33 offen lds
    s_add_u32 m0, s37, 82944
    s_add_u32 s33, s39, 506880
    buffer_load_dwordx4 v16, s[48:51], s33 offen lds
    s_add_u32 m0, s37, 67584
    s_add_u32 s33, s38, 20736
    buffer_load_dwordx4 v14, s[44:47], s33 offen lds
    s_add_u32 m0, s37, 83968
    s_add_u32 s33, s39, 522240
    buffer_load_dwordx4 v16, s[48:51], s33 offen lds
    s_add_u32 m0, s37, 68608
    s_add_u32 s33, s38, 30976
    buffer_load_dwordx4 v15, s[44:47], s33 offen lds
    s_add_u32 m0, s37, 84992
    s_add_u32 s33, s39, 537600
    buffer_load_dwordx4 v16, s[48:51], s33 offen lds
    s_add_u32 m0, s37, 98304
    s_add_u32 s33, s38, 384
    buffer_load_dwordx4 v14, s[44:47], s33 offen lds
    s_add_u32 m0, s37, 114688
    s_add_u32 s33, s39, 737280
    buffer_load_dwordx4 v16, s[48:51], s33 offen lds
    s_add_u32 m0, s37, 99328
    s_add_u32 s33, s38, 10624
    buffer_load_dwordx4 v15, s[44:47], s33 offen lds
    s_add_u32 m0, s37, 115712
    s_add_u32 s33, s39, 752640
    buffer_load_dwordx4 v16, s[48:51], s33 offen lds
    s_add_u32 m0, s37, 100352
    s_add_u32 s33, s38, 20864
    buffer_load_dwordx4 v14, s[44:47], s33 offen lds
    s_add_u32 m0, s37, 116736
    s_add_u32 s33, s39, 768000
    buffer_load_dwordx4 v16, s[48:51], s33 offen lds
    s_add_u32 m0, s37, 101376
    s_add_u32 s33, s38, 31104
    buffer_load_dwordx4 v15, s[44:47], s33 offen lds
    s_add_u32 m0, s37, 117760
    s_add_u32 s33, s39, 783360
    buffer_load_dwordx4 v16, s[48:51], s33 offen lds
    s_waitcnt vmcnt(16)
    s_barrier
    s_add_u32 m0, s37, 0
    s_add_u32 s33, s38, 512
    buffer_load_dwordx4 v14, s[44:47], s33 offen lds
    s_add_u32 m0, s37, 16384
    s_add_u32 s33, s39, 983040
    buffer_load_dwordx4 v16, s[48:51], s33 offen lds
    s_add_u32 m0, s37, 1024
    s_add_u32 s33, s38, 10752
    buffer_load_dwordx4 v15, s[44:47], s33 offen lds
    s_add_u32 m0, s37, 17408
    s_add_u32 s33, s39, 998400
    buffer_load_dwordx4 v16, s[48:51], s33 offen lds
    s_add_u32 m0, s37, 2048
    s_add_u32 s33, s38, 20992
    buffer_load_dwordx4 v14, s[44:47], s33 offen lds
    s_add_u32 m0, s37, 18432
    s_add_u32 s33, s39, 1013760
    buffer_load_dwordx4 v16, s[48:51], s33 offen lds
    s_add_u32 m0, s37, 3072
    s_add_u32 s33, s38, 31232
    buffer_load_dwordx4 v15, s[44:47], s33 offen lds
    s_add_u32 m0, s37, 19456
    s_add_u32 s33, s39, 1029120
    buffer_load_dwordx4 v16, s[48:51], s33 offen lds
    s_waitcnt vmcnt(16)
    s_barrier
    s_add_u32 m0, s37, 32768
    s_add_u32 s33, s38, 640
    buffer_load_dwordx4 v14, s[44:47], s33 offen lds
    s_add_u32 m0, s37, 49152
    s_add_u32 s33, s39, 1228800
    buffer_load_dwordx4 v16, s[48:51], s33 offen lds
    s_add_u32 m0, s37, 33792
    s_add_u32 s33, s38, 10880
    buffer_load_dwordx4 v15, s[44:47], s33 offen lds
    s_add_u32 m0, s37, 50176
    s_add_u32 s33, s39, 1244160
    buffer_load_dwordx4 v16, s[48:51], s33 offen lds
    s_add_u32 m0, s37, 34816
    s_add_u32 s33, s38, 21120
    buffer_load_dwordx4 v14, s[44:47], s33 offen lds
    s_add_u32 m0, s37, 51200
    s_add_u32 s33, s39, 1259520
    buffer_load_dwordx4 v16, s[48:51], s33 offen lds
    s_add_u32 m0, s37, 35840
    s_add_u32 s33, s38, 31360
    buffer_load_dwordx4 v15, s[44:47], s33 offen lds
    s_add_u32 m0, s37, 52224
    s_add_u32 s33, s39, 1274880
    buffer_load_dwordx4 v16, s[48:51], s33 offen lds
    s_waitcnt vmcnt(16)
    s_barrier
    s_add_u32 m0, s37, 65536
    s_add_u32 s33, s38, 768
    buffer_load_dwordx4 v14, s[44:47], s33 offen lds
    s_add_u32 m0, s37, 81920
    s_add_u32 s33, s39, 1474560
    buffer_load_dwordx4 v16, s[48:51], s33 offen lds
    s_add_u32 m0, s37, 66560
    s_add_u32 s33, s38, 11008
    buffer_load_dwordx4 v15, s[44:47], s33 offen lds
    s_add_u32 m0, s37, 82944
    s_add_u32 s33, s39, 1489920
    buffer_load_dwordx4 v16, s[48:51], s33 offen lds
    s_add_u32 m0, s37, 67584
    s_add_u32 s33, s38, 21248
    buffer_load_dwordx4 v14, s[44:47], s33 offen lds
    s_add_u32 m0, s37, 83968
    s_add_u32 s33, s39, 1505280
    buffer_load_dwordx4 v16, s[48:51], s33 offen lds
    s_add_u32 m0, s37, 68608
    s_add_u32 s33, s38, 31488
    buffer_load_dwordx4 v15, s[44:47], s33 offen lds
    s_add_u32 m0, s37, 84992
    s_add_u32 s33, s39, 1520640
    buffer_load_dwordx4 v16, s[48:51], s33 offen lds
    s_waitcnt vmcnt(16)
    s_barrier
    s_add_u32 m0, s37, 98304
    s_add_u32 s33, s38, 896
    buffer_load_dwordx4 v14, s[44:47], s33 offen lds
    s_add_u32 m0, s37, 114688
    s_add_u32 s33, s39, 1720320
    buffer_load_dwordx4 v16, s[48:51], s33 offen lds
    s_add_u32 m0, s37, 99328
    s_add_u32 s33, s38, 11136
    buffer_load_dwordx4 v15, s[44:47], s33 offen lds
    s_add_u32 m0, s37, 115712
    s_add_u32 s33, s39, 1735680
    buffer_load_dwordx4 v16, s[48:51], s33 offen lds
    s_add_u32 m0, s37, 100352
    s_add_u32 s33, s38, 21376
    buffer_load_dwordx4 v14, s[44:47], s33 offen lds
    s_add_u32 m0, s37, 116736
    s_add_u32 s33, s39, 1751040
    buffer_load_dwordx4 v16, s[48:51], s33 offen lds
    s_add_u32 m0, s37, 101376
    s_add_u32 s33, s38, 31616
    buffer_load_dwordx4 v15, s[44:47], s33 offen lds
    s_add_u32 m0, s37, 117760
    s_add_u32 s33, s39, 1766400
    buffer_load_dwordx4 v16, s[48:51], s33 offen lds
    s_waitcnt vmcnt(16)
    s_barrier
    s_add_u32 m0, s37, 0
    s_add_u32 s33, s38, 1024
    buffer_load_dwordx4 v14, s[44:47], s33 offen lds
    s_add_u32 m0, s37, 16384
    s_add_u32 s33, s39, 1966080
    buffer_load_dwordx4 v16, s[48:51], s33 offen lds
    s_add_u32 m0, s37, 1024
    s_add_u32 s33, s38, 11264
    buffer_load_dwordx4 v15, s[44:47], s33 offen lds
    s_add_u32 m0, s37, 17408
    s_add_u32 s33, s39, 1981440
    buffer_load_dwordx4 v16, s[48:51], s33 offen lds
    s_add_u32 m0, s37, 2048
    s_add_u32 s33, s38, 21504
    buffer_load_dwordx4 v14, s[44:47], s33 offen lds
    s_add_u32 m0, s37, 18432
    s_add_u32 s33, s39, 1996800
    buffer_load_dwordx4 v16, s[48:51], s33 offen lds
    s_add_u32 m0, s37, 3072
    s_add_u32 s33, s38, 31744
    buffer_load_dwordx4 v15, s[44:47], s33 offen lds
    s_add_u32 m0, s37, 19456
    s_add_u32 s33, s39, 2012160
    buffer_load_dwordx4 v16, s[48:51], s33 offen lds
    s_waitcnt vmcnt(16)
    s_barrier
    s_add_u32 m0, s37, 32768
    s_add_u32 s33, s38, 1152
    buffer_load_dwordx4 v14, s[44:47], s33 offen lds
    s_add_u32 m0, s37, 49152
    s_add_u32 s33, s39, 2211840
    buffer_load_dwordx4 v16, s[48:51], s33 offen lds
    s_add_u32 m0, s37, 33792
    s_add_u32 s33, s38, 11392
    buffer_load_dwordx4 v15, s[44:47], s33 offen lds
    s_add_u32 m0, s37, 50176
    s_add_u32 s33, s39, 2227200
    buffer_load_dwordx4 v16, s[48:51], s33 offen lds
    s_add_u32 m0, s37, 34816
    s_add_u32 s33, s38, 21632
    buffer_load_dwordx4 v14, s[44:47], s33 offen lds
    s_add_u32 m0, s37, 51200
    s_add_u32 s33, s39, 2242560
    buffer_load_dwordx4 v16, s[48:51], s33 offen lds
    s_add_u32 m0, s37, 35840
    s_add_u32 s33, s38, 31872
    buffer_load_dwordx4 v15, s[44:47], s33 offen lds
    s_add_u32 m0, s37, 52224
    s_add_u32 s33, s39, 2257920
    buffer_load_dwordx4 v16, s[48:51], s33 offen lds
    s_waitcnt vmcnt(16)
    s_barrier
    s_waitcnt vmcnt(8)
    s_barrier
    s_waitcnt vmcnt(0)
    s_barrier
    s_barrier
    s_barrier
    s_branch sequential_preLN__sliding_block__geglu_ffn__prompt_kernel_p1_join8
    s_nop 0
sequential_preLN__sliding_block__geglu_ffn__prompt_kernel_p1_r7:
    s_add_u32 s38, s34, 1
    v_mul_u32_u24 v4, 1280, v1
    v_lshrrev_b32 v5, 4, v1
    v_mul_u32_u24 v5, 3840, v5
    v_and_b32 v6, 15, v1
    v_lshl_add_u32 v5, v6, 7, v5
    s_lshr_b32 s56, s25, 1
    s_lshl_b32 s56, s56, 3
    s_add_u32 s56, s56, s26
    s_mul_i32 s56, s56, 81920
    s_sub_u32 s57, s26, 8
    s_mul_i32 s57, s57, 15360
    s_and_b32 s33, s25, 1
    s_mul_i32 s33, s33, 1792
    s_add_u32 s57, s57, s33
    s_and_b32 s58, s5, 0xffff
    s_and_b32 s59, s7, 0xffff
    s_movk_i32 s33, 128
    s_mov_b32 s54, 2457600
    s_cmp_lt_u32 s26, 8
    s_cselect_b64 vcc, -1, 0
    s_cselect_b32 s56, s56, s57
    s_cselect_b32 s57, s33, 245760
    s_cselect_b32 s52, s4, s6
    s_cselect_b32 s53, s58, s59
    s_cselect_b32 s54, 2621440, s54
    s_cmp_lt_u32 s26, 24
    s_cselect_b32 s54, s54, 0
    s_mov_b32 s55, 0x20000
    v_cndmask_b32 v165, v5, v4, vcc
    s_mul_i32 s33, s57, s38
    s_add_u32 s33, s33, s56
    buffer_load_dword v166, v165, s[52:55], s33 offen
    v_add_u32 v14, s37, v13
    v_add_u32 v15, 65536, v14
    v_mov_b32 v16, 0
    v_mov_b32 v17, 0
    v_mov_b32 v18, 0
    v_mov_b32 v19, 0
    v_mov_b32 v20, 0
    v_mov_b32 v21, 0
    v_mov_b32 v22, 0
    v_mov_b32 v23, 0
    s_barrier
    ds_read_b128 v[32:35], v14 offset:0
    ds_read_b128 v[36:39], v14 offset:1024
    ds_read_b128 v[40:43], v14 offset:2048
    ds_read_b128 v[44:47], v14 offset:3072
    s_waitcnt lgkmcnt(3)
    v_lshlrev_b32 v24, 16, v32
    v_and_b32 v25, 0xffff0000, v32
    s_waitcnt lgkmcnt(2)
    v_lshlrev_b32 v26, 16, v36
    v_and_b32 v27, 0xffff0000, v36
    s_waitcnt lgkmcnt(1)
    v_lshlrev_b32 v28, 16, v40
    v_and_b32 v29, 0xffff0000, v40
    s_waitcnt lgkmcnt(0)
    v_lshlrev_b32 v30, 16, v44
    v_and_b32 v31, 0xffff0000, v44
    v_add_f32 v16, v16, v24
    v_fma_f32 v20, v24, v24, v20
    v_add_f32 v17, v17, v26
    v_fma_f32 v21, v26, v26, v21
    v_add_f32 v18, v18, v28
    v_fma_f32 v22, v28, v28, v22
    v_add_f32 v19, v19, v30
    v_fma_f32 v23, v30, v30, v23
    v_add_f32 v16, v16, v25
    v_fma_f32 v20, v25, v25, v20
    v_add_f32 v17, v17, v27
    v_fma_f32 v21, v27, v27, v21
    v_add_f32 v18, v18, v29
    v_fma_f32 v22, v29, v29, v22
    v_add_f32 v19, v19, v31
    v_fma_f32 v23, v31, v31, v23
    v_lshlrev_b32 v24, 16, v33
    v_and_b32 v25, 0xffff0000, v33
    v_lshlrev_b32 v26, 16, v37
    v_and_b32 v27, 0xffff0000, v37
    v_lshlrev_b32 v28, 16, v41
    v_and_b32 v29, 0xffff0000, v41
    v_lshlrev_b32 v30, 16, v45
    v_and_b32 v31, 0xffff0000, v45
    v_add_f32 v16, v16, v24
    v_fma_f32 v20, v24, v24, v20
    v_add_f32 v17, v17, v26
    v_fma_f32 v21, v26, v26, v21
    v_add_f32 v18, v18, v28
    v_fma_f32 v22, v28, v28, v22
    v_add_f32 v19, v19, v30
    v_fma_f32 v23, v30, v30, v23
    v_add_f32 v16, v16, v25
    v_fma_f32 v20, v25, v25, v20
    v_add_f32 v17, v17, v27
    v_fma_f32 v21, v27, v27, v21
    v_add_f32 v18, v18, v29
    v_fma_f32 v22, v29, v29, v22
    v_add_f32 v19, v19, v31
    v_fma_f32 v23, v31, v31, v23
    v_lshlrev_b32 v24, 16, v34
    v_and_b32 v25, 0xffff0000, v34
    v_lshlrev_b32 v26, 16, v38
    v_and_b32 v27, 0xffff0000, v38
    v_lshlrev_b32 v28, 16, v42
    v_and_b32 v29, 0xffff0000, v42
    v_lshlrev_b32 v30, 16, v46
    v_and_b32 v31, 0xffff0000, v46
    v_add_f32 v16, v16, v24
    v_fma_f32 v20, v24, v24, v20
    v_add_f32 v17, v17, v26
    v_fma_f32 v21, v26, v26, v21
    v_add_f32 v18, v18, v28
    v_fma_f32 v22, v28, v28, v22
    v_add_f32 v19, v19, v30
    v_fma_f32 v23, v30, v30, v23
    v_add_f32 v16, v16, v25
    v_fma_f32 v20, v25, v25, v20
    v_add_f32 v17, v17, v27
    v_fma_f32 v21, v27, v27, v21
    v_add_f32 v18, v18, v29
    v_fma_f32 v22, v29, v29, v22
    v_add_f32 v19, v19, v31
    v_fma_f32 v23, v31, v31, v23
    v_lshlrev_b32 v24, 16, v35
    v_and_b32 v25, 0xffff0000, v35
    v_lshlrev_b32 v26, 16, v39
    v_and_b32 v27, 0xffff0000, v39
    v_lshlrev_b32 v28, 16, v43
    v_and_b32 v29, 0xffff0000, v43
    v_lshlrev_b32 v30, 16, v47
    v_and_b32 v31, 0xffff0000, v47
    v_add_f32 v16, v16, v24
    v_fma_f32 v20, v24, v24, v20
    v_add_f32 v17, v17, v26
    v_fma_f32 v21, v26, v26, v21
    v_add_f32 v18, v18, v28
    v_fma_f32 v22, v28, v28, v22
    v_add_f32 v19, v19, v30
    v_fma_f32 v23, v30, v30, v23
    v_add_f32 v16, v16, v25
    v_fma_f32 v20, v25, v25, v20
    v_add_f32 v17, v17, v27
    v_fma_f32 v21, v27, v27, v21
    v_add_f32 v18, v18, v29
    v_fma_f32 v22, v29, v29, v22
    v_add_f32 v19, v19, v31
    v_fma_f32 v23, v31, v31, v23
    s_barrier
    ds_read_b128 v[32:35], v14 offset:32768
    ds_read_b128 v[36:39], v14 offset:33792
    ds_read_b128 v[40:43], v14 offset:34816
    ds_read_b128 v[44:47], v14 offset:35840
    s_waitcnt lgkmcnt(3)
    v_lshlrev_b32 v24, 16, v32
    v_and_b32 v25, 0xffff0000, v32
    s_waitcnt lgkmcnt(2)
    v_lshlrev_b32 v26, 16, v36
    v_and_b32 v27, 0xffff0000, v36
    s_waitcnt lgkmcnt(1)
    v_lshlrev_b32 v28, 16, v40
    v_and_b32 v29, 0xffff0000, v40
    s_waitcnt lgkmcnt(0)
    v_lshlrev_b32 v30, 16, v44
    v_and_b32 v31, 0xffff0000, v44
    v_add_f32 v16, v16, v24
    v_fma_f32 v20, v24, v24, v20
    v_add_f32 v17, v17, v26
    v_fma_f32 v21, v26, v26, v21
    v_add_f32 v18, v18, v28
    v_fma_f32 v22, v28, v28, v22
    v_add_f32 v19, v19, v30
    v_fma_f32 v23, v30, v30, v23
    v_add_f32 v16, v16, v25
    v_fma_f32 v20, v25, v25, v20
    v_add_f32 v17, v17, v27
    v_fma_f32 v21, v27, v27, v21
    v_add_f32 v18, v18, v29
    v_fma_f32 v22, v29, v29, v22
    v_add_f32 v19, v19, v31
    v_fma_f32 v23, v31, v31, v23
    v_lshlrev_b32 v24, 16, v33
    v_and_b32 v25, 0xffff0000, v33
    v_lshlrev_b32 v26, 16, v37
    v_and_b32 v27, 0xffff0000, v37
    v_lshlrev_b32 v28, 16, v41
    v_and_b32 v29, 0xffff0000, v41
    v_lshlrev_b32 v30, 16, v45
    v_and_b32 v31, 0xffff0000, v45
    v_add_f32 v16, v16, v24
    v_fma_f32 v20, v24, v24, v20
    v_add_f32 v17, v17, v26
    v_fma_f32 v21, v26, v26, v21
    v_add_f32 v18, v18, v28
    v_fma_f32 v22, v28, v28, v22
    v_add_f32 v19, v19, v30
    v_fma_f32 v23, v30, v30, v23
    v_add_f32 v16, v16, v25
    v_fma_f32 v20, v25, v25, v20
    v_add_f32 v17, v17, v27
    v_fma_f32 v21, v27, v27, v21
    v_add_f32 v18, v18, v29
    v_fma_f32 v22, v29, v29, v22
    v_add_f32 v19, v19, v31
    v_fma_f32 v23, v31, v31, v23
    v_lshlrev_b32 v24, 16, v34
    v_and_b32 v25, 0xffff0000, v34
    v_lshlrev_b32 v26, 16, v38
    v_and_b32 v27, 0xffff0000, v38
    v_lshlrev_b32 v28, 16, v42
    v_and_b32 v29, 0xffff0000, v42
    v_lshlrev_b32 v30, 16, v46
    v_and_b32 v31, 0xffff0000, v46
    v_add_f32 v16, v16, v24
    v_fma_f32 v20, v24, v24, v20
    v_add_f32 v17, v17, v26
    v_fma_f32 v21, v26, v26, v21
    v_add_f32 v18, v18, v28
    v_fma_f32 v22, v28, v28, v22
    v_add_f32 v19, v19, v30
    v_fma_f32 v23, v30, v30, v23
    v_add_f32 v16, v16, v25
    v_fma_f32 v20, v25, v25, v20
    v_add_f32 v17, v17, v27
    v_fma_f32 v21, v27, v27, v21
    v_add_f32 v18, v18, v29
    v_fma_f32 v22, v29, v29, v22
    v_add_f32 v19, v19, v31
    v_fma_f32 v23, v31, v31, v23
    v_lshlrev_b32 v24, 16, v35
    v_and_b32 v25, 0xffff0000, v35
    v_lshlrev_b32 v26, 16, v39
    v_and_b32 v27, 0xffff0000, v39
    v_lshlrev_b32 v28, 16, v43
    v_and_b32 v29, 0xffff0000, v43
    v_lshlrev_b32 v30, 16, v47
    v_and_b32 v31, 0xffff0000, v47
    v_add_f32 v16, v16, v24
    v_fma_f32 v20, v24, v24, v20
    v_add_f32 v17, v17, v26
    v_fma_f32 v21, v26, v26, v21
    v_add_f32 v18, v18, v28
    v_fma_f32 v22, v28, v28, v22
    v_add_f32 v19, v19, v30
    v_fma_f32 v23, v30, v30, v23
    v_add_f32 v16, v16, v25
    v_fma_f32 v20, v25, v25, v20
    v_add_f32 v17, v17, v27
    v_fma_f32 v21, v27, v27, v21
    v_add_f32 v18, v18, v29
    v_fma_f32 v22, v29, v29, v22
    v_add_f32 v19, v19, v31
    v_fma_f32 v23, v31, v31, v23
    s_barrier
    ds_read_b128 v[32:35], v15 offset:0
    ds_read_b128 v[36:39], v15 offset:1024
    ds_read_b128 v[40:43], v15 offset:2048
    ds_read_b128 v[44:47], v15 offset:3072
    s_waitcnt lgkmcnt(3)
    v_lshlrev_b32 v24, 16, v32
    v_and_b32 v25, 0xffff0000, v32
    s_waitcnt lgkmcnt(2)
    v_lshlrev_b32 v26, 16, v36
    v_and_b32 v27, 0xffff0000, v36
    s_waitcnt lgkmcnt(1)
    v_lshlrev_b32 v28, 16, v40
    v_and_b32 v29, 0xffff0000, v40
    s_waitcnt lgkmcnt(0)
    v_lshlrev_b32 v30, 16, v44
    v_and_b32 v31, 0xffff0000, v44
    v_add_f32 v16, v16, v24
    v_fma_f32 v20, v24, v24, v20
    v_add_f32 v17, v17, v26
    v_fma_f32 v21, v26, v26, v21
    v_add_f32 v18, v18, v28
    v_fma_f32 v22, v28, v28, v22
    v_add_f32 v19, v19, v30
    v_fma_f32 v23, v30, v30, v23
    v_add_f32 v16, v16, v25
    v_fma_f32 v20, v25, v25, v20
    v_add_f32 v17, v17, v27
    v_fma_f32 v21, v27, v27, v21
    v_add_f32 v18, v18, v29
    v_fma_f32 v22, v29, v29, v22
    v_add_f32 v19, v19, v31
    v_fma_f32 v23, v31, v31, v23
    v_lshlrev_b32 v24, 16, v33
    v_and_b32 v25, 0xffff0000, v33
    v_lshlrev_b32 v26, 16, v37
    v_and_b32 v27, 0xffff0000, v37
    v_lshlrev_b32 v28, 16, v41
    v_and_b32 v29, 0xffff0000, v41
    v_lshlrev_b32 v30, 16, v45
    v_and_b32 v31, 0xffff0000, v45
    v_add_f32 v16, v16, v24
    v_fma_f32 v20, v24, v24, v20
    v_add_f32 v17, v17, v26
    v_fma_f32 v21, v26, v26, v21
    v_add_f32 v18, v18, v28
    v_fma_f32 v22, v28, v28, v22
    v_add_f32 v19, v19, v30
    v_fma_f32 v23, v30, v30, v23
    v_add_f32 v16, v16, v25
    v_fma_f32 v20, v25, v25, v20
    v_add_f32 v17, v17, v27
    v_fma_f32 v21, v27, v27, v21
    v_add_f32 v18, v18, v29
    v_fma_f32 v22, v29, v29, v22
    v_add_f32 v19, v19, v31
    v_fma_f32 v23, v31, v31, v23
    v_lshlrev_b32 v24, 16, v34
    v_and_b32 v25, 0xffff0000, v34
    v_lshlrev_b32 v26, 16, v38
    v_and_b32 v27, 0xffff0000, v38
    v_lshlrev_b32 v28, 16, v42
    v_and_b32 v29, 0xffff0000, v42
    v_lshlrev_b32 v30, 16, v46
    v_and_b32 v31, 0xffff0000, v46
    v_add_f32 v16, v16, v24
    v_fma_f32 v20, v24, v24, v20
    v_add_f32 v17, v17, v26
    v_fma_f32 v21, v26, v26, v21
    v_add_f32 v18, v18, v28
    v_fma_f32 v22, v28, v28, v22
    v_add_f32 v19, v19, v30
    v_fma_f32 v23, v30, v30, v23
    v_add_f32 v16, v16, v25
    v_fma_f32 v20, v25, v25, v20
    v_add_f32 v17, v17, v27
    v_fma_f32 v21, v27, v27, v21
    v_add_f32 v18, v18, v29
    v_fma_f32 v22, v29, v29, v22
    v_add_f32 v19, v19, v31
    v_fma_f32 v23, v31, v31, v23
    v_lshlrev_b32 v24, 16, v35
    v_and_b32 v25, 0xffff0000, v35
    v_lshlrev_b32 v26, 16, v39
    v_and_b32 v27, 0xffff0000, v39
    v_lshlrev_b32 v28, 16, v43
    v_and_b32 v29, 0xffff0000, v43
    v_lshlrev_b32 v30, 16, v47
    v_and_b32 v31, 0xffff0000, v47
    v_add_f32 v16, v16, v24
    v_fma_f32 v20, v24, v24, v20
    v_add_f32 v17, v17, v26
    v_fma_f32 v21, v26, v26, v21
    v_add_f32 v18, v18, v28
    v_fma_f32 v22, v28, v28, v22
    v_add_f32 v19, v19, v30
    v_fma_f32 v23, v30, v30, v23
    v_add_f32 v16, v16, v25
    v_fma_f32 v20, v25, v25, v20
    v_add_f32 v17, v17, v27
    v_fma_f32 v21, v27, v27, v21
    v_add_f32 v18, v18, v29
    v_fma_f32 v22, v29, v29, v22
    v_add_f32 v19, v19, v31
    v_fma_f32 v23, v31, v31, v23
    s_barrier
    ds_read_b128 v[32:35], v15 offset:32768
    ds_read_b128 v[36:39], v15 offset:33792
    ds_read_b128 v[40:43], v15 offset:34816
    ds_read_b128 v[44:47], v15 offset:35840
    s_waitcnt lgkmcnt(3)
    v_lshlrev_b32 v24, 16, v32
    v_and_b32 v25, 0xffff0000, v32
    s_waitcnt lgkmcnt(2)
    v_lshlrev_b32 v26, 16, v36
    v_and_b32 v27, 0xffff0000, v36
    s_waitcnt lgkmcnt(1)
    v_lshlrev_b32 v28, 16, v40
    v_and_b32 v29, 0xffff0000, v40
    s_waitcnt lgkmcnt(0)
    v_lshlrev_b32 v30, 16, v44
    v_and_b32 v31, 0xffff0000, v44
    v_add_f32 v16, v16, v24
    v_fma_f32 v20, v24, v24, v20
    v_add_f32 v17, v17, v26
    v_fma_f32 v21, v26, v26, v21
    v_add_f32 v18, v18, v28
    v_fma_f32 v22, v28, v28, v22
    v_add_f32 v19, v19, v30
    v_fma_f32 v23, v30, v30, v23
    v_add_f32 v16, v16, v25
    v_fma_f32 v20, v25, v25, v20
    v_add_f32 v17, v17, v27
    v_fma_f32 v21, v27, v27, v21
    v_add_f32 v18, v18, v29
    v_fma_f32 v22, v29, v29, v22
    v_add_f32 v19, v19, v31
    v_fma_f32 v23, v31, v31, v23
    v_lshlrev_b32 v24, 16, v33
    v_and_b32 v25, 0xffff0000, v33
    v_lshlrev_b32 v26, 16, v37
    v_and_b32 v27, 0xffff0000, v37
    v_lshlrev_b32 v28, 16, v41
    v_and_b32 v29, 0xffff0000, v41
    v_lshlrev_b32 v30, 16, v45
    v_and_b32 v31, 0xffff0000, v45
    v_add_f32 v16, v16, v24
    v_fma_f32 v20, v24, v24, v20
    v_add_f32 v17, v17, v26
    v_fma_f32 v21, v26, v26, v21
    v_add_f32 v18, v18, v28
    v_fma_f32 v22, v28, v28, v22
    v_add_f32 v19, v19, v30
    v_fma_f32 v23, v30, v30, v23
    v_add_f32 v16, v16, v25
    v_fma_f32 v20, v25, v25, v20
    v_add_f32 v17, v17, v27
    v_fma_f32 v21, v27, v27, v21
    v_add_f32 v18, v18, v29
    v_fma_f32 v22, v29, v29, v22
    v_add_f32 v19, v19, v31
    v_fma_f32 v23, v31, v31, v23
    v_lshlrev_b32 v24, 16, v34
    v_and_b32 v25, 0xffff0000, v34
    v_lshlrev_b32 v26, 16, v38
    v_and_b32 v27, 0xffff0000, v38
    v_lshlrev_b32 v28, 16, v42
    v_and_b32 v29, 0xffff0000, v42
    v_lshlrev_b32 v30, 16, v46
    v_and_b32 v31, 0xffff0000, v46
    v_add_f32 v16, v16, v24
    v_fma_f32 v20, v24, v24, v20
    v_add_f32 v17, v17, v26
    v_fma_f32 v21, v26, v26, v21
    v_add_f32 v18, v18, v28
    v_fma_f32 v22, v28, v28, v22
    v_add_f32 v19, v19, v30
    v_fma_f32 v23, v30, v30, v23
    v_add_f32 v16, v16, v25
    v_fma_f32 v20, v25, v25, v20
    v_add_f32 v17, v17, v27
    v_fma_f32 v21, v27, v27, v21
    v_add_f32 v18, v18, v29
    v_fma_f32 v22, v29, v29, v22
    v_add_f32 v19, v19, v31
    v_fma_f32 v23, v31, v31, v23
    v_lshlrev_b32 v24, 16, v35
    v_and_b32 v25, 0xffff0000, v35
    v_lshlrev_b32 v26, 16, v39
    v_and_b32 v27, 0xffff0000, v39
    v_lshlrev_b32 v28, 16, v43
    v_and_b32 v29, 0xffff0000, v43
    v_lshlrev_b32 v30, 16, v47
    v_and_b32 v31, 0xffff0000, v47
    v_add_f32 v16, v16, v24
    v_fma_f32 v20, v24, v24, v20
    v_add_f32 v17, v17, v26
    v_fma_f32 v21, v26, v26, v21
    v_add_f32 v18, v18, v28
    v_fma_f32 v22, v28, v28, v22
    v_add_f32 v19, v19, v30
    v_fma_f32 v23, v30, v30, v23
    v_add_f32 v16, v16, v25
    v_fma_f32 v20, v25, v25, v20
    v_add_f32 v17, v17, v27
    v_fma_f32 v21, v27, v27, v21
    v_add_f32 v18, v18, v29
    v_fma_f32 v22, v29, v29, v22
    v_add_f32 v19, v19, v31
    v_fma_f32 v23, v31, v31, v23
    s_barrier
    ds_read_b128 v[32:35], v14 offset:0
    ds_read_b128 v[36:39], v14 offset:1024
    ds_read_b128 v[40:43], v14 offset:2048
    ds_read_b128 v[44:47], v14 offset:3072
    s_waitcnt lgkmcnt(3)
    v_lshlrev_b32 v24, 16, v32
    v_and_b32 v25, 0xffff0000, v32
    s_waitcnt lgkmcnt(2)
    v_lshlrev_b32 v26, 16, v36
    v_and_b32 v27, 0xffff0000, v36
    s_waitcnt lgkmcnt(1)
    v_lshlrev_b32 v28, 16, v40
    v_and_b32 v29, 0xffff0000, v40
    s_waitcnt lgkmcnt(0)
    v_lshlrev_b32 v30, 16, v44
    v_and_b32 v31, 0xffff0000, v44
    v_add_f32 v16, v16, v24
    v_fma_f32 v20, v24, v24, v20
    v_add_f32 v17, v17, v26
    v_fma_f32 v21, v26, v26, v21
    v_add_f32 v18, v18, v28
    v_fma_f32 v22, v28, v28, v22
    v_add_f32 v19, v19, v30
    v_fma_f32 v23, v30, v30, v23
    v_add_f32 v16, v16, v25
    v_fma_f32 v20, v25, v25, v20
    v_add_f32 v17, v17, v27
    v_fma_f32 v21, v27, v27, v21
    v_add_f32 v18, v18, v29
    v_fma_f32 v22, v29, v29, v22
    v_add_f32 v19, v19, v31
    v_fma_f32 v23, v31, v31, v23
    v_lshlrev_b32 v24, 16, v33
    v_and_b32 v25, 0xffff0000, v33
    v_lshlrev_b32 v26, 16, v37
    v_and_b32 v27, 0xffff0000, v37
    v_lshlrev_b32 v28, 16, v41
    v_and_b32 v29, 0xffff0000, v41
    v_lshlrev_b32 v30, 16, v45
    v_and_b32 v31, 0xffff0000, v45
    v_add_f32 v16, v16, v24
    v_fma_f32 v20, v24, v24, v20
    v_add_f32 v17, v17, v26
    v_fma_f32 v21, v26, v26, v21
    v_add_f32 v18, v18, v28
    v_fma_f32 v22, v28, v28, v22
    v_add_f32 v19, v19, v30
    v_fma_f32 v23, v30, v30, v23
    v_add_f32 v16, v16, v25
    v_fma_f32 v20, v25, v25, v20
    v_add_f32 v17, v17, v27
    v_fma_f32 v21, v27, v27, v21
    v_add_f32 v18, v18, v29
    v_fma_f32 v22, v29, v29, v22
    v_add_f32 v19, v19, v31
    v_fma_f32 v23, v31, v31, v23
    v_lshlrev_b32 v24, 16, v34
    v_and_b32 v25, 0xffff0000, v34
    v_lshlrev_b32 v26, 16, v38
    v_and_b32 v27, 0xffff0000, v38
    v_lshlrev_b32 v28, 16, v42
    v_and_b32 v29, 0xffff0000, v42
    v_lshlrev_b32 v30, 16, v46
    v_and_b32 v31, 0xffff0000, v46
    v_add_f32 v16, v16, v24
    v_fma_f32 v20, v24, v24, v20
    v_add_f32 v17, v17, v26
    v_fma_f32 v21, v26, v26, v21
    v_add_f32 v18, v18, v28
    v_fma_f32 v22, v28, v28, v22
    v_add_f32 v19, v19, v30
    v_fma_f32 v23, v30, v30, v23
    v_add_f32 v16, v16, v25
    v_fma_f32 v20, v25, v25, v20
    v_add_f32 v17, v17, v27
    v_fma_f32 v21, v27, v27, v21
    v_add_f32 v18, v18, v29
    v_fma_f32 v22, v29, v29, v22
    v_add_f32 v19, v19, v31
    v_fma_f32 v23, v31, v31, v23
    v_lshlrev_b32 v24, 16, v35
    v_and_b32 v25, 0xffff0000, v35
    v_lshlrev_b32 v26, 16, v39
    v_and_b32 v27, 0xffff0000, v39
    v_lshlrev_b32 v28, 16, v43
    v_and_b32 v29, 0xffff0000, v43
    v_lshlrev_b32 v30, 16, v47
    v_and_b32 v31, 0xffff0000, v47
    v_add_f32 v16, v16, v24
    v_fma_f32 v20, v24, v24, v20
    v_add_f32 v17, v17, v26
    v_fma_f32 v21, v26, v26, v21
    v_add_f32 v18, v18, v28
    v_fma_f32 v22, v28, v28, v22
    v_add_f32 v19, v19, v30
    v_fma_f32 v23, v30, v30, v23
    v_add_f32 v16, v16, v25
    v_fma_f32 v20, v25, v25, v20
    v_add_f32 v17, v17, v27
    v_fma_f32 v21, v27, v27, v21
    v_add_f32 v18, v18, v29
    v_fma_f32 v22, v29, v29, v22
    v_add_f32 v19, v19, v31
    v_fma_f32 v23, v31, v31, v23
    s_barrier
    ds_read_b128 v[32:35], v14 offset:32768
    ds_read_b128 v[36:39], v14 offset:33792
    ds_read_b128 v[40:43], v14 offset:34816
    ds_read_b128 v[44:47], v14 offset:35840
    s_waitcnt lgkmcnt(3)
    v_lshlrev_b32 v24, 16, v32
    v_and_b32 v25, 0xffff0000, v32
    s_waitcnt lgkmcnt(2)
    v_lshlrev_b32 v26, 16, v36
    v_and_b32 v27, 0xffff0000, v36
    s_waitcnt lgkmcnt(1)
    v_lshlrev_b32 v28, 16, v40
    v_and_b32 v29, 0xffff0000, v40
    s_waitcnt lgkmcnt(0)
    v_lshlrev_b32 v30, 16, v44
    v_and_b32 v31, 0xffff0000, v44
    v_add_f32 v16, v16, v24
    v_fma_f32 v20, v24, v24, v20
    v_add_f32 v17, v17, v26
    v_fma_f32 v21, v26, v26, v21
    v_add_f32 v18, v18, v28
    v_fma_f32 v22, v28, v28, v22
    v_add_f32 v19, v19, v30
    v_fma_f32 v23, v30, v30, v23
    v_add_f32 v16, v16, v25
    v_fma_f32 v20, v25, v25, v20
    v_add_f32 v17, v17, v27
    v_fma_f32 v21, v27, v27, v21
    v_add_f32 v18, v18, v29
    v_fma_f32 v22, v29, v29, v22
    v_add_f32 v19, v19, v31
    v_fma_f32 v23, v31, v31, v23
    v_lshlrev_b32 v24, 16, v33
    v_and_b32 v25, 0xffff0000, v33
    v_lshlrev_b32 v26, 16, v37
    v_and_b32 v27, 0xffff0000, v37
    v_lshlrev_b32 v28, 16, v41
    v_and_b32 v29, 0xffff0000, v41
    v_lshlrev_b32 v30, 16, v45
    v_and_b32 v31, 0xffff0000, v45
    v_add_f32 v16, v16, v24
    v_fma_f32 v20, v24, v24, v20
    v_add_f32 v17, v17, v26
    v_fma_f32 v21, v26, v26, v21
    v_add_f32 v18, v18, v28
    v_fma_f32 v22, v28, v28, v22
    v_add_f32 v19, v19, v30
    v_fma_f32 v23, v30, v30, v23
    v_add_f32 v16, v16, v25
    v_fma_f32 v20, v25, v25, v20
    v_add_f32 v17, v17, v27
    v_fma_f32 v21, v27, v27, v21
    v_add_f32 v18, v18, v29
    v_fma_f32 v22, v29, v29, v22
    v_add_f32 v19, v19, v31
    v_fma_f32 v23, v31, v31, v23
    v_lshlrev_b32 v24, 16, v34
    v_and_b32 v25, 0xffff0000, v34
    v_lshlrev_b32 v26, 16, v38
    v_and_b32 v27, 0xffff0000, v38
    v_lshlrev_b32 v28, 16, v42
    v_and_b32 v29, 0xffff0000, v42
    v_lshlrev_b32 v30, 16, v46
    v_and_b32 v31, 0xffff0000, v46
    v_add_f32 v16, v16, v24
    v_fma_f32 v20, v24, v24, v20
    v_add_f32 v17, v17, v26
    v_fma_f32 v21, v26, v26, v21
    v_add_f32 v18, v18, v28
    v_fma_f32 v22, v28, v28, v22
    v_add_f32 v19, v19, v30
    v_fma_f32 v23, v30, v30, v23
    v_add_f32 v16, v16, v25
    v_fma_f32 v20, v25, v25, v20
    v_add_f32 v17, v17, v27
    v_fma_f32 v21, v27, v27, v21
    v_add_f32 v18, v18, v29
    v_fma_f32 v22, v29, v29, v22
    v_add_f32 v19, v19, v31
    v_fma_f32 v23, v31, v31, v23
    v_lshlrev_b32 v24, 16, v35
    v_and_b32 v25, 0xffff0000, v35
    v_lshlrev_b32 v26, 16, v39
    v_and_b32 v27, 0xffff0000, v39
    v_lshlrev_b32 v28, 16, v43
    v_and_b32 v29, 0xffff0000, v43
    v_lshlrev_b32 v30, 16, v47
    v_and_b32 v31, 0xffff0000, v47
    v_add_f32 v16, v16, v24
    v_fma_f32 v20, v24, v24, v20
    v_add_f32 v17, v17, v26
    v_fma_f32 v21, v26, v26, v21
    v_add_f32 v18, v18, v28
    v_fma_f32 v22, v28, v28, v22
    v_add_f32 v19, v19, v30
    v_fma_f32 v23, v30, v30, v23
    v_add_f32 v16, v16, v25
    v_fma_f32 v20, v25, v25, v20
    v_add_f32 v17, v17, v27
    v_fma_f32 v21, v27, v27, v21
    v_add_f32 v18, v18, v29
    v_fma_f32 v22, v29, v29, v22
    v_add_f32 v19, v19, v31
    v_fma_f32 v23, v31, v31, v23
    s_barrier
    ds_read_b128 v[32:35], v15 offset:0
    ds_read_b128 v[36:39], v15 offset:1024
    ds_read_b128 v[40:43], v15 offset:2048
    ds_read_b128 v[44:47], v15 offset:3072
    s_waitcnt lgkmcnt(3)
    v_lshlrev_b32 v24, 16, v32
    v_and_b32 v25, 0xffff0000, v32
    s_waitcnt lgkmcnt(2)
    v_lshlrev_b32 v26, 16, v36
    v_and_b32 v27, 0xffff0000, v36
    s_waitcnt lgkmcnt(1)
    v_lshlrev_b32 v28, 16, v40
    v_and_b32 v29, 0xffff0000, v40
    s_waitcnt lgkmcnt(0)
    v_lshlrev_b32 v30, 16, v44
    v_and_b32 v31, 0xffff0000, v44
    v_add_f32 v16, v16, v24
    v_fma_f32 v20, v24, v24, v20
    v_add_f32 v17, v17, v26
    v_fma_f32 v21, v26, v26, v21
    v_add_f32 v18, v18, v28
    v_fma_f32 v22, v28, v28, v22
    v_add_f32 v19, v19, v30
    v_fma_f32 v23, v30, v30, v23
    v_add_f32 v16, v16, v25
    v_fma_f32 v20, v25, v25, v20
    v_add_f32 v17, v17, v27
    v_fma_f32 v21, v27, v27, v21
    v_add_f32 v18, v18, v29
    v_fma_f32 v22, v29, v29, v22
    v_add_f32 v19, v19, v31
    v_fma_f32 v23, v31, v31, v23
    v_lshlrev_b32 v24, 16, v33
    v_and_b32 v25, 0xffff0000, v33
    v_lshlrev_b32 v26, 16, v37
    v_and_b32 v27, 0xffff0000, v37
    v_lshlrev_b32 v28, 16, v41
    v_and_b32 v29, 0xffff0000, v41
    v_lshlrev_b32 v30, 16, v45
    v_and_b32 v31, 0xffff0000, v45
    v_add_f32 v16, v16, v24
    v_fma_f32 v20, v24, v24, v20
    v_add_f32 v17, v17, v26
    v_fma_f32 v21, v26, v26, v21
    v_add_f32 v18, v18, v28
    v_fma_f32 v22, v28, v28, v22
    v_add_f32 v19, v19, v30
    v_fma_f32 v23, v30, v30, v23
    v_add_f32 v16, v16, v25
    v_fma_f32 v20, v25, v25, v20
    v_add_f32 v17, v17, v27
    v_fma_f32 v21, v27, v27, v21
    v_add_f32 v18, v18, v29
    v_fma_f32 v22, v29, v29, v22
    v_add_f32 v19, v19, v31
    v_fma_f32 v23, v31, v31, v23
    v_lshlrev_b32 v24, 16, v34
    v_and_b32 v25, 0xffff0000, v34
    v_lshlrev_b32 v26, 16, v38
    v_and_b32 v27, 0xffff0000, v38
    v_lshlrev_b32 v28, 16, v42
    v_and_b32 v29, 0xffff0000, v42
    v_lshlrev_b32 v30, 16, v46
    v_and_b32 v31, 0xffff0000, v46
    v_add_f32 v16, v16, v24
    v_fma_f32 v20, v24, v24, v20
    v_add_f32 v17, v17, v26
    v_fma_f32 v21, v26, v26, v21
    v_add_f32 v18, v18, v28
    v_fma_f32 v22, v28, v28, v22
    v_add_f32 v19, v19, v30
    v_fma_f32 v23, v30, v30, v23
    v_add_f32 v16, v16, v25
    v_fma_f32 v20, v25, v25, v20
    v_add_f32 v17, v17, v27
    v_fma_f32 v21, v27, v27, v21
    v_add_f32 v18, v18, v29
    v_fma_f32 v22, v29, v29, v22
    v_add_f32 v19, v19, v31
    v_fma_f32 v23, v31, v31, v23
    v_lshlrev_b32 v24, 16, v35
    v_and_b32 v25, 0xffff0000, v35
    v_lshlrev_b32 v26, 16, v39
    v_and_b32 v27, 0xffff0000, v39
    v_lshlrev_b32 v28, 16, v43
    v_and_b32 v29, 0xffff0000, v43
    v_lshlrev_b32 v30, 16, v47
    v_and_b32 v31, 0xffff0000, v47
    v_add_f32 v16, v16, v24
    v_fma_f32 v20, v24, v24, v20
    v_add_f32 v17, v17, v26
    v_fma_f32 v21, v26, v26, v21
    v_add_f32 v18, v18, v28
    v_fma_f32 v22, v28, v28, v22
    v_add_f32 v19, v19, v30
    v_fma_f32 v23, v30, v30, v23
    v_add_f32 v16, v16, v25
    v_fma_f32 v20, v25, v25, v20
    v_add_f32 v17, v17, v27
    v_fma_f32 v21, v27, v27, v21
    v_add_f32 v18, v18, v29
    v_fma_f32 v22, v29, v29, v22
    v_add_f32 v19, v19, v31
    v_fma_f32 v23, v31, v31, v23
    s_barrier
    ds_read_b128 v[32:35], v15 offset:32768
    ds_read_b128 v[36:39], v15 offset:33792
    ds_read_b128 v[40:43], v15 offset:34816
    ds_read_b128 v[44:47], v15 offset:35840
    s_waitcnt lgkmcnt(3)
    v_lshlrev_b32 v24, 16, v32
    v_and_b32 v25, 0xffff0000, v32
    s_waitcnt lgkmcnt(2)
    v_lshlrev_b32 v26, 16, v36
    v_and_b32 v27, 0xffff0000, v36
    s_waitcnt lgkmcnt(1)
    v_lshlrev_b32 v28, 16, v40
    v_and_b32 v29, 0xffff0000, v40
    s_waitcnt lgkmcnt(0)
    v_lshlrev_b32 v30, 16, v44
    v_and_b32 v31, 0xffff0000, v44
    v_add_f32 v16, v16, v24
    v_fma_f32 v20, v24, v24, v20
    v_add_f32 v17, v17, v26
    v_fma_f32 v21, v26, v26, v21
    v_add_f32 v18, v18, v28
    v_fma_f32 v22, v28, v28, v22
    v_add_f32 v19, v19, v30
    v_fma_f32 v23, v30, v30, v23
    v_add_f32 v16, v16, v25
    v_fma_f32 v20, v25, v25, v20
    v_add_f32 v17, v17, v27
    v_fma_f32 v21, v27, v27, v21
    v_add_f32 v18, v18, v29
    v_fma_f32 v22, v29, v29, v22
    v_add_f32 v19, v19, v31
    v_fma_f32 v23, v31, v31, v23
    v_lshlrev_b32 v24, 16, v33
    v_and_b32 v25, 0xffff0000, v33
    v_lshlrev_b32 v26, 16, v37
    v_and_b32 v27, 0xffff0000, v37
    v_lshlrev_b32 v28, 16, v41
    v_and_b32 v29, 0xffff0000, v41
    v_lshlrev_b32 v30, 16, v45
    v_and_b32 v31, 0xffff0000, v45
    v_add_f32 v16, v16, v24
    v_fma_f32 v20, v24, v24, v20
    v_add_f32 v17, v17, v26
    v_fma_f32 v21, v26, v26, v21
    v_add_f32 v18, v18, v28
    v_fma_f32 v22, v28, v28, v22
    v_add_f32 v19, v19, v30
    v_fma_f32 v23, v30, v30, v23
    v_add_f32 v16, v16, v25
    v_fma_f32 v20, v25, v25, v20
    v_add_f32 v17, v17, v27
    v_fma_f32 v21, v27, v27, v21
    v_add_f32 v18, v18, v29
    v_fma_f32 v22, v29, v29, v22
    v_add_f32 v19, v19, v31
    v_fma_f32 v23, v31, v31, v23
    v_lshlrev_b32 v24, 16, v34
    v_and_b32 v25, 0xffff0000, v34
    v_lshlrev_b32 v26, 16, v38
    v_and_b32 v27, 0xffff0000, v38
    v_lshlrev_b32 v28, 16, v42
    v_and_b32 v29, 0xffff0000, v42
    v_lshlrev_b32 v30, 16, v46
    v_and_b32 v31, 0xffff0000, v46
    v_add_f32 v16, v16, v24
    v_fma_f32 v20, v24, v24, v20
    v_add_f32 v17, v17, v26
    v_fma_f32 v21, v26, v26, v21
    v_add_f32 v18, v18, v28
    v_fma_f32 v22, v28, v28, v22
    v_add_f32 v19, v19, v30
    v_fma_f32 v23, v30, v30, v23
    v_add_f32 v16, v16, v25
    v_fma_f32 v20, v25, v25, v20
    v_add_f32 v17, v17, v27
    v_fma_f32 v21, v27, v27, v21
    v_add_f32 v18, v18, v29
    v_fma_f32 v22, v29, v29, v22
    v_add_f32 v19, v19, v31
    v_fma_f32 v23, v31, v31, v23
    v_lshlrev_b32 v24, 16, v35
    v_and_b32 v25, 0xffff0000, v35
    v_lshlrev_b32 v26, 16, v39
    v_and_b32 v27, 0xffff0000, v39
    v_lshlrev_b32 v28, 16, v43
    v_and_b32 v29, 0xffff0000, v43
    v_lshlrev_b32 v30, 16, v47
    v_and_b32 v31, 0xffff0000, v47
    v_add_f32 v16, v16, v24
    v_fma_f32 v20, v24, v24, v20
    v_add_f32 v17, v17, v26
    v_fma_f32 v21, v26, v26, v21
    v_add_f32 v18, v18, v28
    v_fma_f32 v22, v28, v28, v22
    v_add_f32 v19, v19, v30
    v_fma_f32 v23, v30, v30, v23
    v_add_f32 v16, v16, v25
    v_fma_f32 v20, v25, v25, v20
    v_add_f32 v17, v17, v27
    v_fma_f32 v21, v27, v27, v21
    v_add_f32 v18, v18, v29
    v_fma_f32 v22, v29, v29, v22
    v_add_f32 v19, v19, v31
    v_fma_f32 v23, v31, v31, v23
    s_barrier
    ds_read_b128 v[32:35], v14 offset:0
    ds_read_b128 v[36:39], v14 offset:1024
    ds_read_b128 v[40:43], v14 offset:2048
    ds_read_b128 v[44:47], v14 offset:3072
    s_waitcnt lgkmcnt(3)
    v_lshlrev_b32 v24, 16, v32
    v_and_b32 v25, 0xffff0000, v32
    s_waitcnt lgkmcnt(2)
    v_lshlrev_b32 v26, 16, v36
    v_and_b32 v27, 0xffff0000, v36
    s_waitcnt lgkmcnt(1)
    v_lshlrev_b32 v28, 16, v40
    v_and_b32 v29, 0xffff0000, v40
    s_waitcnt lgkmcnt(0)
    v_lshlrev_b32 v30, 16, v44
    v_and_b32 v31, 0xffff0000, v44
    v_add_f32 v16, v16, v24
    v_fma_f32 v20, v24, v24, v20
    v_add_f32 v17, v17, v26
    v_fma_f32 v21, v26, v26, v21
    v_add_f32 v18, v18, v28
    v_fma_f32 v22, v28, v28, v22
    v_add_f32 v19, v19, v30
    v_fma_f32 v23, v30, v30, v23
    v_add_f32 v16, v16, v25
    v_fma_f32 v20, v25, v25, v20
    v_add_f32 v17, v17, v27
    v_fma_f32 v21, v27, v27, v21
    v_add_f32 v18, v18, v29
    v_fma_f32 v22, v29, v29, v22
    v_add_f32 v19, v19, v31
    v_fma_f32 v23, v31, v31, v23
    v_lshlrev_b32 v24, 16, v33
    v_and_b32 v25, 0xffff0000, v33
    v_lshlrev_b32 v26, 16, v37
    v_and_b32 v27, 0xffff0000, v37
    v_lshlrev_b32 v28, 16, v41
    v_and_b32 v29, 0xffff0000, v41
    v_lshlrev_b32 v30, 16, v45
    v_and_b32 v31, 0xffff0000, v45
    v_add_f32 v16, v16, v24
    v_fma_f32 v20, v24, v24, v20
    v_add_f32 v17, v17, v26
    v_fma_f32 v21, v26, v26, v21
    v_add_f32 v18, v18, v28
    v_fma_f32 v22, v28, v28, v22
    v_add_f32 v19, v19, v30
    v_fma_f32 v23, v30, v30, v23
    v_add_f32 v16, v16, v25
    v_fma_f32 v20, v25, v25, v20
    v_add_f32 v17, v17, v27
    v_fma_f32 v21, v27, v27, v21
    v_add_f32 v18, v18, v29
    v_fma_f32 v22, v29, v29, v22
    v_add_f32 v19, v19, v31
    v_fma_f32 v23, v31, v31, v23
    v_lshlrev_b32 v24, 16, v34
    v_and_b32 v25, 0xffff0000, v34
    v_lshlrev_b32 v26, 16, v38
    v_and_b32 v27, 0xffff0000, v38
    v_lshlrev_b32 v28, 16, v42
    v_and_b32 v29, 0xffff0000, v42
    v_lshlrev_b32 v30, 16, v46
    v_and_b32 v31, 0xffff0000, v46
    v_add_f32 v16, v16, v24
    v_fma_f32 v20, v24, v24, v20
    v_add_f32 v17, v17, v26
    v_fma_f32 v21, v26, v26, v21
    v_add_f32 v18, v18, v28
    v_fma_f32 v22, v28, v28, v22
    v_add_f32 v19, v19, v30
    v_fma_f32 v23, v30, v30, v23
    v_add_f32 v16, v16, v25
    v_fma_f32 v20, v25, v25, v20
    v_add_f32 v17, v17, v27
    v_fma_f32 v21, v27, v27, v21
    v_add_f32 v18, v18, v29
    v_fma_f32 v22, v29, v29, v22
    v_add_f32 v19, v19, v31
    v_fma_f32 v23, v31, v31, v23
    v_lshlrev_b32 v24, 16, v35
    v_and_b32 v25, 0xffff0000, v35
    v_lshlrev_b32 v26, 16, v39
    v_and_b32 v27, 0xffff0000, v39
    v_lshlrev_b32 v28, 16, v43
    v_and_b32 v29, 0xffff0000, v43
    v_lshlrev_b32 v30, 16, v47
    v_and_b32 v31, 0xffff0000, v47
    v_add_f32 v16, v16, v24
    v_fma_f32 v20, v24, v24, v20
    v_add_f32 v17, v17, v26
    v_fma_f32 v21, v26, v26, v21
    v_add_f32 v18, v18, v28
    v_fma_f32 v22, v28, v28, v22
    v_add_f32 v19, v19, v30
    v_fma_f32 v23, v30, v30, v23
    v_add_f32 v16, v16, v25
    v_fma_f32 v20, v25, v25, v20
    v_add_f32 v17, v17, v27
    v_fma_f32 v21, v27, v27, v21
    v_add_f32 v18, v18, v29
    v_fma_f32 v22, v29, v29, v22
    v_add_f32 v19, v19, v31
    v_fma_f32 v23, v31, v31, v23
    s_barrier
    ds_read_b128 v[32:35], v14 offset:32768
    ds_read_b128 v[36:39], v14 offset:33792
    ds_read_b128 v[40:43], v14 offset:34816
    ds_read_b128 v[44:47], v14 offset:35840
    s_waitcnt lgkmcnt(3)
    v_lshlrev_b32 v24, 16, v32
    v_and_b32 v25, 0xffff0000, v32
    s_waitcnt lgkmcnt(2)
    v_lshlrev_b32 v26, 16, v36
    v_and_b32 v27, 0xffff0000, v36
    s_waitcnt lgkmcnt(1)
    v_lshlrev_b32 v28, 16, v40
    v_and_b32 v29, 0xffff0000, v40
    s_waitcnt lgkmcnt(0)
    v_lshlrev_b32 v30, 16, v44
    v_and_b32 v31, 0xffff0000, v44
    v_add_f32 v16, v16, v24
    v_fma_f32 v20, v24, v24, v20
    v_add_f32 v17, v17, v26
    v_fma_f32 v21, v26, v26, v21
    v_add_f32 v18, v18, v28
    v_fma_f32 v22, v28, v28, v22
    v_add_f32 v19, v19, v30
    v_fma_f32 v23, v30, v30, v23
    v_add_f32 v16, v16, v25
    v_fma_f32 v20, v25, v25, v20
    v_add_f32 v17, v17, v27
    v_fma_f32 v21, v27, v27, v21
    v_add_f32 v18, v18, v29
    v_fma_f32 v22, v29, v29, v22
    v_add_f32 v19, v19, v31
    v_fma_f32 v23, v31, v31, v23
    v_lshlrev_b32 v24, 16, v33
    v_and_b32 v25, 0xffff0000, v33
    v_lshlrev_b32 v26, 16, v37
    v_and_b32 v27, 0xffff0000, v37
    v_lshlrev_b32 v28, 16, v41
    v_and_b32 v29, 0xffff0000, v41
    v_lshlrev_b32 v30, 16, v45
    v_and_b32 v31, 0xffff0000, v45
    v_add_f32 v16, v16, v24
    v_fma_f32 v20, v24, v24, v20
    v_add_f32 v17, v17, v26
    v_fma_f32 v21, v26, v26, v21
    v_add_f32 v18, v18, v28
    v_fma_f32 v22, v28, v28, v22
    v_add_f32 v19, v19, v30
    v_fma_f32 v23, v30, v30, v23
    v_add_f32 v16, v16, v25
    v_fma_f32 v20, v25, v25, v20
    v_add_f32 v17, v17, v27
    v_fma_f32 v21, v27, v27, v21
    v_add_f32 v18, v18, v29
    v_fma_f32 v22, v29, v29, v22
    v_add_f32 v19, v19, v31
    v_fma_f32 v23, v31, v31, v23
    v_lshlrev_b32 v24, 16, v34
    v_and_b32 v25, 0xffff0000, v34
    v_lshlrev_b32 v26, 16, v38
    v_and_b32 v27, 0xffff0000, v38
    v_lshlrev_b32 v28, 16, v42
    v_and_b32 v29, 0xffff0000, v42
    v_lshlrev_b32 v30, 16, v46
    v_and_b32 v31, 0xffff0000, v46
    v_add_f32 v16, v16, v24
    v_fma_f32 v20, v24, v24, v20
    v_add_f32 v17, v17, v26
    v_fma_f32 v21, v26, v26, v21
    v_add_f32 v18, v18, v28
    v_fma_f32 v22, v28, v28, v22
    v_add_f32 v19, v19, v30
    v_fma_f32 v23, v30, v30, v23
    v_add_f32 v16, v16, v25
    v_fma_f32 v20, v25, v25, v20
    v_add_f32 v17, v17, v27
    v_fma_f32 v21, v27, v27, v21
    v_add_f32 v18, v18, v29
    v_fma_f32 v22, v29, v29, v22
    v_add_f32 v19, v19, v31
    v_fma_f32 v23, v31, v31, v23
    v_lshlrev_b32 v24, 16, v35
    v_and_b32 v25, 0xffff0000, v35
    v_lshlrev_b32 v26, 16, v39
    v_and_b32 v27, 0xffff0000, v39
    v_lshlrev_b32 v28, 16, v43
    v_and_b32 v29, 0xffff0000, v43
    v_lshlrev_b32 v30, 16, v47
    v_and_b32 v31, 0xffff0000, v47
    v_add_f32 v16, v16, v24
    v_fma_f32 v20, v24, v24, v20
    v_add_f32 v17, v17, v26
    v_fma_f32 v21, v26, v26, v21
    v_add_f32 v18, v18, v28
    v_fma_f32 v22, v28, v28, v22
    v_add_f32 v19, v19, v30
    v_fma_f32 v23, v30, v30, v23
    v_add_f32 v16, v16, v25
    v_fma_f32 v20, v25, v25, v20
    v_add_f32 v17, v17, v27
    v_fma_f32 v21, v27, v27, v21
    v_add_f32 v18, v18, v29
    v_fma_f32 v22, v29, v29, v22
    v_add_f32 v19, v19, v31
    v_fma_f32 v23, v31, v31, v23
    v_add_f32_dpp v16, v16, v16 quad_perm:[1,0,3,2] row_mask:0xf bank_mask:0xf
    v_add_f32_dpp v17, v17, v17 quad_perm:[1,0,3,2] row_mask:0xf bank_mask:0xf
    v_add_f32_dpp v18, v18, v18 quad_perm:[1,0,3,2] row_mask:0xf bank_mask:0xf
    v_add_f32_dpp v19, v19, v19 quad_perm:[1,0,3,2] row_mask:0xf bank_mask:0xf
    v_add_f32_dpp v20, v20, v20 quad_perm:[1,0,3,2] row_mask:0xf bank_mask:0xf
    v_add_f32_dpp v21, v21, v21 quad_perm:[1,0,3,2] row_mask:0xf bank_mask:0xf
    v_add_f32_dpp v22, v22, v22 quad_perm:[1,0,3,2] row_mask:0xf bank_mask:0xf
    v_add_f32_dpp v23, v23, v23 quad_perm:[1,0,3,2] row_mask:0xf bank_mask:0xf
    v_add_f32_dpp v16, v16, v16 quad_perm:[2,3,0,1] row_mask:0xf bank_mask:0xf
    v_add_f32_dpp v17, v17, v17 quad_perm:[2,3,0,1] row_mask:0xf bank_mask:0xf
    v_add_f32_dpp v18, v18, v18 quad_perm:[2,3,0,1] row_mask:0xf bank_mask:0xf
    v_add_f32_dpp v19, v19, v19 quad_perm:[2,3,0,1] row_mask:0xf bank_mask:0xf
    v_add_f32_dpp v20, v20, v20 quad_perm:[2,3,0,1] row_mask:0xf bank_mask:0xf
    v_add_f32_dpp v21, v21, v21 quad_perm:[2,3,0,1] row_mask:0xf bank_mask:0xf
    v_add_f32_dpp v22, v22, v22 quad_perm:[2,3,0,1] row_mask:0xf bank_mask:0xf
    v_add_f32_dpp v23, v23, v23 quad_perm:[2,3,0,1] row_mask:0xf bank_mask:0xf
    v_add_f32_dpp v16, v16, v16 row_half_mirror row_mask:0xf bank_mask:0xf
    v_add_f32_dpp v17, v17, v17 row_half_mirror row_mask:0xf bank_mask:0xf
    v_add_f32_dpp v18, v18, v18 row_half_mirror row_mask:0xf bank_mask:0xf
    v_add_f32_dpp v19, v19, v19 row_half_mirror row_mask:0xf bank_mask:0xf
    v_add_f32_dpp v20, v20, v20 row_half_mirror row_mask:0xf bank_mask:0xf
    v_add_f32_dpp v21, v21, v21 row_half_mirror row_mask:0xf bank_mask:0xf
    v_add_f32_dpp v22, v22, v22 row_half_mirror row_mask:0xf bank_mask:0xf
    v_add_f32_dpp v23, v23, v23 row_half_mirror row_mask:0xf bank_mask:0xf
    s_lshl_b32 s33, s34, 8
    s_add_u32 s33, s33, 132096
    v_lshrrev_b32 v4, 3, v1
    v_lshl_add_u32 v4, v4, 2, s33
    v_mul_f32 v16, 0x3acccccd, v16
    v_mul_f32 v20, 0x3acccccd, v20
    v_mul_f32 v17, 0x3acccccd, v17
    v_mul_f32 v21, 0x3acccccd, v21
    v_mul_f32 v18, 0x3acccccd, v18
    v_mul_f32 v22, 0x3acccccd, v22
    v_mul_f32 v19, 0x3acccccd, v19
    v_mul_f32 v23, 0x3acccccd, v23
    v_fma_f32 v20, -v16, v16, v20
    v_fma_f32 v21, -v17, v17, v21
    v_fma_f32 v22, -v18, v18, v22
    v_fma_f32 v23, -v19, v19, v23
    v_max_f32 v20, 0, v20
    v_max_f32 v21, 0, v21
    v_max_f32 v22, 0, v22
    v_max_f32 v23, 0, v23
    v_add_f32 v20, 0x3727c5ac, v20
    v_add_f32 v21, 0x3727c5ac, v21
    v_add_f32 v22, 0x3727c5ac, v22
    v_add_f32 v23, 0x3727c5ac, v23
    v_rsq_f32 v20, v20
    v_rsq_f32 v21, v21
    v_rsq_f32 v22, v22
    v_rsq_f32 v23, v23
    ds_write2_b32 v4, v16, v20 offset0:0 offset1:32
    ds_write2_b32 v4, v17, v21 offset0:8 offset1:40
    ds_write2_b32 v4, v18, v22 offset0:16 offset1:48
    ds_write2_b32 v4, v19, v23 offset0:24 offset1:56
    s_waitcnt lgkmcnt(0)
    s_barrier
    s_mov_b32 s44, s20
    s_and_b32 s45, s21, 0xffff
    s_mov_b32 s46, 0x100
    s_mov_b32 s47, 0x20000
    v_mov_b32 v5, 0
    s_mov_b32 s32, 0x40000
    s_nop 3
sequential_preLN__sliding_block__geglu_ffn__prompt_kernel_tok11:
    buffer_load_dword v4, v5, s[44:47], 0 offen sc1
    s_waitcnt vmcnt(0)
    v_readfirstlane_b32 s24, v4
    s_nop 0
    s_cmp_lg_u32 s24, 0
    s_cbranch_scc1 sequential_preLN__sliding_block__geglu_ffn__prompt_kernel_tokd12
    s_sub_u32 s32, s32, 1
    s_cbranch_scc1 sequential_preLN__sliding_block__geglu_ffn__prompt_kernel_tokd12
    s_sleep 2
    s_branch sequential_preLN__sliding_block__geglu_ffn__prompt_kernel_tok11
    s_nop 0
sequential_preLN__sliding_block__geglu_ffn__prompt_kernel_tokd12:
    s_barrier
    s_cmp_lg_u32 s3, 11
    s_cbranch_scc1 sequential_preLN__sliding_block__geglu_ffn__prompt_kernel_nosig13
    s_lshl_b32 s33, s35, 4
    s_add_u32 s33, s33, s36
    s_lshl_b32 s33, s33, 7
    v_mov_b32 v4, s24
    v_mov_b32 v5, 0
    s_mov_b64 exec, 1
    buffer_store_dword v4, v5, s[92:95], s33 offen sc1
    s_mov_b64 exec, -1
    s_nop 1
sequential_preLN__sliding_block__geglu_ffn__prompt_kernel_nosig13:
sequential_preLN__sliding_block__geglu_ffn__prompt_kernel_p1_join8:
    s_branch sequential_preLN__sliding_block__geglu_ffn__prompt_kernel_p1end4
    s_nop 0
sequential_preLN__sliding_block__geglu_ffn__prompt_kernel_p1pack3:
    s_sub_u32 s35, s2, 240
    s_mul_i32 s34, s35, 12
    s_add_u32 s34, s34, s3
    s_lshl_b32 s34, s34, 6
    v_add_u32 v19, s34, v1
    s_mov_b32 s44, s8
    s_and_b32 s45, s9, 0xffff
    s_mov_b32 s46, 0xc8000
    s_mov_b32 s47, 0x20000
    s_add_u32 s48, s22, 0x13c0000
    s_addc_u32 s49, s23, 0
    s_and_b32 s49, s49, 0xffff
    s_mov_b32 s50, 0xc8000
    s_mov_b32 s51, 0x20000
    v_lshlrev_b32 v9, 4, v19
    s_mov_b32 s33, 0
    buffer_load_dwordx4 v[20:23], v9, s[44:47], s33 offen
    s_mov_b32 s33, 196608
    buffer_load_dwordx4 v[24:27], v9, s[44:47], s33 offen
    s_mov_b32 s33, 393216
    buffer_load_dwordx4 v[28:31], v9, s[44:47], s33 offen
    s_mov_b32 s33, 589824
    buffer_load_dwordx4 v[32:35], v9, s[44:47], s33 offen
    s_mov_b32 s33, 786432
    buffer_load_dwordx4 v[36:39], v9, s[44:47], s33 offen
    s_mov_b32 s33, 0x3333334
    v_mul_hi_u32 v4, v19, s33
    v_mul_u32_u24 v5, 80, v4
    v_sub_u32 v5, v19, v5
    v_mul_u32_u24 v6, 3277, v4
    v_lshrrev_b32 v6, 16, v6
    v_mul_u32_u24 v7, 20, v6
    v_sub_u32 v7, v4, v7
    v_lshl_add_u32 v4, v6, 4, v7
    v_bfe_u32 v10, v6, 1, 3
    v_lshl_add_u32 v14, v10, 4, v7
    v_and_b32 v10, 1, v6
    v_lshl_add_u32 v14, v10, 2, v14
    v_lshrrev_b32 v10, 4, v6
    v_lshl_add_u32 v14, v10, 3, v14
    v_add_u32 v14, 496, v14
    v_cmp_lt_u32 vcc, 15, v7
    s_nop 1
    v_cndmask_b32 v4, v4, v14, vcc
    v_mul_u32_u24 v14, 160, v4
    v_lshl_add_u32 v14, v5, 4, v14
    v_mul_u32_u24 v5, 205, v5
    v_lshrrev_b32 v5, 11, v5
    s_mov_b32 s33, 102240
    v_mad_u32_u24 v14, v5, s33, v14
    v_cmp_le_u32 vcc, 51200, v19
    s_nop 1
    v_cndmask_b32 v14, v14, -1, vcc
    v_add_u32 v19, 12288, v19
    s_mov_b32 s33, 0x3333334
    v_mul_hi_u32 v4, v19, s33
    v_mul_u32_u24 v5, 80, v4
    v_sub_u32 v5, v19, v5
    v_mul_u32_u24 v6, 3277, v4
    v_lshrrev_b32 v6, 16, v6
    v_mul_u32_u24 v7, 20, v6
    v_sub_u32 v7, v4, v7
    v_lshl_add_u32 v4, v6, 4, v7
    v_bfe_u32 v10, v6, 1, 3
    v_lshl_add_u32 v15, v10, 4, v7
    v_and_b32 v10, 1, v6
    v_lshl_add_u32 v15, v10, 2, v15
    v_lshrrev_b32 v10, 4, v6
    v_lshl_add_u32 v15, v10, 3, v15
    v_add_u32 v15, 496, v15
    v_cmp_lt_u32 vcc, 15, v7
    s_nop 1
    v_cndmask_b32 v4, v4, v15, vcc
    v_mul_u32_u24 v15, 160, v4
    v_lshl_add_u32 v15, v5, 4, v15
    v_mul_u32_u24 v5, 205, v5
    v_lshrrev_b32 v5, 11, v5
    s_mov_b32 s33, 102240
    v_mad_u32_u24 v15, v5, s33, v15
    v_cmp_le_u32 vcc, 51200, v19
    s_nop 1
    v_cndmask_b32 v15, v15, -1, vcc
    v_add_u32 v19, 12288, v19
    s_mov_b32 s33, 0x3333334
    v_mul_hi_u32 v4, v19, s33
    v_mul_u32_u24 v5, 80, v4
    v_sub_u32 v5, v19, v5
    v_mul_u32_u24 v6, 3277, v4
    v_lshrrev_b32 v6, 16, v6
    v_mul_u32_u24 v7, 20, v6
    v_sub_u32 v7, v4, v7
    v_lshl_add_u32 v4, v6, 4, v7
    v_bfe_u32 v10, v6, 1, 3
    v_lshl_add_u32 v16, v10, 4, v7
    v_and_b32 v10, 1, v6
    v_lshl_add_u32 v16, v10, 2, v16
    v_lshrrev_b32 v10, 4, v6
    v_lshl_add_u32 v16, v10, 3, v16
    v_add_u32 v16, 496, v16
    v_cmp_lt_u32 vcc, 15, v7
    s_nop 1
    v_cndmask_b32 v4, v4, v16, vcc
    v_mul_u32_u24 v16, 160, v4
    v_lshl_add_u32 v16, v5, 4, v16
    v_mul_u32_u24 v5, 205, v5
    v_lshrrev_b32 v5, 11, v5
    s_mov_b32 s33, 102240
    v_mad_u32_u24 v16, v5, s33, v16
    v_cmp_le_u32 vcc, 51200, v19
    s_nop 1
    v_cndmask_b32 v16, v16, -1, vcc
    v_add_u32 v19, 12288, v19
    s_mov_b32 s33, 0x3333334
    v_mul_hi_u32 v4, v19, s33
    v_mul_u32_u24 v5, 80, v4
    v_sub_u32 v5, v19, v5
    v_mul_u32_u24 v6, 3277, v4
    v_lshrrev_b32 v6, 16, v6
    v_mul_u32_u24 v7, 20, v6
    v_sub_u32 v7, v4, v7
    v_lshl_add_u32 v4, v6, 4, v7
    v_bfe_u32 v10, v6, 1, 3
    v_lshl_add_u32 v17, v10, 4, v7
    v_and_b32 v10, 1, v6
    v_lshl_add_u32 v17, v10, 2, v17
    v_lshrrev_b32 v10, 4, v6
    v_lshl_add_u32 v17, v10, 3, v17
    v_add_u32 v17, 496, v17
    v_cmp_lt_u32 vcc, 15, v7
    s_nop 1
    v_cndmask_b32 v4, v4, v17, vcc
    v_mul_u32_u24 v17, 160, v4
    v_lshl_add_u32 v17, v5, 4, v17
    v_mul_u32_u24 v5, 205, v5
    v_lshrrev_b32 v5, 11, v5
    s_mov_b32 s33, 102240
    v_mad_u32_u24 v17, v5, s33, v17
    v_cmp_le_u32 vcc, 51200, v19
    s_nop 1
    v_cndmask_b32 v17, v17, -1, vcc
    v_add_u32 v19, 12288, v19
    s_mov_b32 s33, 0x3333334
    v_mul_hi_u32 v4, v19, s33
    v_mul_u32_u24 v5, 80, v4
    v_sub_u32 v5, v19, v5
    v_mul_u32_u24 v6, 3277, v4
    v_lshrrev_b32 v6, 16, v6
    v_mul_u32_u24 v7, 20, v6
    v_sub_u32 v7, v4, v7
    v_lshl_add_u32 v4, v6, 4, v7
    v_bfe_u32 v10, v6, 1, 3
    v_lshl_add_u32 v18, v10, 4, v7
    v_and_b32 v10, 1, v6
    v_lshl_add_u32 v18, v10, 2, v18
    v_lshrrev_b32 v10, 4, v6
    v_lshl_add_u32 v18, v10, 3, v18
    v_add_u32 v18, 496, v18
    v_cmp_lt_u32 vcc, 15, v7
    s_nop 1
    v_cndmask_b32 v4, v4, v18, vcc
    v_mul_u32_u24 v18, 160, v4
    v_lshl_add_u32 v18, v5, 4, v18
    v_mul_u32_u24 v5, 205, v5
    v_lshrrev_b32 v5, 11, v5
    s_mov_b32 s33, 102240
    v_mad_u32_u24 v18, v5, s33, v18
    v_cmp_le_u32 vcc, 51200, v19
    s_nop 1
    v_cndmask_b32 v18, v18, -1, vcc
    v_add_u32 v19, 12288, v19
    s_waitcnt vmcnt(4)
    buffer_store_dwordx4 v[20:23], v14, s[48:51], 0 offen sc1
    s_waitcnt vmcnt(4)
    buffer_store_dwordx4 v[24:27], v15, s[48:51], 0 offen sc1
    s_waitcnt vmcnt(4)
    buffer_store_dwordx4 v[28:31], v16, s[48:51], 0 offen sc1
    s_waitcnt vmcnt(4)
    buffer_store_dwordx4 v[32:35], v17, s[48:51], 0 offen sc1
    s_waitcnt vmcnt(4)
    buffer_store_dwordx4 v[36:39], v18, s[48:51], 0 offen sc1
    s_cmp_lt_u32 s3, 8
    s_cbranch_scc1 sequential_preLN__sliding_block__geglu_ffn__prompt_kernel_notok14
    s_mov_b32 s44, s20
    s_and_b32 s45, s21, 0xffff
    s_mov_b32 s46, 0x100
    s_mov_b32 s47, 0x20000
    v_mov_b32 v5, 0
    s_mov_b32 s32, 0x40000
    s_nop 3
sequential_preLN__sliding_block__geglu_ffn__prompt_kernel_tok15:
    buffer_load_dword v4, v5, s[44:47], 0 offen sc1
    s_waitcnt vmcnt(0)
    v_readfirstlane_b32 s24, v4
    s_nop 0
    s_cmp_lg_u32 s24, 0
    s_cbranch_scc1 sequential_preLN__sliding_block__geglu_ffn__prompt_kernel_tokd16
    s_sub_u32 s32, s32, 1
    s_cbranch_scc1 sequential_preLN__sliding_block__geglu_ffn__prompt_kernel_tokd16
    s_sleep 2
    s_branch sequential_preLN__sliding_block__geglu_ffn__prompt_kernel_tok15
    s_nop 0
sequential_preLN__sliding_block__geglu_ffn__prompt_kernel_tokd16:
sequential_preLN__sliding_block__geglu_ffn__prompt_kernel_notok14:
    s_waitcnt vmcnt(0)
    s_barrier
    s_cmp_lg_u32 s3, 11
    s_cbranch_scc1 sequential_preLN__sliding_block__geglu_ffn__prompt_kernel_nosig17
    s_lshl_b32 s33, s35, 7
    s_add_u32 s33, s33, 32768
    v_mov_b32 v4, s24
    v_mov_b32 v5, 0
    s_mov_b64 exec, 1
    buffer_store_dword v4, v5, s[92:95], s33 offen sc1
    s_mov_b64 exec, -1
    s_nop 1
sequential_preLN__sliding_block__geglu_ffn__prompt_kernel_nosig17:
sequential_preLN__sliding_block__geglu_ffn__prompt_kernel_p1end4:
ph2:
    s_cmp_lg_u32 s3, 9
    s_cbranch_scc1 sequential_preLN__sliding_block__geglu_ffn__prompt_kernel_nocpf18
    s_mul_i32 s33, s26, 3072
    s_add_u32 s33, s33, ph3-sequential_preLN__sliding_block__geglu_ffn__prompt_kernel
    v_lshl_add_u32 v5, v1, 7, s33
    s_mov_b32 s33, sequential_preLN__sliding_block__geglu_ffn__prompt_kernel_end-sequential_preLN__sliding_block__geglu_ffn__prompt_kernel-4
    v_cmp_ge_u32 vcc, s33, v5
    s_nop 0
    s_and_b64 exec, vcc, 0xffffff
    s_cbranch_scc0 sequential_preLN__sliding_block__geglu_ffn__prompt_kernel_nocpf18
    global_load_dword v166, v5, s[96:97]
    s_nop 1
sequential_preLN__sliding_block__geglu_ffn__prompt_kernel_nocpf18:
    s_mov_b64 exec, -1
    s_and_b32 s34, s26, 7
    s_lshr_b32 s35, s26, 3
    s_lshl_b32 s33, s25, 2
    s_add_u32 s35, s35, s33
    s_cmp_ge_u32 s3, 8
    s_cbranch_scc1 sequential_preLN__sliding_block__geglu_ffn__prompt_kernel_p2_r20
    s_lshl_b32 s36, s34, 3
    s_add_u32 s36, s36, s3
    s_lshr_b32 s33, s35, 1
    s_mul_i32 s37, s33, 5
    s_and_b32 s38, s35, 1
    s_mul_i32 s33, s38, 3
    s_add_u32 s39, s37, s33
    s_lshl_b32 s39, s39, 9
    s_add_u32 s40, s37, 2
    s_lshl_b32 s40, s40, 9
    s_lshl_b32 s38, s38, 3
    v_lshlrev_b32 v4, 4, v2
    v_add_u32 v4, s38, v4
    v_lshlrev_b32 v5, 30, v3
    v_or_b32 v14, v4, v5
    v_mul_u32_u24 v5, 40960, v3
    v_lshl_add_u32 v15, v2, 4, v5
    s_mov_b32 s44, s22
    s_and_b32 s45, s23, 0xffff
    s_mov_b32 s46, 0x280000
    s_mov_b32 s47, 0x20000
    s_add_u32 s48, s22, 0x280000
    s_addc_u32 s49, s23, 0
    s_and_b32 s49, s49, 0xffff
    s_mov_b32 s50, 0x280000
    s_mov_b32 s51, 0x20000
    s_add_u32 s52, s22, 0x500000
    s_addc_u32 s53, s23, 0
    s_and_b32 s53, s53, 0xffff
    s_mov_b32 s54, 0x280000
    s_mov_b32 s55, 0x20000
    s_add_u32 s56, s22, 0x780000
    s_addc_u32 s57, s23, 0
    s_and_b32 s57, s57, 0xffff
    s_mov_b32 s58, 0x280000
    s_mov_b32 s59, 0x20000
    s_mul_i32 s41, s36, 40960
    s_lshl_b32 s42, s34, 3
    s_sub_u32 s42, s42, 8
    s_lshl_b32 s33, s3, 10
    v_add_u32 v16, s33, v13
    s_lshl_b32 s33, s3, 9
    s_add_u32 s33, s33, 16384
    v_add_u32 v17, s33, v4
    v_mul_u32_u24 v4, 320, v3
    v_lshl_add_u32 v4, v2, 4, v4
    s_mul_i32 s33, s3, 1280
    s_add_u32 s33, s33, 24576
    v_add_u32 v18, s33, v4
    v_cmp_eq_u32 vcc, 20, v2
    v_mov_b32 v5, 0x3f803f80
    s_nop 0
    v_cndmask_b32 v4, 0, v5, vcc
    v_mov_b32 v56, v4
    v_mov_b32 v57, v4
    v_mov_b32 v58, v4
    v_mov_b32 v59, v4
    v_mov_b32 v60, v4
    v_mov_b32 v61, v4
    v_mov_b32 v62, v4
    v_mov_b32 v63, v4
    v_mov_b32 v64, v4
    v_mov_b32 v65, v4
    v_mov_b32 v66, v4
    v_mov_b32 v67, v4
    v_mov_b32 v68, v4
    v_mov_b32 v69, v4
    v_mov_b32 v70, v4
    v_mov_b32 v71, v4
    v_mov_b32 v72, v4
    v_mov_b32 v73, v4
    v_mov_b32 v74, v4
    v_mov_b32 v75, v4
    v_mov_b32 v76, v4
    v_mov_b32 v77, v4
    v_mov_b32 v78, v4
    v_mov_b32 v79, v4
    v_mov_b32 v46, v5
    v_mov_b32 v50, v5
    v_mov_b32 v54, v5
    v_mov_b32 v30, 0
    v_mov_b32 v31, 0xf149
    v_lshlrev_b32 v6, 2, v3
    v_sub_u32 v6, v2, v6
    v_mov_b32 v7, 0xf149f2ca
    v_cmp_le_i32 s[60:61], 0, v6
    v_cmp_le_i32 s[62:63], 1, v6
    v_cmp_le_i32 s[64:65], 2, v6
    v_cmp_le_i32 s[66:67], 3, v6
    v_cndmask_b32 v128, v7, 0, s[60:61]
    v_cndmask_b32 v112, 0, v7, s[60:61]
    v_cndmask_b32 v129, v7, 0, s[62:63]
    v_cndmask_b32 v113, 0, v7, s[62:63]
    v_cndmask_b32 v130, v7, 0, s[64:65]
    v_cndmask_b32 v114, 0, v7, s[64:65]
    v_cndmask_b32 v131, v7, 0, s[66:67]
    v_cndmask_b32 v115, 0, v7, s[66:67]
    v_cmp_le_i32 s[60:61], 8, v6
    v_cmp_le_i32 s[62:63], 9, v6
    v_cmp_le_i32 s[64:65], 10, v6
    v_cmp_le_i32 s[66:67], 11, v6
    v_cndmask_b32 v132, v7, 0, s[60:61]
    v_cndmask_b32 v116, 0, v7, s[60:61]
    v_cndmask_b32 v133, v7, 0, s[62:63]
    v_cndmask_b32 v117, 0, v7, s[62:63]
    v_cndmask_b32 v134, v7, 0, s[64:65]
    v_cndmask_b32 v118, 0, v7, s[64:65]
    v_cndmask_b32 v135, v7, 0, s[66:67]
    v_cndmask_b32 v119, 0, v7, s[66:67]
    v_cmp_le_i32 s[60:61], 16, v6
    v_cmp_le_i32 s[62:63], 17, v6
    v_cmp_le_i32 s[64:65], 18, v6
    v_cmp_le_i32 s[66:67], 19, v6
    v_cndmask_b32 v136, v7, 0, s[60:61]
    v_cndmask_b32 v120, 0, v7, s[60:61]
    v_cndmask_b32 v137, v7, 0, s[62:63]
    v_cndmask_b32 v121, 0, v7, s[62:63]
    v_cndmask_b32 v138, v7, 0, s[64:65]
    v_cndmask_b32 v122, 0, v7, s[64:65]
    v_cndmask_b32 v139, v7, 0, s[66:67]
    v_cndmask_b32 v123, 0, v7, s[66:67]
    v_cmp_le_i32 s[60:61], 24, v6
    v_cmp_le_i32 s[62:63], 25, v6
    v_cmp_le_i32 s[64:65], 26, v6
    v_cmp_le_i32 s[66:67], 27, v6
    v_cndmask_b32 v140, v7, 0, s[60:61]
    v_cndmask_b32 v124, 0, v7, s[60:61]
    v_cndmask_b32 v141, v7, 0, s[62:63]
    v_cndmask_b32 v125, 0, v7, s[62:63]
    v_cndmask_b32 v142, v7, 0, s[64:65]
    v_cndmask_b32 v126, 0, v7, s[64:65]
    v_cndmask_b32 v143, v7, 0, s[66:67]
    v_cndmask_b32 v127, 0, v7, s[66:67]
    v_bfe_u32 v6, v1, 4, 1
    v_mul_u32_u24 v6, 20480, v6
    v_and_b32 v8, 15, v1
    v_lshl_add_u32 v6, v8, 4, v6
    v_lshl_add_u32 v19, v3, 8, v6
    v_lshlrev_b32 v8, 30, v3
    v_or_b32 v20, v6, v8
    s_lshl_b32 s68, s35, 9
    s_add_u32 s68, s68, s41
    s_and_b32 s69, s35, 15
    s_lshl_b32 s69, s69, 8
    s_lshr_b32 s33, s35, 4
    s_lshl_b32 s33, s33, 3
    s_add_u32 s69, s69, s33
    s_add_u32 s69, s69, s41
    s_add_u32 s69, s69, 16384
    s_cmp_lt_u32 s36, 8
    s_cselect_b32 s70, 0x3f80, 0
    s_cmp_lt_u32 s36, 7
    s_cselect_b32 s71, 0x3f80, 0
    s_cmp_lt_u32 s36, 6
    s_cselect_b32 s72, 0x3f80, 0
    s_cmp_lt_u32 s36, 5
    s_cselect_b32 s73, 0x3f80, 0
    s_cmp_lt_u32 s36, 4
    s_cselect_b32 s74, 0x3f80, 0
    s_cmp_lt_u32 s36, 3
    s_cselect_b32 s75, 0x3f80, 0
    s_cmp_lt_u32 s36, 2
    s_cselect_b32 s76, 0x3f80, 0
    s_cmp_lt_u32 s36, 1
    s_cselect_b32 s77, 0x3f80, 0
    s_cmp_lt_u32 s36, 0
    s_cselect_b32 s78, 0x3f80, 0
    s_barrier
    s_add_u32 s33, s41, s39
    buffer_load_dwordx4 v[24:27], v13, s[44:47], s33 offen sc1
    s_add_u32 s33, s41, s40
    buffer_load_dwordx2 v[28:29], v14, s[44:47], s33 offen sc1
    s_add_u32 s43, s42, s3
    s_max_i32 s43, s43, 0
    s_mul_i32 s43, s43, 40960
    s_add_u32 s43, s43, s39
    s_lshl_b32 s33, s3, 10
    s_add_u32 m0, s33, 0
    s_nop 0
    buffer_load_dwordx4 v13, s[48:51], s43 offen sc1 lds
    s_add_u32 s43, s42, s3
    s_add_u32 s43, s43, 8
    s_max_i32 s43, s43, 0
    s_mul_i32 s43, s43, 40960
    s_add_u32 s43, s43, s39
    s_lshl_b32 s33, s3, 10
    s_add_u32 m0, s33, 8192
    s_nop 0
    buffer_load_dwordx4 v13, s[48:51], s43 offen sc1 lds
    s_lshl_b32 s43, s3, 1
    s_add_u32 s43, s43, s42
    s_max_i32 s43, s43, 0
    s_mul_i32 s43, s43, 40960
    s_add_u32 s43, s43, s40
    s_add_u32 m0, s33, 16384
    s_nop 0
    buffer_load_dwordx4 v15, s[48:51], s43 offen sc1 lds
    s_mul_i32 s79, s35, 81920
    s_mul_i32 s43, s42, 1280
    s_add_u32 s43, s43, s79
    s_add_u32 s43, s43, s33
    s_add_u32 s80, s43, 0
    s_max_i32 s80, s80, s79
    s_add_u32 m0, s33, 24576
    s_nop 0
    buffer_load_dwordx4 v13, s[52:55], s80 offen sc1 lds
    s_add_u32 s80, s43, 8192
    s_max_i32 s80, s80, s79
    s_add_u32 m0, s33, 32768
    s_nop 0
    buffer_load_dwordx4 v13, s[52:55], s80 offen sc1 lds
    s_add_u32 s80, s43, 16384
    s_max_i32 s80, s80, s79
    s_cmp_lt_u32 s3, 4
    s_cselect_b64 exec, -1, 0
    s_cbranch_scc0 sequential_preLN__sliding_block__geglu_ffn__prompt_kernel_nov22
    s_add_u32 m0, s33, 40960
    s_nop 0
    buffer_load_dwordx4 v13, s[52:55], s80 offen sc1 lds
    s_nop 1
sequential_preLN__sliding_block__geglu_ffn__prompt_kernel_nov22:
    s_mov_b64 exec, -1
    s_waitcnt vmcnt(2)
    s_barrier
    ds_read_b128 v[32:35], v16 offset:0
    ds_read_b64 v[44:45], v17 offset:0
    v_mov_b32 v47, s70
    ds_read_b128 v[36:39], v16 offset:1024
    ds_read_b64 v[48:49], v17 offset:512
    v_mov_b32 v51, s71
    ds_read_b128 v[40:43], v16 offset:2048
    ds_read_b64 v[52:53], v17 offset:1024
    v_mov_b32 v55, s72
    s_waitcnt lgkmcnt(4)
    v_mfma_f32_32x32x16_bf16 v[80:95], v[32:35], v[24:27], v[112:127]
    v_mfma_f32_32x32x16_bf16 v[80:95], v[44:47], v[28:31], v[80:95]
    s_waitcnt lgkmcnt(2)
    v_mfma_f32_32x32x16_bf16 v[96:111], v[36:39], v[24:27], 0
    v_mfma_f32_32x32x16_bf16 v[96:111], v[48:51], v[28:31], v[96:111]
    ds_read_b128 v[32:35], v16 offset:3072
    ds_read_b64 v[44:45], v17 offset:1536
    v_mov_b32 v47, s73
    s_nop 5
    v_max3_f32 v21, v80, v81, v82
    v_max3_f32 v4, v83, v84, v85
    v_max3_f32 v21, v21, v86, v87
    v_max3_f32 v4, v4, v88, v89
    v_max3_f32 v21, v21, v90, v91
    v_max3_f32 v4, v4, v92, v93
    v_max3_f32 v21, v21, v94, v95
    s_waitcnt lgkmcnt(2)
    v_mfma_f32_32x32x16_bf16 v[80:95], v[40:43], v[24:27], 0
    v_mfma_f32_32x32x16_bf16 v[80:95], v[52:55], v[28:31], v[80:95]
    ds_read_b128 v[36:39], v16 offset:4096
    ds_read_b64 v[48:49], v17 offset:2048
    v_mov_b32 v51, s74
    v_max3_f32 v21, v21, v96, v97
    v_max3_f32 v4, v4, v98, v99
    v_max3_f32 v21, v21, v100, v101
    v_max3_f32 v4, v4, v102, v103
    v_max3_f32 v21, v21, v104, v105
    v_max3_f32 v4, v4, v106, v107
    v_max3_f32 v21, v21, v108, v109
    v_max3_f32 v4, v4, v110, v111
    s_waitcnt lgkmcnt(2)
    v_mfma_f32_32x32x16_bf16 v[96:111], v[32:35], v[24:27], 0
    v_mfma_f32_32x32x16_bf16 v[96:111], v[44:47], v[28:31], v[96:111]
    ds_read_b128 v[40:43], v16 offset:5120
    ds_read_b64 v[52:53], v17 offset:2560
    v_mov_b32 v55, s75
    v_max3_f32 v21, v21, v80, v81
    v_max3_f32 v4, v4, v82, v83
    v_max3_f32 v21, v21, v84, v85
    v_max3_f32 v4, v4, v86, v87
    v_max3_f32 v21, v21, v88, v89
    v_max3_f32 v4, v4, v90, v91
    v_max3_f32 v21, v21, v92, v93
    v_max3_f32 v4, v4, v94, v95
    s_waitcnt lgkmcnt(2)
    v_mfma_f32_32x32x16_bf16 v[80:95], v[36:39], v[24:27], 0
    v_mfma_f32_32x32x16_bf16 v[80:95], v[48:51], v[28:31], v[80:95]
    ds_read_b128 v[32:35], v16 offset:6144
    ds_read_b64 v[44:45], v17 offset:3072
    v_mov_b32 v47, s76
    v_max3_f32 v21, v21, v96, v97
    v_max3_f32 v4, v4, v98, v99
    v_max3_f32 v21, v21, v100, v101
    v_max3_f32 v4, v4, v102, v103
    v_max3_f32 v21, v21, v104, v105
    v_max3_f32 v4, v4, v106, v107
    v_max3_f32 v21, v21, v108, v109
    v_max3_f32 v4, v4, v110, v111
    s_waitcnt lgkmcnt(2)
    v_mfma_f32_32x32x16_bf16 v[96:111], v[40:43], v[24:27], 0
    v_mfma_f32_32x32x16_bf16 v[96:111], v[52:55], v[28:31], v[96:111]
    ds_read_b128 v[36:39], v16 offset:7168
    ds_read_b64 v[48:49], v17 offset:3584
    v_mov_b32 v51, s77
    v_max3_f32 v21, v21, v80, v81
    v_max3_f32 v4, v4, v82, v83
    v_max3_f32 v21, v21, v84, v85
    v_max3_f32 v4, v4, v86, v87
    v_max3_f32 v21, v21, v88, v89
    v_max3_f32 v4, v4, v90, v91
    v_max3_f32 v21, v21, v92, v93
    v_max3_f32 v4, v4, v94, v95
    s_waitcnt lgkmcnt(2)
    v_mfma_f32_32x32x16_bf16 v[80:95], v[32:35], v[24:27], 0
    v_mfma_f32_32x32x16_bf16 v[80:95], v[44:47], v[28:31], v[80:95]
    ds_read_b128 v[40:43], v16 offset:8192
    ds_read_b64 v[52:53], v17 offset:4096
    v_mov_b32 v55, s78
    v_max3_f32 v21, v21, v96, v97
    v_max3_f32 v4, v4, v98, v99
    v_max3_f32 v21, v21, v100, v101
    v_max3_f32 v4, v4, v102, v103
    v_max3_f32 v21, v21, v104, v105
    v_max3_f32 v4, v4, v106, v107
    v_max3_f32 v21, v21, v108, v109
    v_max3_f32 v4, v4, v110, v111
    s_waitcnt lgkmcnt(2)
    v_mfma_f32_32x32x16_bf16 v[96:111], v[36:39], v[24:27], 0
    v_mfma_f32_32x32x16_bf16 v[96:111], v[48:51], v[28:31], v[96:111]
    v_max3_f32 v21, v21, v80, v81
    v_max3_f32 v4, v4, v82, v83
    v_max3_f32 v21, v21, v84, v85
    v_max3_f32 v4, v4, v86, v87
    v_max3_f32 v21, v21, v88, v89
    v_max3_f32 v4, v4, v90, v91
    v_max3_f32 v21, v21, v92, v93
    v_max3_f32 v4, v4, v94, v95
    s_waitcnt lgkmcnt(0)
    v_mfma_f32_32x32x16_bf16 v[80:95], v[40:43], v[24:27], v[128:143]
    v_mfma_f32_32x32x16_bf16 v[80:95], v[52:55], v[28:31], v[80:95]
    s_nop 0
    v_max3_f32 v21, v21, v96, v97
    v_max3_f32 v4, v4, v98, v99
    v_max3_f32 v21, v21, v100, v101
    v_max3_f32 v4, v4, v102, v103
    v_max3_f32 v21, v21, v104, v105
    v_max3_f32 v4, v4, v106, v107
    v_max3_f32 v21, v21, v108, v109
    v_max3_f32 v4, v4, v110, v111
    s_nop 2
    v_max3_f32 v21, v21, v80, v81
    v_max3_f32 v4, v4, v82, v83
    v_max3_f32 v21, v21, v84, v85
    v_max3_f32 v4, v4, v86, v87
    v_max3_f32 v21, v21, v88, v89
    v_max3_f32 v4, v4, v90, v91
    v_max3_f32 v21, v21, v92, v93
    v_max3_f32 v4, v4, v94, v95
    ds_read_b128 v[32:35], v16 offset:0
    ds_read_b64 v[44:45], v17 offset:0
    v_mov_b32 v47, s70
    ds_read_b128 v[36:39], v16 offset:1024
    ds_read_b64 v[48:49], v17 offset:512
    v_mov_b32 v51, s71
    ds_read_b128 v[40:43], v16 offset:2048
    ds_read_b64 v[52:53], v17 offset:1024
    v_mov_b32 v55, s72
    s_waitcnt vmcnt(0)
    s_barrier
    s_mov_b32 exec_lo, 0x000fffff
    s_mov_b32 exec_hi, 0x000fffff
    ds_read_b128 v[56:59], v18 offset:0
    ds_read_b128 v[60:63], v18 offset:640
    s_mov_b64 exec, -1
    s_mov_b32 exec_lo, 0x000fffff
    s_mov_b32 exec_hi, 0x000fffff
    ds_read_b128 v[64:67], v18 offset:1280
    ds_read_b128 v[68:71], v18 offset:1920
    s_mov_b64 exec, -1
    v_max_f32 v21, v21, v4
    v_mov_b32 v4, v21
    s_nop 1
    v_permlane32_swap_b32 v21, v4
    v_max_f32 v21, v21, v4
    v_cvt_pk_bf16_f32 v4, -v21, -v21
    v_and_b32 v5, 0xffff0000, v4
    v_sub_f32 v6, -v21, v5
    v_cvt_pk_bf16_f32 v4, v5, v6
    v_cmp_eq_u32 vcc, 0, v3
    s_nop 1
    v_cndmask_b32 v30, 0, v4, vcc
    s_waitcnt lgkmcnt(8)
    s_cmp_lt_u32 s3, 4
    s_cbranch_scc1 sequential_preLN__sliding_block__geglu_ffn__prompt_kernel_py23
    s_setprio 1
sequential_preLN__sliding_block__geglu_ffn__prompt_kernel_py23:
    v_mfma_f32_32x32x16_bf16 v[80:95], v[32:35], v[24:27], v[112:127]
    v_mfma_f32_32x32x16_bf16 v[80:95], v[44:47], v[28:31], v[80:95]
    s_waitcnt lgkmcnt(6)
    v_mfma_f32_32x32x16_bf16 v[96:111], v[36:39], v[24:27], 0
    v_mfma_f32_32x32x16_bf16 v[96:111], v[48:51], v[28:31], v[96:111]
    ds_read_b128 v[32:35], v16 offset:3072
    ds_read_b64 v[44:45], v17 offset:1536
    v_mov_b32 v47, s73
    s_mov_b32 exec_lo, 0x000fffff
    s_mov_b32 exec_hi, 0x000fffff
    ds_read_b128 v[72:75], v18 offset:2560
    ds_read_b128 v[76:79], v18 offset:3200
    s_mov_b64 exec, -1
    s_nop 0
    v_exp_f32 v80, v80
    v_exp_f32 v81, v81
    v_exp_f32 v82, v82
    v_exp_f32 v83, v83
    v_exp_f32 v84, v84
    v_exp_f32 v85, v85
    v_exp_f32 v86, v86
    v_exp_f32 v87, v87
    v_exp_f32 v88, v88
    v_exp_f32 v89, v89
    v_exp_f32 v90, v90
    v_exp_f32 v91, v91
    v_exp_f32 v92, v92
    v_exp_f32 v93, v93
    v_exp_f32 v94, v94
    v_exp_f32 v95, v95
    v_cvt_pk_bf16_f32 v80, v80, v81
    v_cvt_pk_bf16_f32 v81, v82, v83
    v_cvt_pk_bf16_f32 v82, v84, v85
    v_cvt_pk_bf16_f32 v83, v86, v87
    v_cvt_pk_bf16_f32 v84, v88, v89
    v_cvt_pk_bf16_f32 v85, v90, v91
    v_cvt_pk_bf16_f32 v86, v92, v93
    v_cvt_pk_bf16_f32 v87, v94, v95
    s_waitcnt lgkmcnt(6)
    v_mfma_f32_32x32x16_bf16 v[144:159], v[56:59], v[80:83], 0
    v_mfma_f32_32x32x16_bf16 v[144:159], v[60:63], v[84:87], v[144:159]
    v_mfma_f32_32x32x16_bf16 v[80:95], v[40:43], v[24:27], 0
    v_mfma_f32_32x32x16_bf16 v[80:95], v[52:55], v[28:31], v[80:95]
    ds_read_b128 v[36:39], v16 offset:4096
    ds_read_b64 v[48:49], v17 offset:2048
    v_mov_b32 v51, s74
    s_mov_b32 exec_lo, 0x000fffff
    s_mov_b32 exec_hi, 0x000fffff
    ds_read_b128 v[56:59], v18 offset:3840
    ds_read_b128 v[60:63], v18 offset:4480
    s_mov_b64 exec, -1
    v_exp_f32 v96, v96
    v_exp_f32 v97, v97
    v_exp_f32 v98, v98
    v_exp_f32 v99, v99
    v_exp_f32 v100, v100
    v_exp_f32 v101, v101
    v_exp_f32 v102, v102
    v_exp_f32 v103, v103
    v_exp_f32 v104, v104
    v_exp_f32 v105, v105
    v_exp_f32 v106, v106
    v_exp_f32 v107, v107
    v_exp_f32 v108, v108
    v_exp_f32 v109, v109
    v_exp_f32 v110, v110
    v_exp_f32 v111, v111
    v_cvt_pk_bf16_f32 v96, v96, v97
    v_cvt_pk_bf16_f32 v97, v98, v99
    v_cvt_pk_bf16_f32 v98, v100, v101
    v_cvt_pk_bf16_f32 v99, v102, v103
    v_cvt_pk_bf16_f32 v100, v104, v105
    v_cvt_pk_bf16_f32 v101, v106, v107
    v_cvt_pk_bf16_f32 v102, v108, v109
    v_cvt_pk_bf16_f32 v103, v110, v111
    s_waitcnt lgkmcnt(8)
    v_mfma_f32_32x32x16_bf16 v[144:159], v[64:67], v[96:99], v[144:159]
    v_mfma_f32_32x32x16_bf16 v[144:159], v[68:71], v[100:103], v[144:159]
    s_waitcnt lgkmcnt(6)
    v_mfma_f32_32x32x16_bf16 v[96:111], v[32:35], v[24:27], 0
    v_mfma_f32_32x32x16_bf16 v[96:111], v[44:47], v[28:31], v[96:111]
    ds_read_b128 v[40:43], v16 offset:5120
    ds_read_b64 v[52:53], v17 offset:2560
    v_mov_b32 v55, s75
    s_mov_b32 exec_lo, 0x000fffff
    s_mov_b32 exec_hi, 0x000fffff
    ds_read_b128 v[64:67], v18 offset:5120
    ds_read_b128 v[68:71], v18 offset:5760
    s_mov_b64 exec, -1
    v_exp_f32 v80, v80
    v_exp_f32 v81, v81
    v_exp_f32 v82, v82
    v_exp_f32 v83, v83
    v_exp_f32 v84, v84
    v_exp_f32 v85, v85
    v_exp_f32 v86, v86
    v_exp_f32 v87, v87
    v_exp_f32 v88, v88
    v_exp_f32 v89, v89
    v_exp_f32 v90, v90
    v_exp_f32 v91, v91
    v_exp_f32 v92, v92
    v_exp_f32 v93, v93
    v_exp_f32 v94, v94
    v_exp_f32 v95, v95
    v_cvt_pk_bf16_f32 v80, v80, v81
    v_cvt_pk_bf16_f32 v81, v82, v83
    v_cvt_pk_bf16_f32 v82, v84, v85
    v_cvt_pk_bf16_f32 v83, v86, v87
    v_cvt_pk_bf16_f32 v84, v88, v89
    v_cvt_pk_bf16_f32 v85, v90, v91
    v_cvt_pk_bf16_f32 v86, v92, v93
    v_cvt_pk_bf16_f32 v87, v94, v95
    s_waitcnt lgkmcnt(8)
    v_mfma_f32_32x32x16_bf16 v[144:159], v[72:75], v[80:83], v[144:159]
    v_mfma_f32_32x32x16_bf16 v[144:159], v[76:79], v[84:87], v[144:159]
    s_waitcnt lgkmcnt(6)
    v_mfma_f32_32x32x16_bf16 v[80:95], v[36:39], v[24:27], 0
    v_mfma_f32_32x32x16_bf16 v[80:95], v[48:51], v[28:31], v[80:95]
    ds_read_b128 v[32:35], v16 offset:6144
    ds_read_b64 v[44:45], v17 offset:3072
    v_mov_b32 v47, s76
    s_mov_b32 exec_lo, 0x000fffff
    s_mov_b32 exec_hi, 0x000fffff
    ds_read_b128 v[72:75], v18 offset:6400
    ds_read_b128 v[76:79], v18 offset:7040
    s_mov_b64 exec, -1
    v_exp_f32 v96, v96
    v_exp_f32 v97, v97
    v_exp_f32 v98, v98
    v_exp_f32 v99, v99
    v_exp_f32 v100, v100
    v_exp_f32 v101, v101
    v_exp_f32 v102, v102
    v_exp_f32 v103, v103
    v_exp_f32 v104, v104
    v_exp_f32 v105, v105
    v_exp_f32 v106, v106
    v_exp_f32 v107, v107
    v_exp_f32 v108, v108
    v_exp_f32 v109, v109
    v_exp_f32 v110, v110
    v_exp_f32 v111, v111
    v_cvt_pk_bf16_f32 v96, v96, v97
    v_cvt_pk_bf16_f32 v97, v98, v99
    v_cvt_pk_bf16_f32 v98, v100, v101
    v_cvt_pk_bf16_f32 v99, v102, v103
    v_cvt_pk_bf16_f32 v100, v104, v105
    v_cvt_pk_bf16_f32 v101, v106, v107
    v_cvt_pk_bf16_f32 v102, v108, v109
    v_cvt_pk_bf16_f32 v103, v110, v111
    s_waitcnt lgkmcnt(8)
    v_mfma_f32_32x32x16_bf16 v[144:159], v[56:59], v[96:99], v[144:159]
    v_mfma_f32_32x32x16_bf16 v[144:159], v[60:63], v[100:103], v[144:159]
    s_waitcnt lgkmcnt(6)
    v_mfma_f32_32x32x16_bf16 v[96:111], v[40:43], v[24:27], 0
    v_mfma_f32_32x32x16_bf16 v[96:111], v[52:55], v[28:31], v[96:111]
    ds_read_b128 v[36:39], v16 offset:7168
    ds_read_b64 v[48:49], v17 offset:3584
    v_mov_b32 v51, s77
    s_mov_b32 exec_lo, 0x000fffff
    s_mov_b32 exec_hi, 0x000fffff
    ds_read_b128 v[56:59], v18 offset:7680
    ds_read_b128 v[60:63], v18 offset:8320
    s_mov_b64 exec, -1
    v_exp_f32 v80, v80
    v_exp_f32 v81, v81
    v_exp_f32 v82, v82
    v_exp_f32 v83, v83
    v_exp_f32 v84, v84
    v_exp_f32 v85, v85
    v_exp_f32 v86, v86
    v_exp_f32 v87, v87
    v_exp_f32 v88, v88
    v_exp_f32 v89, v89
    v_exp_f32 v90, v90
    v_exp_f32 v91, v91
    v_exp_f32 v92, v92
    v_exp_f32 v93, v93
    v_exp_f32 v94, v94
    v_exp_f32 v95, v95
    v_cvt_pk_bf16_f32 v80, v80, v81
    v_cvt_pk_bf16_f32 v81, v82, v83
    v_cvt_pk_bf16_f32 v82, v84, v85
    v_cvt_pk_bf16_f32 v83, v86, v87
    v_cvt_pk_bf16_f32 v84, v88, v89
    v_cvt_pk_bf16_f32 v85, v90, v91
    v_cvt_pk_bf16_f32 v86, v92, v93
    v_cvt_pk_bf16_f32 v87, v94, v95
    s_waitcnt lgkmcnt(8)
    v_mfma_f32_32x32x16_bf16 v[144:159], v[64:67], v[80:83], v[144:159]
    v_mfma_f32_32x32x16_bf16 v[144:159], v[68:71], v[84:87], v[144:159]
    s_setprio 0
    s_waitcnt lgkmcnt(6)
    v_mfma_f32_32x32x16_bf16 v[80:95], v[32:35], v[24:27], 0
    v_mfma_f32_32x32x16_bf16 v[80:95], v[44:47], v[28:31], v[80:95]
    ds_read_b128 v[40:43], v16 offset:8192
    ds_read_b64 v[52:53], v17 offset:4096
    v_mov_b32 v55, s78
    s_mov_b32 exec_lo, 0x000fffff
    s_mov_b32 exec_hi, 0x000fffff
    ds_read_b128 v[64:67], v18 offset:8960
    ds_read_b128 v[68:71], v18 offset:9600
    s_mov_b64 exec, -1
    v_exp_f32 v96, v96
    v_exp_f32 v97, v97
    v_exp_f32 v98, v98
    v_exp_f32 v99, v99
    v_exp_f32 v100, v100
    v_exp_f32 v101, v101
    v_exp_f32 v102, v102
    v_exp_f32 v103, v103
    v_exp_f32 v104, v104
    v_exp_f32 v105, v105
    v_exp_f32 v106, v106
    v_exp_f32 v107, v107
    v_exp_f32 v108, v108
    v_exp_f32 v109, v109
    v_exp_f32 v110, v110
    v_exp_f32 v111, v111
    v_cvt_pk_bf16_f32 v96, v96, v97
    v_cvt_pk_bf16_f32 v97, v98, v99
    v_cvt_pk_bf16_f32 v98, v100, v101
    v_cvt_pk_bf16_f32 v99, v102, v103
    v_cvt_pk_bf16_f32 v100, v104, v105
    v_cvt_pk_bf16_f32 v101, v106, v107
    v_cvt_pk_bf16_f32 v102, v108, v109
    v_cvt_pk_bf16_f32 v103, v110, v111
    s_waitcnt lgkmcnt(8)
    v_mfma_f32_32x32x16_bf16 v[144:159], v[72:75], v[96:99], v[144:159]
    v_mfma_f32_32x32x16_bf16 v[144:159], v[76:79], v[100:103], v[144:159]
    s_waitcnt lgkmcnt(6)
    v_mfma_f32_32x32x16_bf16 v[96:111], v[36:39], v[24:27], 0
    v_mfma_f32_32x32x16_bf16 v[96:111], v[48:51], v[28:31], v[96:111]
    s_mov_b32 exec_lo, 0x000fffff
    s_mov_b32 exec_hi, 0x000fffff
    ds_read_b128 v[72:75], v18 offset:10240
    ds_read_b128 v[76:79], v18 offset:10880
    s_mov_b64 exec, -1
    v_exp_f32 v80, v80
    v_exp_f32 v81, v81
    v_exp_f32 v82, v82
    v_exp_f32 v83, v83
    v_exp_f32 v84, v84
    v_exp_f32 v85, v85
    v_exp_f32 v86, v86
    v_exp_f32 v87, v87
    v_exp_f32 v88, v88
    v_exp_f32 v89, v89
    v_exp_f32 v90, v90
    v_exp_f32 v91, v91
    v_exp_f32 v92, v92
    v_exp_f32 v93, v93
    v_exp_f32 v94, v94
    v_exp_f32 v95, v95
    v_cvt_pk_bf16_f32 v80, v80, v81
    v_cvt_pk_bf16_f32 v81, v82, v83
    v_cvt_pk_bf16_f32 v82, v84, v85
    v_cvt_pk_bf16_f32 v83, v86, v87
    v_cvt_pk_bf16_f32 v84, v88, v89
    v_cvt_pk_bf16_f32 v85, v90, v91
    v_cvt_pk_bf16_f32 v86, v92, v93
    v_cvt_pk_bf16_f32 v87, v94, v95
    s_waitcnt lgkmcnt(6)
    v_mfma_f32_32x32x16_bf16 v[144:159], v[56:59], v[80:83], v[144:159]
    v_mfma_f32_32x32x16_bf16 v[144:159], v[60:63], v[84:87], v[144:159]
    s_waitcnt lgkmcnt(4)
    v_mfma_f32_32x32x16_bf16 v[80:95], v[40:43], v[24:27], v[128:143]
    v_mfma_f32_32x32x16_bf16 v[80:95], v[52:55], v[28:31], v[80:95]
    v_exp_f32 v96, v96
    v_exp_f32 v97, v97
    v_exp_f32 v98, v98
    v_exp_f32 v99, v99
    v_exp_f32 v100, v100
    v_exp_f32 v101, v101
    v_exp_f32 v102, v102
    v_exp_f32 v103, v103
    v_exp_f32 v104, v104
    v_exp_f32 v105, v105
    v_exp_f32 v106, v106
    v_exp_f32 v107, v107
    v_exp_f32 v108, v108
    v_exp_f32 v109, v109
    v_exp_f32 v110, v110
    v_exp_f32 v111, v111
    v_cvt_pk_bf16_f32 v96, v96, v97
    v_cvt_pk_bf16_f32 v97, v98, v99
    v_cvt_pk_bf16_f32 v98, v100, v101
    v_cvt_pk_bf16_f32 v99, v102, v103
    v_cvt_pk_bf16_f32 v100, v104, v105
    v_cvt_pk_bf16_f32 v101, v106, v107
    v_cvt_pk_bf16_f32 v102, v108, v109
    v_cvt_pk_bf16_f32 v103, v110, v111
    s_waitcnt lgkmcnt(2)
    v_mfma_f32_32x32x16_bf16 v[144:159], v[64:67], v[96:99], v[144:159]
    v_mfma_f32_32x32x16_bf16 v[144:159], v[68:71], v[100:103], v[144:159]
    v_exp_f32 v80, v80
    v_exp_f32 v81, v81
    v_exp_f32 v82, v82
    v_exp_f32 v83, v83
    v_exp_f32 v84, v84
    v_exp_f32 v85, v85
    v_exp_f32 v86, v86
    v_exp_f32 v87, v87
    v_exp_f32 v88, v88
    v_exp_f32 v89, v89
    v_exp_f32 v90, v90
    v_exp_f32 v91, v91
    v_exp_f32 v92, v92
    v_exp_f32 v93, v93
    v_exp_f32 v94, v94
    v_exp_f32 v95, v95
    v_cvt_pk_bf16_f32 v80, v80, v81
    v_cvt_pk_bf16_f32 v81, v82, v83
    v_cvt_pk_bf16_f32 v82, v84, v85
    v_cvt_pk_bf16_f32 v83, v86, v87
    v_cvt_pk_bf16_f32 v84, v88, v89
    v_cvt_pk_bf16_f32 v85, v90, v91
    v_cvt_pk_bf16_f32 v86, v92, v93
    v_cvt_pk_bf16_f32 v87, v94, v95
    s_waitcnt lgkmcnt(0)
    v_mfma_f32_32x32x16_bf16 v[144:159], v[72:75], v[80:83], v[144:159]
    v_mfma_f32_32x32x16_bf16 v[144:159], v[76:79], v[84:87], v[144:159]
    s_nop 11
    v_mov_b32 v4, v152
    v_mov_b32 v5, v152
    s_nop 1
    v_permlane32_swap_b32 v4, v5
    v_rcp_f32 v5, v5
    s_nop 0
    v_mul_f32 v144, v5, v144
    v_mul_f32 v145, v5, v145
    v_mul_f32 v146, v5, v146
    v_mul_f32 v147, v5, v147
    v_mul_f32 v148, v5, v148
    v_mul_f32 v149, v5, v149
    v_mul_f32 v150, v5, v150
    v_mul_f32 v151, v5, v151
    v_mul_f32 v152, v5, v152
    v_mul_f32 v153, v5, v153
    v_mul_f32 v154, v5, v154
    v_mul_f32 v155, v5, v155
    v_cvt_pk_bf16_f32 v144, v144, v145
    v_cvt_pk_bf16_f32 v145, v146, v147
    v_cvt_pk_bf16_f32 v146, v148, v149
    v_cvt_pk_bf16_f32 v147, v150, v151
    v_cvt_pk_bf16_f32 v148, v152, v153
    v_cvt_pk_bf16_f32 v149, v154, v155
    buffer_store_dwordx4 v[144:147], v19, s[56:59], s68 offen sc1
    buffer_store_dwordx2 v[148:149], v20, s[56:59], s69 offen sc1
    s_waitcnt vmcnt(0)
    s_setprio 0
    s_barrier
    s_branch sequential_preLN__sliding_block__geglu_ffn__prompt_kernel_p2_join21
    s_nop 0
sequential_preLN__sliding_block__geglu_ffn__prompt_kernel_p2_r20:
    s_mov_b32 s44, s16
    s_and_b32 s45, s17, 0xffff
    s_mov_b32 s46, 0x21c000
    s_mov_b32 s47, 0x20000
    s_add_u32 s48, s22, 0x1488000
    s_addc_u32 s49, s23, 0
    s_and_b32 s49, s49, 0xffff
    s_mov_b32 s50, 0x21c000
    s_mov_b32 s51, 0x20000
    s_add_u32 s52, s22, 0x13c0000
    s_addc_u32 s53, s23, 0
    s_and_b32 s53, s53, 0xffff
    s_mov_b32 s54, 0xc8000
    s_mov_b32 s55, 0x20000
    s_sub_u32 s38, s3, 8
    s_lshl_b32 s38, s38, 8
    s_add_u32 s38, s38, s2
    s_and_b32 s39, s13, 0xffff
    s_and_b32 s40, s15, 0xffff
    s_sub_u32 s41, s38, 270
    s_cmp_lt_u32 s38, 270
    s_cselect_b32 s56, s12, s14
    s_cselect_b32 s57, s39, s40
    s_cselect_b32 s38, s38, s41
    s_min_u32 s38, s38, 270
    s_cmp_ge_u32 s3, 11
    s_cselect_b32 s58, 0, 2211840
    s_mov_b32 s59, 0x20000
    s_lshl_b32 s38, s38, 13
    v_lshlrev_b32 v9, 7, v1
    buffer_load_dword v166, v9, s[56:59], s38 offen
    s_cmp_lg_u32 s3, 11
    s_cbranch_scc1 sequential_preLN__sliding_block__geglu_ffn__prompt_kernel_sj24
    s_lshl_b32 s36, s34, 12
    s_sub_u32 s36, s36, 4096
    s_cmp_eq_u32 s34, 0
    s_cselect_b32 s36, 0, s36
    s_cselect_b32 s37, 0, 0x7fff7fff
    s_mov_b32 s30, 0x7fff7fff
    s_mov_b32 s31, s37
    s_mov_b32 s32, 0x40000
    v_lshlrev_b32 v8, 7, v1
    s_mov_b64 exec, s[30:31]
    s_nop 3
sequential_preLN__sliding_block__geglu_ffn__prompt_kernel_poll25:
    buffer_load_dword v4, v8, s[92:95], s36 offen sc1
    s_waitcnt vmcnt(0)
    v_xor_b32 v4, s24, v4
    v_cmp_ne_u32 vcc, 0, v4
    s_nop 0
    s_and_b64 s[28:29], vcc, s[30:31]
    s_cbranch_scc0 sequential_preLN__sliding_block__geglu_ffn__prompt_kernel_pdone26
    s_sub_u32 s32, s32, 1
    s_cbranch_scc1 sequential_preLN__sliding_block__geglu_ffn__prompt_kernel_pdone26
    s_sleep 1
    s_branch sequential_preLN__sliding_block__geglu_ffn__prompt_kernel_poll25
    s_nop 0
sequential_preLN__sliding_block__geglu_ffn__prompt_kernel_pdone26:
    s_mov_b64 exec, -1
    s_nop 0
sequential_preLN__sliding_block__geglu_ffn__prompt_kernel_sj24:
    s_barrier
    s_lshl_b32 s36, s2, 2
    s_add_u32 s36, s36, s3
    s_sub_u32 s36, s36, 8
    s_lshl_b32 s37, s36, 6
    v_add_u32 v17, s37, v1
    s_mov_b32 s33, 0x3333334
    v_mul_hi_u32 v4, v17, s33
    v_mul_u32_u24 v5, 80, v4
    v_sub_u32 v5, v17, v5
    v_mul_u32_u24 v14, 160, v4
    v_lshl_add_u32 v14, v5, 4, v14
    v_mul_u32_u24 v5, 205, v5
    v_lshrrev_b32 v5, 11, v5
    s_mov_b32 s33, 276320
    v_mad_u32_u24 v14, v5, s33, v14
    v_cmp_le_u32 vcc, 138240, v17
    s_nop 1
    v_cndmask_b32 v14, v14, -1, vcc
    v_add_u32 v17, 65536, v17
    s_mov_b32 s33, 0x3333334
    v_mul_hi_u32 v4, v17, s33
    v_mul_u32_u24 v5, 80, v4
    v_sub_u32 v5, v17, v5
    v_mul_u32_u24 v15, 160, v4
    v_lshl_add_u32 v15, v5, 4, v15
    v_mul_u32_u24 v5, 205, v5
    v_lshrrev_b32 v5, 11, v5
    s_mov_b32 s33, 276320
    v_mad_u32_u24 v15, v5, s33, v15
    v_cmp_le_u32 vcc, 138240, v17
    s_nop 1
    v_cndmask_b32 v15, v15, -1, vcc
    v_add_u32 v17, 65536, v17
    s_mov_b32 s33, 0x3333334
    v_mul_hi_u32 v4, v17, s33
    v_mul_u32_u24 v5, 80, v4
    v_sub_u32 v5, v17, v5
    v_mul_u32_u24 v16, 160, v4
    v_lshl_add_u32 v16, v5, 4, v16
    v_mul_u32_u24 v5, 205, v5
    v_lshrrev_b32 v5, 11, v5
    s_mov_b32 s33, 276320
    v_mad_u32_u24 v16, v5, s33, v16
    v_cmp_le_u32 vcc, 138240, v17
    s_nop 1
    v_cndmask_b32 v16, v16, -1, vcc
    v_add_u32 v17, 65536, v17
    s_lshl_b32 s37, s36, 10
    s_barrier
    s_add_u32 s33, s37, 0
    s_min_u32 s33, s33, 2211840
    buffer_load_dwordx4 v[20:23], v13, s[44:47], s33 offen
    s_add_u32 s33, s37, 1048576
    s_min_u32 s33, s33, 2211840
    buffer_load_dwordx4 v[24:27], v13, s[44:47], s33 offen
    s_add_u32 s33, s37, 2097152
    s_min_u32 s33, s33, 2211840
    buffer_load_dwordx4 v[28:31], v13, s[44:47], s33 offen
    s_barrier
    s_waitcnt vmcnt(2)
    buffer_store_dwordx4 v[20:23], v14, s[48:51], 0 offen sc1
    s_waitcnt vmcnt(2)
    buffer_store_dwordx4 v[24:27], v15, s[48:51], 0 offen sc1
    s_waitcnt vmcnt(2)
    buffer_store_dwordx4 v[28:31], v16, s[48:51], 0 offen sc1
    s_mov_b32 s38, 32768
    s_mov_b32 s30, 0xffff
    s_mov_b32 s31, 0
    s_mov_b32 s32, 0x40000
    v_lshlrev_b32 v8, 7, v1
    s_mov_b64 exec, s[30:31]
    s_nop 3
sequential_preLN__sliding_block__geglu_ffn__prompt_kernel_poll28:
    buffer_load_dword v4, v8, s[92:95], s38 offen sc1
    s_waitcnt vmcnt(0)
    v_xor_b32 v4, s24, v4
    v_cmp_ne_u32 vcc, 0, v4
    s_nop 0
    s_and_b64 s[28:29], vcc, s[30:31]
    s_cbranch_scc0 sequential_preLN__sliding_block__geglu_ffn__prompt_kernel_pdone29
    s_sub_u32 s32, s32, 1
    s_cbranch_scc1 sequential_preLN__sliding_block__geglu_ffn__prompt_kernel_pdone29
    s_sleep 1
    s_branch sequential_preLN__sliding_block__geglu_ffn__prompt_kernel_poll28
    s_nop 0
sequential_preLN__sliding_block__geglu_ffn__prompt_kernel_pdone29:
    s_mov_b64 exec, -1
    s_and_b32 s38, s26, 7
    s_mul_i32 s38, s38, 102400
    s_sub_u32 s39, s3, 8
    s_lshl_b32 s39, s39, 10
    s_add_u32 s38, s38, s39
    s_add_u32 m0, s39, 45056
    s_add_u32 s33, s38, 0
    buffer_load_dwordx4 v13, s[52:55], s33 offen sc1 lds
    s_add_u32 m0, s39, 49152
    s_add_u32 s33, s38, 4096
    buffer_load_dwordx4 v13, s[52:55], s33 offen sc1 lds
    s_add_u32 m0, s39, 53248
    s_add_u32 s33, s38, 8192
    buffer_load_dwordx4 v13, s[52:55], s33 offen sc1 lds
    s_add_u32 m0, s39, 57344
    s_add_u32 s33, s38, 12288
    buffer_load_dwordx4 v13, s[52:55], s33 offen sc1 lds
    s_add_u32 m0, s39, 61440
    s_add_u32 s33, s38, 16384
    buffer_load_dwordx4 v13, s[52:55], s33 offen sc1 lds
    s_add_u32 m0, s39, 65536
    s_add_u32 s33, s38, 20480
    buffer_load_dwordx4 v13, s[52:55], s33 offen sc1 lds
    s_add_u32 m0, s39, 69632
    s_add_u32 s33, s38, 24576
    buffer_load_dwordx4 v13, s[52:55], s33 offen sc1 lds
    s_add_u32 m0, s39, 73728
    s_add_u32 s33, s38, 28672
    buffer_load_dwordx4 v13, s[52:55], s33 offen sc1 lds
    s_add_u32 m0, s39, 77824
    s_add_u32 s33, s38, 32768
    buffer_load_dwordx4 v13, s[52:55], s33 offen sc1 lds
    s_add_u32 m0, s39, 81920
    s_add_u32 s33, s38, 36864
    buffer_load_dwordx4 v13, s[52:55], s33 offen sc1 lds
    s_add_u32 m0, s39, 86016
    s_add_u32 s33, s38, 40960
    buffer_load_dwordx4 v13, s[52:55], s33 offen sc1 lds
    s_add_u32 m0, s39, 90112
    s_add_u32 s33, s38, 45056
    buffer_load_dwordx4 v13, s[52:55], s33 offen sc1 lds
    s_add_u32 m0, s39, 94208
    s_add_u32 s33, s38, 49152
    buffer_load_dwordx4 v13, s[52:55], s33 offen sc1 lds
    s_add_u32 m0, s39, 98304
    s_add_u32 s33, s38, 53248
    buffer_load_dwordx4 v13, s[52:55], s33 offen sc1 lds
    s_add_u32 m0, s39, 102400
    s_add_u32 s33, s38, 57344
    buffer_load_dwordx4 v13, s[52:55], s33 offen sc1 lds
    s_add_u32 m0, s39, 106496
    s_add_u32 s33, s38, 61440
    buffer_load_dwordx4 v13, s[52:55], s33 offen sc1 lds
    s_add_u32 m0, s39, 110592
    s_add_u32 s33, s38, 65536
    buffer_load_dwordx4 v13, s[52:55], s33 offen sc1 lds
    s_add_u32 m0, s39, 114688
    s_add_u32 s33, s38, 69632
    buffer_load_dwordx4 v13, s[52:55], s33 offen sc1 lds
    s_add_u32 m0, s39, 118784
    s_add_u32 s33, s38, 73728
    buffer_load_dwordx4 v13, s[52:55], s33 offen sc1 lds
    s_add_u32 m0, s39, 122880
    s_add_u32 s33, s38, 77824
    buffer_load_dwordx4 v13, s[52:55], s33 offen sc1 lds
    s_add_u32 m0, s39, 126976
    s_add_u32 s33, s38, 81920
    buffer_load_dwordx4 v13, s[52:55], s33 offen sc1 lds
    s_add_u32 m0, s39, 131072
    s_add_u32 s33, s38, 86016
    buffer_load_dwordx4 v13, s[52:55], s33 offen sc1 lds
    s_add_u32 m0, s39, 135168
    s_add_u32 s33, s38, 90112
    buffer_load_dwordx4 v13, s[52:55], s33 offen sc1 lds
    s_add_u32 m0, s39, 139264
    s_add_u32 s33, s38, 94208
    buffer_load_dwordx4 v13, s[52:55], s33 offen sc1 lds
    s_add_u32 m0, s39, 143360
    s_add_u32 s33, s38, 98304
    buffer_load_dwordx4 v13, s[52:55], s33 offen sc1 lds
    s_waitcnt vmcnt(0)
    s_barrier
    s_cmp_lg_u32 s3, 11
    s_cbranch_scc1 sequential_preLN__sliding_block__geglu_ffn__prompt_kernel_nosig30
    s_lshl_b32 s33, s34, 5
    s_add_u32 s33, s33, s35
    s_lshl_b32 s33, s33, 7
    s_add_u32 s33, s33, 65536
    v_mov_b32 v4, s24
    v_mov_b32 v5, 0
    s_mov_b64 exec, 1
    buffer_store_dword v4, v5, s[92:95], s33 offen sc1
    s_mov_b64 exec, -1
    s_nop 1
sequential_preLN__sliding_block__geglu_ffn__prompt_kernel_nosig30:
sequential_preLN__sliding_block__geglu_ffn__prompt_kernel_p2_join21:
ph3:
    s_cmp_lg_u32 s3, 9
    s_cbranch_scc1 sequential_preLN__sliding_block__geglu_ffn__prompt_kernel_nocpf31
    s_mul_i32 s33, s26, 3072
    s_add_u32 s33, s33, ph4-sequential_preLN__sliding_block__geglu_ffn__prompt_kernel
    v_lshl_add_u32 v5, v1, 7, s33
    s_mov_b32 s33, sequential_preLN__sliding_block__geglu_ffn__prompt_kernel_end-sequential_preLN__sliding_block__geglu_ffn__prompt_kernel-4
    v_cmp_ge_u32 vcc, s33, v5
    s_nop 0
    s_and_b64 exec, vcc, 0xffffff
    s_cbranch_scc0 sequential_preLN__sliding_block__geglu_ffn__prompt_kernel_nocpf31
    global_load_dword v166, v5, s[96:97]
    s_nop 1
sequential_preLN__sliding_block__geglu_ffn__prompt_kernel_nocpf31:
    s_mov_b64 exec, -1
    s_lshr_b32 s34, s26, 3
    s_and_b32 s35, s26, 7
    s_lshl_b32 s36, s25, 2
    s_add_u32 s36, s36, s34
    s_cmp_ge_u32 s3, 8
    s_cbranch_scc1 sequential_preLN__sliding_block__geglu_ffn__prompt_kernel_p3_r34
    s_cmp_ge_u32 s3, 4
    s_cbranch_scc1 sequential_preLN__sliding_block__geglu_ffn__prompt_kernel_p3_r33
    s_lshl_b32 s37, s36, 2
    s_add_u32 s37, s37, s3
    s_mul_i32 s38, s37, 20480
    s_mul_i32 s39, s35, 160
    v_mul_u32_u24 v5, 6554, v1
    v_lshrrev_b32 v5, 16, v5
    v_mul_u32_u24 v6, 10, v5
    v_sub_u32 v6, v1, v6
    v_mul_u32_u24 v5, 1280, v5
    v_lshl_add_u32 v14, v6, 4, v5
    v_add_u32 v4, 64, v1
    v_mul_u32_u24 v5, 6554, v4
    v_lshrrev_b32 v5, 16, v5
    v_mul_u32_u24 v6, 10, v5
    v_sub_u32 v6, v4, v6
    v_mul_u32_u24 v5, 1280, v5
    v_lshl_add_u32 v15, v6, 4, v5
    v_add_u32 v4, 128, v1
    v_mul_u32_u24 v5, 6554, v4
    v_lshrrev_b32 v5, 16, v5
    v_mul_u32_u24 v6, 10, v5
    v_sub_u32 v6, v4, v6
    v_mul_u32_u24 v5, 1280, v5
    v_lshl_add_u32 v16, v6, 4, v5
    s_add_u32 s44, s22, 0x780000
    s_addc_u32 s45, s23, 0
    s_and_b32 s45, s45, 0xffff
    s_mov_b32 s46, 0x280000
    s_mov_b32 s47, 0x20000
    s_mov_b32 s48, s4
    s_and_b32 s49, s5, 0xffff
    s_mov_b32 s50, 0x280000
    s_mov_b32 s51, 0x20000
    s_add_u32 s56, s22, 0xc80000
    s_addc_u32 s57, s23, 0
    s_and_b32 s57, s57, 0xffff
    s_mov_b32 s58, 0x20000
    s_mov_b32 s59, 0x20000
    s_add_u32 s52, s22, 0xa00000
    s_addc_u32 s53, s23, 0
    s_and_b32 s53, s53, 0xffff
    s_mov_b32 s54, 0x280000
    s_mov_b32 s55, 0x20000
    s_mul_i32 s40, s3, 2560
    s_add_u32 s40, s40, 147456
    v_and_b32 v8, 15, v1
    v_lshrrev_b32 v9, 4, v1
    v_lshrrev_b32 v4, 1, v9
    v_lshlrev_b32 v4, 9, v4
    v_lshl_add_u32 v4, v8, 4, v4
    v_and_b32 v5, 1, v9
    v_lshl_add_u32 v20, v5, 3, v4
    v_lshl_add_u32 v23, v5, 10, v4
    s_lshr_b32 s41, s37, 1
    s_mul_i32 s41, s41, 40960
    s_and_b32 s33, s37, 1
    s_lshl_b32 s33, s33, 8
    s_add_u32 s41, s41, s33
    s_mul_i32 s33, s35, 5120
    s_add_u32 s41, s41, s33
    s_mul_i32 s42, s37, 20480
    s_add_u32 s42, s42, s39
    v_bfe_u32 v4, v1, 2, 2
    v_and_b32 v5, 3, v1
    v_lshrrev_b32 v6, 1, v9
    v_and_b32 v7, 1, v9
    v_lshlrev_b32 v6, 4, v6
    v_lshl_add_u32 v6, v7, 2, v6
    v_add_u32 v6, v6, v4
    v_mul_u32_u24 v6, 160, v6
    v_lshl_add_u32 v17, v5, 3, v6
    v_add_u32 v18, 65536, v17
    v_add_u32 v19, 131072, v17
    v_mul_u32_u24 v4, 160, v8
    v_lshl_add_u32 v4, v9, 3, v4
    v_add_u32 v21, s40, v4
    v_add_u32 v22, s40, v13
    s_add_u32 m0, s40, 0
    s_nop 0
    buffer_load_dwordx4 v14, s[48:51], s42 offen lds
    s_add_u32 m0, s40, 1024
    s_nop 0
    buffer_load_dwordx4 v15, s[48:51], s42 offen lds
    s_add_u32 m0, s40, 2048
    s_mov_b32 exec_hi, 0
    buffer_load_dwordx4 v16, s[48:51], s42 offen lds
    s_mov_b64 exec, -1
    s_barrier
    s_add_u32 s33, s38, 0
    buffer_load_dwordx4 v[24:27], v13, s[44:47], s33 offen sc1
    s_add_u32 s33, s38, 1024
    buffer_load_dwordx4 v[28:31], v13, s[44:47], s33 offen sc1
    s_add_u32 s33, s38, 2048
    buffer_load_dwordx4 v[32:35], v13, s[44:47], s33 offen sc1
    s_add_u32 s33, s38, 3072
    buffer_load_dwordx4 v[36:39], v13, s[44:47], s33 offen sc1
    s_add_u32 s33, s38, 4096
    buffer_load_dwordx4 v[40:43], v13, s[44:47], s33 offen sc1
    s_add_u32 s33, s38, 5120
    buffer_load_dwordx4 v[44:47], v13, s[44:47], s33 offen sc1
    s_add_u32 s33, s38, 6144
    buffer_load_dwordx4 v[48:51], v13, s[44:47], s33 offen sc1
    s_add_u32 s33, s38, 7168
    buffer_load_dwordx4 v[52:55], v13, s[44:47], s33 offen sc1
    s_add_u32 s33, s38, 8192
    buffer_load_dwordx4 v[56:59], v13, s[44:47], s33 offen sc1
    s_add_u32 s33, s38, 9216
    buffer_load_dwordx4 v[60:63], v13, s[44:47], s33 offen sc1
    ds_read_b64_tr_b16 v[72:73], v17 offset:45056
    ds_read_b64_tr_b16 v[74:75], v17 offset:46336
    ds_read_b64_tr_b16 v[76:77], v17 offset:45088
    ds_read_b64_tr_b16 v[78:79], v17 offset:46368
    ds_read_b64_tr_b16 v[80:81], v17 offset:45120
    ds_read_b64_tr_b16 v[82:83], v17 offset:46400
    ds_read_b64_tr_b16 v[84:85], v17 offset:45152
    ds_read_b64_tr_b16 v[86:87], v17 offset:46432
    ds_read_b64_tr_b16 v[88:89], v17 offset:45184
    ds_read_b64_tr_b16 v[90:91], v17 offset:46464
    s_waitcnt vmcnt(9)
    s_waitcnt lgkmcnt(8)
    v_mfma_f32_16x16x32_bf16 v[112:115], v[72:75], v[24:27], 0
    ds_read_b64_tr_b16 v[92:93], v17 offset:50176
    ds_read_b64_tr_b16 v[94:95], v17 offset:51456
    s_add_u32 s33, s38, 10240
    buffer_load_dwordx4 v[64:67], v13, s[44:47], s33 offen sc1
    s_waitcnt lgkmcnt(8)
    v_mfma_f32_16x16x32_bf16 v[116:119], v[76:79], v[24:27], 0
    ds_read_b64_tr_b16 v[96:97], v17 offset:50208
    ds_read_b64_tr_b16 v[98:99], v17 offset:51488
    s_waitcnt lgkmcnt(8)
    v_mfma_f32_16x16x32_bf16 v[120:123], v[80:83], v[24:27], 0
    ds_read_b64_tr_b16 v[100:101], v17 offset:50240
    ds_read_b64_tr_b16 v[102:103], v17 offset:51520
    s_waitcnt lgkmcnt(8)
    v_mfma_f32_16x16x32_bf16 v[124:127], v[84:87], v[24:27], 0
    ds_read_b64_tr_b16 v[104:105], v17 offset:50272
    ds_read_b64_tr_b16 v[106:107], v17 offset:51552
    s_waitcnt lgkmcnt(8)
    v_mfma_f32_16x16x32_bf16 v[128:131], v[88:91], v[24:27], 0
    ds_read_b64_tr_b16 v[108:109], v17 offset:50304
    ds_read_b64_tr_b16 v[110:111], v17 offset:51584
    s_waitcnt vmcnt(9)
    s_waitcnt lgkmcnt(8)
    v_mfma_f32_16x16x32_bf16 v[112:115], v[92:95], v[28:31], v[112:115]
    ds_read_b64_tr_b16 v[72:73], v17 offset:55296
    ds_read_b64_tr_b16 v[74:75], v17 offset:56576
    s_add_u32 s33, s38, 11264
    buffer_load_dwordx4 v[68:71], v13, s[44:47], s33 offen sc1
    s_waitcnt lgkmcnt(8)
    v_mfma_f32_16x16x32_bf16 v[116:119], v[96:99], v[28:31], v[116:119]
    ds_read_b64_tr_b16 v[76:77], v17 offset:55328
    ds_read_b64_tr_b16 v[78:79], v17 offset:56608
    s_waitcnt lgkmcnt(8)
    v_mfma_f32_16x16x32_bf16 v[120:123], v[100:103], v[28:31], v[120:123]
    ds_read_b64_tr_b16 v[80:81], v17 offset:55360
    ds_read_b64_tr_b16 v[82:83], v17 offset:56640
    s_waitcnt lgkmcnt(8)
    v_mfma_f32_16x16x32_bf16 v[124:127], v[104:107], v[28:31], v[124:127]
    ds_read_b64_tr_b16 v[84:85], v17 offset:55392
    ds_read_b64_tr_b16 v[86:87], v17 offset:56672
    s_waitcnt lgkmcnt(8)
    v_mfma_f32_16x16x32_bf16 v[128:131], v[108:111], v[28:31], v[128:131]
    ds_read_b64_tr_b16 v[88:89], v17 offset:55424
    ds_read_b64_tr_b16 v[90:91], v17 offset:56704
    s_waitcnt vmcnt(9)
    s_waitcnt lgkmcnt(8)
    v_mfma_f32_16x16x32_bf16 v[112:115], v[72:75], v[32:35], v[112:115]
    ds_read_b64_tr_b16 v[92:93], v17 offset:60416
    ds_read_b64_tr_b16 v[94:95], v17 offset:61696
    s_add_u32 s33, s38, 12288
    buffer_load_dwordx4 v[24:27], v13, s[44:47], s33 offen sc1
    s_waitcnt lgkmcnt(8)
    v_mfma_f32_16x16x32_bf16 v[116:119], v[76:79], v[32:35], v[116:119]
    ds_read_b64_tr_b16 v[96:97], v17 offset:60448
    ds_read_b64_tr_b16 v[98:99], v17 offset:61728
    s_waitcnt lgkmcnt(8)
    v_mfma_f32_16x16x32_bf16 v[120:123], v[80:83], v[32:35], v[120:123]
    ds_read_b64_tr_b16 v[100:101], v17 offset:60480
    ds_read_b64_tr_b16 v[102:103], v17 offset:61760
    s_waitcnt lgkmcnt(8)
    v_mfma_f32_16x16x32_bf16 v[124:127], v[84:87], v[32:35], v[124:127]
    ds_read_b64_tr_b16 v[104:105], v17 offset:60512
    ds_read_b64_tr_b16 v[106:107], v17 offset:61792
    s_waitcnt lgkmcnt(8)
    v_mfma_f32_16x16x32_bf16 v[128:131], v[88:91], v[32:35], v[128:131]
    ds_read_b64_tr_b16 v[108:109], v17 offset:60544
    ds_read_b64_tr_b16 v[110:111], v17 offset:61824
    s_waitcnt vmcnt(9)
    s_waitcnt lgkmcnt(8)
    v_mfma_f32_16x16x32_bf16 v[112:115], v[92:95], v[36:39], v[112:115]
    ds_read_b64_tr_b16 v[72:73], v18 offset:0
    ds_read_b64_tr_b16 v[74:75], v18 offset:1280
    s_add_u32 s33, s38, 13312
    buffer_load_dwordx4 v[28:31], v13, s[44:47], s33 offen sc1
    s_waitcnt lgkmcnt(8)
    v_mfma_f32_16x16x32_bf16 v[116:119], v[96:99], v[36:39], v[116:119]
    ds_read_b64_tr_b16 v[76:77], v18 offset:32
    ds_read_b64_tr_b16 v[78:79], v18 offset:1312
    s_waitcnt lgkmcnt(8)
    v_mfma_f32_16x16x32_bf16 v[120:123], v[100:103], v[36:39], v[120:123]
    ds_read_b64_tr_b16 v[80:81], v18 offset:64
    ds_read_b64_tr_b16 v[82:83], v18 offset:1344
    s_waitcnt lgkmcnt(8)
    v_mfma_f32_16x16x32_bf16 v[124:127], v[104:107], v[36:39], v[124:127]
    ds_read_b64_tr_b16 v[84:85], v18 offset:96
    ds_read_b64_tr_b16 v[86:87], v18 offset:1376
    s_waitcnt lgkmcnt(8)
    v_mfma_f32_16x16x32_bf16 v[128:131], v[108:111], v[36:39], v[128:131]
    ds_read_b64_tr_b16 v[88:89], v18 offset:128
    ds_read_b64_tr_b16 v[90:91], v18 offset:1408
    s_waitcnt vmcnt(9)
    s_waitcnt lgkmcnt(8)
    v_mfma_f32_16x16x32_bf16 v[112:115], v[72:75], v[40:43], v[112:115]
    ds_read_b64_tr_b16 v[92:93], v18 offset:5120
    ds_read_b64_tr_b16 v[94:95], v18 offset:6400
    s_add_u32 s33, s38, 14336
    buffer_load_dwordx4 v[32:35], v13, s[44:47], s33 offen sc1
    s_waitcnt lgkmcnt(8)
    v_mfma_f32_16x16x32_bf16 v[116:119], v[76:79], v[40:43], v[116:119]
    ds_read_b64_tr_b16 v[96:97], v18 offset:5152
    ds_read_b64_tr_b16 v[98:99], v18 offset:6432
    s_waitcnt lgkmcnt(8)
    v_mfma_f32_16x16x32_bf16 v[120:123], v[80:83], v[40:43], v[120:123]
    ds_read_b64_tr_b16 v[100:101], v18 offset:5184
    ds_read_b64_tr_b16 v[102:103], v18 offset:6464
    s_waitcnt lgkmcnt(8)
    v_mfma_f32_16x16x32_bf16 v[124:127], v[84:87], v[40:43], v[124:127]
    ds_read_b64_tr_b16 v[104:105], v18 offset:5216
    ds_read_b64_tr_b16 v[106:107], v18 offset:6496
    s_waitcnt lgkmcnt(8)
    v_mfma_f32_16x16x32_bf16 v[128:131], v[88:91], v[40:43], v[128:131]
    ds_read_b64_tr_b16 v[108:109], v18 offset:5248
    ds_read_b64_tr_b16 v[110:111], v18 offset:6528
    s_waitcnt vmcnt(9)
    s_waitcnt lgkmcnt(8)
    v_mfma_f32_16x16x32_bf16 v[112:115], v[92:95], v[44:47], v[112:115]
    ds_read_b64_tr_b16 v[72:73], v18 offset:10240
    ds_read_b64_tr_b16 v[74:75], v18 offset:11520
    s_add_u32 s33, s38, 15360
    buffer_load_dwordx4 v[36:39], v13, s[44:47], s33 offen sc1
    s_waitcnt lgkmcnt(8)
    v_mfma_f32_16x16x32_bf16 v[116:119], v[96:99], v[44:47], v[116:119]
    ds_read_b64_tr_b16 v[76:77], v18 offset:10272
    ds_read_b64_tr_b16 v[78:79], v18 offset:11552
    s_waitcnt lgkmcnt(8)
    v_mfma_f32_16x16x32_bf16 v[120:123], v[100:103], v[44:47], v[120:123]
    ds_read_b64_tr_b16 v[80:81], v18 offset:10304
    ds_read_b64_tr_b16 v[82:83], v18 offset:11584
    s_waitcnt lgkmcnt(8)
    v_mfma_f32_16x16x32_bf16 v[124:127], v[104:107], v[44:47], v[124:127]
    ds_read_b64_tr_b16 v[84:85], v18 offset:10336
    ds_read_b64_tr_b16 v[86:87], v18 offset:11616
    s_waitcnt lgkmcnt(8)
    v_mfma_f32_16x16x32_bf16 v[128:131], v[108:111], v[44:47], v[128:131]
    ds_read_b64_tr_b16 v[88:89], v18 offset:10368
    ds_read_b64_tr_b16 v[90:91], v18 offset:11648
    s_waitcnt vmcnt(9)
    s_waitcnt lgkmcnt(8)
    v_mfma_f32_16x16x32_bf16 v[112:115], v[72:75], v[48:51], v[112:115]
    ds_read_b64_tr_b16 v[92:93], v18 offset:15360
    ds_read_b64_tr_b16 v[94:95], v18 offset:16640
    s_add_u32 s33, s38, 16384
    buffer_load_dwordx4 v[40:43], v13, s[44:47], s33 offen sc1
    s_waitcnt lgkmcnt(8)
    v_mfma_f32_16x16x32_bf16 v[116:119], v[76:79], v[48:51], v[116:119]
    ds_read_b64_tr_b16 v[96:97], v18 offset:15392
    ds_read_b64_tr_b16 v[98:99], v18 offset:16672
    s_waitcnt lgkmcnt(8)
    v_mfma_f32_16x16x32_bf16 v[120:123], v[80:83], v[48:51], v[120:123]
    ds_read_b64_tr_b16 v[100:101], v18 offset:15424
    ds_read_b64_tr_b16 v[102:103], v18 offset:16704
    s_waitcnt lgkmcnt(8)
    v_mfma_f32_16x16x32_bf16 v[124:127], v[84:87], v[48:51], v[124:127]
    ds_read_b64_tr_b16 v[104:105], v18 offset:15456
    ds_read_b64_tr_b16 v[106:107], v18 offset:16736
    s_waitcnt lgkmcnt(8)
    v_mfma_f32_16x16x32_bf16 v[128:131], v[88:91], v[48:51], v[128:131]
    ds_read_b64_tr_b16 v[108:109], v18 offset:15488
    ds_read_b64_tr_b16 v[110:111], v18 offset:16768
    s_waitcnt vmcnt(9)
    s_waitcnt lgkmcnt(8)
    v_mfma_f32_16x16x32_bf16 v[112:115], v[92:95], v[52:55], v[112:115]
    ds_read_b64_tr_b16 v[72:73], v18 offset:20480
    ds_read_b64_tr_b16 v[74:75], v18 offset:21760
    s_add_u32 s33, s38, 17408
    buffer_load_dwordx4 v[44:47], v13, s[44:47], s33 offen sc1
    s_waitcnt lgkmcnt(8)
    v_mfma_f32_16x16x32_bf16 v[116:119], v[96:99], v[52:55], v[116:119]
    ds_read_b64_tr_b16 v[76:77], v18 offset:20512
    ds_read_b64_tr_b16 v[78:79], v18 offset:21792
    s_waitcnt lgkmcnt(8)
    v_mfma_f32_16x16x32_bf16 v[120:123], v[100:103], v[52:55], v[120:123]
    ds_read_b64_tr_b16 v[80:81], v18 offset:20544
    ds_read_b64_tr_b16 v[82:83], v18 offset:21824
    s_waitcnt lgkmcnt(8)
    v_mfma_f32_16x16x32_bf16 v[124:127], v[104:107], v[52:55], v[124:127]
    ds_read_b64_tr_b16 v[84:85], v18 offset:20576
    ds_read_b64_tr_b16 v[86:87], v18 offset:21856
    s_waitcnt lgkmcnt(8)
    v_mfma_f32_16x16x32_bf16 v[128:131], v[108:111], v[52:55], v[128:131]
    ds_read_b64_tr_b16 v[88:89], v18 offset:20608
    ds_read_b64_tr_b16 v[90:91], v18 offset:21888
    s_waitcnt vmcnt(9)
    s_waitcnt lgkmcnt(8)
    v_mfma_f32_16x16x32_bf16 v[112:115], v[72:75], v[56:59], v[112:115]
    ds_read_b64_tr_b16 v[92:93], v18 offset:25600
    ds_read_b64_tr_b16 v[94:95], v18 offset:26880
    s_add_u32 s33, s38, 18432
    buffer_load_dwordx4 v[48:51], v13, s[44:47], s33 offen sc1
    s_waitcnt lgkmcnt(8)
    v_mfma_f32_16x16x32_bf16 v[116:119], v[76:79], v[56:59], v[116:119]
    ds_read_b64_tr_b16 v[96:97], v18 offset:25632
    ds_read_b64_tr_b16 v[98:99], v18 offset:26912
    s_waitcnt lgkmcnt(8)
    v_mfma_f32_16x16x32_bf16 v[120:123], v[80:83], v[56:59], v[120:123]
    ds_read_b64_tr_b16 v[100:101], v18 offset:25664
    ds_read_b64_tr_b16 v[102:103], v18 offset:26944
    s_waitcnt lgkmcnt(8)
    v_mfma_f32_16x16x32_bf16 v[124:127], v[84:87], v[56:59], v[124:127]
    ds_read_b64_tr_b16 v[104:105], v18 offset:25696
    ds_read_b64_tr_b16 v[106:107], v18 offset:26976
    s_waitcnt lgkmcnt(8)
    v_mfma_f32_16x16x32_bf16 v[128:131], v[88:91], v[56:59], v[128:131]
    ds_read_b64_tr_b16 v[108:109], v18 offset:25728
    ds_read_b64_tr_b16 v[110:111], v18 offset:27008
    s_waitcnt vmcnt(9)
    s_waitcnt lgkmcnt(8)
    v_mfma_f32_16x16x32_bf16 v[112:115], v[92:95], v[60:63], v[112:115]
    ds_read_b64_tr_b16 v[72:73], v18 offset:30720
    ds_read_b64_tr_b16 v[74:75], v18 offset:32000
    s_add_u32 s33, s38, 19456
    buffer_load_dwordx4 v[52:55], v13, s[44:47], s33 offen sc1
    s_waitcnt lgkmcnt(8)
    v_mfma_f32_16x16x32_bf16 v[116:119], v[96:99], v[60:63], v[116:119]
    ds_read_b64_tr_b16 v[76:77], v18 offset:30752
    ds_read_b64_tr_b16 v[78:79], v18 offset:32032
    s_waitcnt lgkmcnt(8)
    v_mfma_f32_16x16x32_bf16 v[120:123], v[100:103], v[60:63], v[120:123]
    ds_read_b64_tr_b16 v[80:81], v18 offset:30784
    ds_read_b64_tr_b16 v[82:83], v18 offset:32064
    s_waitcnt lgkmcnt(8)
    v_mfma_f32_16x16x32_bf16 v[124:127], v[104:107], v[60:63], v[124:127]
    ds_read_b64_tr_b16 v[84:85], v18 offset:30816
    ds_read_b64_tr_b16 v[86:87], v18 offset:32096
    s_waitcnt lgkmcnt(8)
    v_mfma_f32_16x16x32_bf16 v[128:131], v[108:111], v[60:63], v[128:131]
    ds_read_b64_tr_b16 v[88:89], v18 offset:30848
    ds_read_b64_tr_b16 v[90:91], v18 offset:32128
    s_waitcnt vmcnt(9)
    s_waitcnt lgkmcnt(8)
    v_mfma_f32_16x16x32_bf16 v[112:115], v[72:75], v[64:67], v[112:115]
    ds_read_b64_tr_b16 v[92:93], v18 offset:35840
    ds_read_b64_tr_b16 v[94:95], v18 offset:37120
    s_waitcnt lgkmcnt(8)
    v_mfma_f32_16x16x32_bf16 v[116:119], v[76:79], v[64:67], v[116:119]
    ds_read_b64_tr_b16 v[96:97], v18 offset:35872
    ds_read_b64_tr_b16 v[98:99], v18 offset:37152
    s_waitcnt lgkmcnt(8)
    v_mfma_f32_16x16x32_bf16 v[120:123], v[80:83], v[64:67], v[120:123]
    ds_read_b64_tr_b16 v[100:101], v18 offset:35904
    ds_read_b64_tr_b16 v[102:103], v18 offset:37184
    s_waitcnt lgkmcnt(8)
    v_mfma_f32_16x16x32_bf16 v[124:127], v[84:87], v[64:67], v[124:127]
    ds_read_b64_tr_b16 v[104:105], v18 offset:35936
    ds_read_b64_tr_b16 v[106:107], v18 offset:37216
    s_waitcnt lgkmcnt(8)
    v_mfma_f32_16x16x32_bf16 v[128:131], v[88:91], v[64:67], v[128:131]
    ds_read_b64_tr_b16 v[108:109], v18 offset:35968
    ds_read_b64_tr_b16 v[110:111], v18 offset:37248
    s_waitcnt vmcnt(8)
    s_waitcnt lgkmcnt(8)
    v_mfma_f32_16x16x32_bf16 v[112:115], v[92:95], v[68:71], v[112:115]
    ds_read_b64_tr_b16 v[72:73], v18 offset:40960
    ds_read_b64_tr_b16 v[74:75], v18 offset:42240
    s_waitcnt lgkmcnt(8)
    v_mfma_f32_16x16x32_bf16 v[116:119], v[96:99], v[68:71], v[116:119]
    ds_read_b64_tr_b16 v[76:77], v18 offset:40992
    ds_read_b64_tr_b16 v[78:79], v18 offset:42272
    s_waitcnt lgkmcnt(8)
    v_mfma_f32_16x16x32_bf16 v[120:123], v[100:103], v[68:71], v[120:123]
    ds_read_b64_tr_b16 v[80:81], v18 offset:41024
    ds_read_b64_tr_b16 v[82:83], v18 offset:42304
    s_waitcnt lgkmcnt(8)
    v_mfma_f32_16x16x32_bf16 v[124:127], v[104:107], v[68:71], v[124:127]
    ds_read_b64_tr_b16 v[84:85], v18 offset:41056
    ds_read_b64_tr_b16 v[86:87], v18 offset:42336
    s_waitcnt lgkmcnt(8)
    v_mfma_f32_16x16x32_bf16 v[128:131], v[108:111], v[68:71], v[128:131]
    ds_read_b64_tr_b16 v[88:89], v18 offset:41088
    ds_read_b64_tr_b16 v[90:91], v18 offset:42368
    s_waitcnt vmcnt(7)
    s_waitcnt lgkmcnt(8)
    v_mfma_f32_16x16x32_bf16 v[112:115], v[72:75], v[24:27], v[112:115]
    ds_read_b64_tr_b16 v[92:93], v18 offset:46080
    ds_read_b64_tr_b16 v[94:95], v18 offset:47360
    s_waitcnt lgkmcnt(8)
    v_mfma_f32_16x16x32_bf16 v[116:119], v[76:79], v[24:27], v[116:119]
    ds_read_b64_tr_b16 v[96:97], v18 offset:46112
    ds_read_b64_tr_b16 v[98:99], v18 offset:47392
    s_waitcnt lgkmcnt(8)
    v_mfma_f32_16x16x32_bf16 v[120:123], v[80:83], v[24:27], v[120:123]
    ds_read_b64_tr_b16 v[100:101], v18 offset:46144
    ds_read_b64_tr_b16 v[102:103], v18 offset:47424
    s_waitcnt lgkmcnt(8)
    v_mfma_f32_16x16x32_bf16 v[124:127], v[84:87], v[24:27], v[124:127]
    ds_read_b64_tr_b16 v[104:105], v18 offset:46176
    ds_read_b64_tr_b16 v[106:107], v18 offset:47456
    s_waitcnt lgkmcnt(8)
    v_mfma_f32_16x16x32_bf16 v[128:131], v[88:91], v[24:27], v[128:131]
    ds_read_b64_tr_b16 v[108:109], v18 offset:46208
    ds_read_b64_tr_b16 v[110:111], v18 offset:47488
    s_waitcnt vmcnt(6)
    s_waitcnt lgkmcnt(8)
    v_mfma_f32_16x16x32_bf16 v[112:115], v[92:95], v[28:31], v[112:115]
    ds_read_b64_tr_b16 v[72:73], v18 offset:51200
    ds_read_b64_tr_b16 v[74:75], v18 offset:52480
    s_waitcnt lgkmcnt(8)
    v_mfma_f32_16x16x32_bf16 v[116:119], v[96:99], v[28:31], v[116:119]
    ds_read_b64_tr_b16 v[76:77], v18 offset:51232
    ds_read_b64_tr_b16 v[78:79], v18 offset:52512
    s_waitcnt lgkmcnt(8)
    v_mfma_f32_16x16x32_bf16 v[120:123], v[100:103], v[28:31], v[120:123]
    ds_read_b64_tr_b16 v[80:81], v18 offset:51264
    ds_read_b64_tr_b16 v[82:83], v18 offset:52544
    s_waitcnt lgkmcnt(8)
    v_mfma_f32_16x16x32_bf16 v[124:127], v[104:107], v[28:31], v[124:127]
    ds_read_b64_tr_b16 v[84:85], v18 offset:51296
    ds_read_b64_tr_b16 v[86:87], v18 offset:52576
    s_waitcnt lgkmcnt(8)
    v_mfma_f32_16x16x32_bf16 v[128:131], v[108:111], v[28:31], v[128:131]
    ds_read_b64_tr_b16 v[88:89], v18 offset:51328
    ds_read_b64_tr_b16 v[90:91], v18 offset:52608
    s_waitcnt vmcnt(5)
    s_waitcnt lgkmcnt(8)
    v_mfma_f32_16x16x32_bf16 v[112:115], v[72:75], v[32:35], v[112:115]
    ds_read_b64_tr_b16 v[92:93], v18 offset:56320
    ds_read_b64_tr_b16 v[94:95], v18 offset:57600
    s_waitcnt lgkmcnt(8)
    v_mfma_f32_16x16x32_bf16 v[116:119], v[76:79], v[32:35], v[116:119]
    ds_read_b64_tr_b16 v[96:97], v18 offset:56352
    ds_read_b64_tr_b16 v[98:99], v18 offset:57632
    s_waitcnt lgkmcnt(8)
    v_mfma_f32_16x16x32_bf16 v[120:123], v[80:83], v[32:35], v[120:123]
    ds_read_b64_tr_b16 v[100:101], v18 offset:56384
    ds_read_b64_tr_b16 v[102:103], v18 offset:57664
    s_waitcnt lgkmcnt(8)
    v_mfma_f32_16x16x32_bf16 v[124:127], v[84:87], v[32:35], v[124:127]
    ds_read_b64_tr_b16 v[104:105], v18 offset:56416
    ds_read_b64_tr_b16 v[106:107], v18 offset:57696
    s_waitcnt lgkmcnt(8)
    v_mfma_f32_16x16x32_bf16 v[128:131], v[88:91], v[32:35], v[128:131]
    ds_read_b64_tr_b16 v[108:109], v18 offset:56448
    ds_read_b64_tr_b16 v[110:111], v18 offset:57728
    s_waitcnt vmcnt(4)
    s_waitcnt lgkmcnt(8)
    v_mfma_f32_16x16x32_bf16 v[112:115], v[92:95], v[36:39], v[112:115]
    ds_read_b64_tr_b16 v[72:73], v18 offset:61440
    ds_read_b64_tr_b16 v[74:75], v18 offset:62720
    s_waitcnt lgkmcnt(8)
    v_mfma_f32_16x16x32_bf16 v[116:119], v[96:99], v[36:39], v[116:119]
    ds_read_b64_tr_b16 v[76:77], v18 offset:61472
    ds_read_b64_tr_b16 v[78:79], v18 offset:62752
    s_waitcnt lgkmcnt(8)
    v_mfma_f32_16x16x32_bf16 v[120:123], v[100:103], v[36:39], v[120:123]
    ds_read_b64_tr_b16 v[80:81], v18 offset:61504
    ds_read_b64_tr_b16 v[82:83], v18 offset:62784
    s_waitcnt lgkmcnt(8)
    v_mfma_f32_16x16x32_bf16 v[124:127], v[104:107], v[36:39], v[124:127]
    ds_read_b64_tr_b16 v[84:85], v18 offset:61536
    ds_read_b64_tr_b16 v[86:87], v18 offset:62816
    s_waitcnt lgkmcnt(8)
    v_mfma_f32_16x16x32_bf16 v[128:131], v[108:111], v[36:39], v[128:131]
    ds_read_b64_tr_b16 v[88:89], v18 offset:61568
    ds_read_b64_tr_b16 v[90:91], v18 offset:62848
    s_waitcnt vmcnt(3)
    s_waitcnt lgkmcnt(8)
    v_mfma_f32_16x16x32_bf16 v[112:115], v[72:75], v[40:43], v[112:115]
    ds_read_b64_tr_b16 v[92:93], v19 offset:1024
    ds_read_b64_tr_b16 v[94:95], v19 offset:2304
    s_waitcnt lgkmcnt(8)
    v_mfma_f32_16x16x32_bf16 v[116:119], v[76:79], v[40:43], v[116:119]
    ds_read_b64_tr_b16 v[96:97], v19 offset:1056
    ds_read_b64_tr_b16 v[98:99], v19 offset:2336
    s_waitcnt lgkmcnt(8)
    v_mfma_f32_16x16x32_bf16 v[120:123], v[80:83], v[40:43], v[120:123]
    ds_read_b64_tr_b16 v[100:101], v19 offset:1088
    ds_read_b64_tr_b16 v[102:103], v19 offset:2368
    s_waitcnt lgkmcnt(8)
    v_mfma_f32_16x16x32_bf16 v[124:127], v[84:87], v[40:43], v[124:127]
    ds_read_b64_tr_b16 v[104:105], v19 offset:1120
    ds_read_b64_tr_b16 v[106:107], v19 offset:2400
    s_waitcnt lgkmcnt(8)
    v_mfma_f32_16x16x32_bf16 v[128:131], v[88:91], v[40:43], v[128:131]
    ds_read_b64_tr_b16 v[108:109], v19 offset:1152
    ds_read_b64_tr_b16 v[110:111], v19 offset:2432
    s_waitcnt vmcnt(2)
    s_waitcnt lgkmcnt(8)
    v_mfma_f32_16x16x32_bf16 v[112:115], v[92:95], v[44:47], v[112:115]
    ds_read_b64_tr_b16 v[72:73], v19 offset:6144
    ds_read_b64_tr_b16 v[74:75], v19 offset:7424
    s_waitcnt lgkmcnt(8)
    v_mfma_f32_16x16x32_bf16 v[116:119], v[96:99], v[44:47], v[116:119]
    ds_read_b64_tr_b16 v[76:77], v19 offset:6176
    ds_read_b64_tr_b16 v[78:79], v19 offset:7456
    s_waitcnt lgkmcnt(8)
    v_mfma_f32_16x16x32_bf16 v[120:123], v[100:103], v[44:47], v[120:123]
    ds_read_b64_tr_b16 v[80:81], v19 offset:6208
    ds_read_b64_tr_b16 v[82:83], v19 offset:7488
    s_waitcnt lgkmcnt(8)
    v_mfma_f32_16x16x32_bf16 v[124:127], v[104:107], v[44:47], v[124:127]
    ds_read_b64_tr_b16 v[84:85], v19 offset:6240
    ds_read_b64_tr_b16 v[86:87], v19 offset:7520
    s_waitcnt lgkmcnt(8)
    v_mfma_f32_16x16x32_bf16 v[128:131], v[108:111], v[44:47], v[128:131]
    ds_read_b64_tr_b16 v[88:89], v19 offset:6272
    ds_read_b64_tr_b16 v[90:91], v19 offset:7552
    s_waitcnt vmcnt(1)
    s_waitcnt lgkmcnt(8)
    v_mfma_f32_16x16x32_bf16 v[112:115], v[72:75], v[48:51], v[112:115]
    ds_read_b64_tr_b16 v[92:93], v19 offset:11264
    ds_read_b64_tr_b16 v[94:95], v19 offset:12544
    s_waitcnt lgkmcnt(8)
    v_mfma_f32_16x16x32_bf16 v[116:119], v[76:79], v[48:51], v[116:119]
    ds_read_b64_tr_b16 v[96:97], v19 offset:11296
    ds_read_b64_tr_b16 v[98:99], v19 offset:12576
    s_waitcnt lgkmcnt(8)
    v_mfma_f32_16x16x32_bf16 v[120:123], v[80:83], v[48:51], v[120:123]
    ds_read_b64_tr_b16 v[100:101], v19 offset:11328
    ds_read_b64_tr_b16 v[102:103], v19 offset:12608
    s_waitcnt lgkmcnt(8)
    v_mfma_f32_16x16x32_bf16 v[124:127], v[84:87], v[48:51], v[124:127]
    ds_read_b64_tr_b16 v[104:105], v19 offset:11360
    ds_read_b64_tr_b16 v[106:107], v19 offset:12640
    s_waitcnt lgkmcnt(8)
    v_mfma_f32_16x16x32_bf16 v[128:131], v[88:91], v[48:51], v[128:131]
    ds_read_b64_tr_b16 v[108:109], v19 offset:11392
    ds_read_b64_tr_b16 v[110:111], v19 offset:12672
    s_waitcnt vmcnt(0)
    s_waitcnt lgkmcnt(8)
    v_mfma_f32_16x16x32_bf16 v[112:115], v[92:95], v[52:55], v[112:115]
    s_waitcnt lgkmcnt(6)
    v_mfma_f32_16x16x32_bf16 v[116:119], v[96:99], v[52:55], v[116:119]
    s_waitcnt lgkmcnt(4)
    v_mfma_f32_16x16x32_bf16 v[120:123], v[100:103], v[52:55], v[120:123]
    s_waitcnt lgkmcnt(2)
    v_mfma_f32_16x16x32_bf16 v[124:127], v[104:107], v[52:55], v[124:127]
    s_waitcnt lgkmcnt(0)
    v_mfma_f32_16x16x32_bf16 v[128:131], v[108:111], v[52:55], v[128:131]
    ds_read_b64 v[132:133], v21 offset:0
    ds_read_b64 v[134:135], v21 offset:32
    ds_read_b64 v[136:137], v21 offset:64
    ds_read_b64 v[138:139], v21 offset:96
    ds_read_b64 v[140:141], v21 offset:128
    v_mov_b32 v10, 0x3f803f80
    v_mov_b32 v4, 0
    v_mov_b32 v5, 0
    s_waitcnt lgkmcnt(4)
    v_lshlrev_b32 v144, 16, v132
    v_and_b32 v145, 0xffff0000, v132
    v_lshlrev_b32 v146, 16, v133
    v_and_b32 v147, 0xffff0000, v133
    v_add_f32 v112, v112, v144
    v_add_f32 v113, v113, v145
    v_add_f32 v114, v114, v146
    v_add_f32 v115, v115, v147
    v_cvt_pk_bf16_f32 v72, v112, v113
    v_cvt_pk_bf16_f32 v73, v114, v115
    s_waitcnt lgkmcnt(3)
    v_lshlrev_b32 v144, 16, v134
    v_and_b32 v145, 0xffff0000, v134
    v_lshlrev_b32 v146, 16, v135
    v_and_b32 v147, 0xffff0000, v135
    v_add_f32 v116, v116, v144
    v_add_f32 v117, v117, v145
    v_add_f32 v118, v118, v146
    v_add_f32 v119, v119, v147
    v_cvt_pk_bf16_f32 v74, v116, v117
    v_cvt_pk_bf16_f32 v75, v118, v119
    s_waitcnt lgkmcnt(2)
    v_lshlrev_b32 v144, 16, v136
    v_and_b32 v145, 0xffff0000, v136
    v_lshlrev_b32 v146, 16, v137
    v_and_b32 v147, 0xffff0000, v137
    v_add_f32 v120, v120, v144
    v_add_f32 v121, v121, v145
    v_add_f32 v122, v122, v146
    v_add_f32 v123, v123, v147
    v_cvt_pk_bf16_f32 v76, v120, v121
    v_cvt_pk_bf16_f32 v77, v122, v123
    s_waitcnt lgkmcnt(1)
    v_lshlrev_b32 v144, 16, v138
    v_and_b32 v145, 0xffff0000, v138
    v_lshlrev_b32 v146, 16, v139
    v_and_b32 v147, 0xffff0000, v139
    v_add_f32 v124, v124, v144
    v_add_f32 v125, v125, v145
    v_add_f32 v126, v126, v146
    v_add_f32 v127, v127, v147
    v_cvt_pk_bf16_f32 v78, v124, v125
    v_cvt_pk_bf16_f32 v79, v126, v127
    s_waitcnt lgkmcnt(0)
    v_lshlrev_b32 v144, 16, v140
    v_and_b32 v145, 0xffff0000, v140
    v_lshlrev_b32 v146, 16, v141
    v_and_b32 v147, 0xffff0000, v141
    v_add_f32 v128, v128, v144
    v_add_f32 v129, v129, v145
    v_add_f32 v130, v130, v146
    v_add_f32 v131, v131, v147
    v_cvt_pk_bf16_f32 v80, v128, v129
    v_cvt_pk_bf16_f32 v81, v130, v131
    v_dot2_f32_bf16 v4, v72, v10, v4
    v_dot2_f32_bf16 v5, v72, v72, v5
    v_dot2_f32_bf16 v4, v73, v10, v4
    v_dot2_f32_bf16 v5, v73, v73, v5
    v_dot2_f32_bf16 v4, v74, v10, v4
    v_dot2_f32_bf16 v5, v74, v74, v5
    v_dot2_f32_bf16 v4, v75, v10, v4
    v_dot2_f32_bf16 v5, v75, v75, v5
    v_dot2_f32_bf16 v4, v76, v10, v4
    v_dot2_f32_bf16 v5, v76, v76, v5
    v_dot2_f32_bf16 v4, v77, v10, v4
    v_dot2_f32_bf16 v5, v77, v77, v5
    v_dot2_f32_bf16 v4, v78, v10, v4
    v_dot2_f32_bf16 v5, v78, v78, v5
    v_dot2_f32_bf16 v4, v79, v10, v4
    v_dot2_f32_bf16 v5, v79, v79, v5
    v_dot2_f32_bf16 v4, v80, v10, v4
    v_dot2_f32_bf16 v5, v80, v80, v5
    v_dot2_f32_bf16 v4, v81, v10, v4
    v_dot2_f32_bf16 v5, v81, v81, v5
    v_mov_b32 v82, v80
    v_mov_b32 v83, v81
    v_permlane16_swap_b32 v72, v74
    v_permlane16_swap_b32 v73, v75
    s_add_u32 s33, s41, 0
    buffer_store_dwordx4 v[72:75], v23, s[52:55], s33 offen sc1
    v_permlane16_swap_b32 v76, v78
    v_permlane16_swap_b32 v77, v79
    s_add_u32 s33, s41, 2048
    buffer_store_dwordx4 v[76:79], v23, s[52:55], s33 offen sc1
    v_permlane16_swap_b32 v80, v82
    v_permlane16_swap_b32 v81, v83
    s_add_u32 s33, s41, 4096
    s_mov_b32 exec_lo, 0xffff
    s_mov_b32 exec_hi, 0xffff
    buffer_store_dwordx4 v[80:83], v23, s[52:55], s33 offen sc1
    s_mov_b64 exec, -1
    v_mov_b32 v6, v4
    v_mov_b32 v7, v5
    s_nop 0
    v_permlane32_swap_b32 v4, v6
    v_permlane32_swap_b32 v5, v7
    v_add_f32 v4, v4, v6
    v_add_f32 v5, v5, v7
    v_mov_b32 v6, v4
    v_mov_b32 v7, v5
    s_nop 0
    v_permlane16_swap_b32 v4, v6
    v_permlane16_swap_b32 v5, v7
    v_add_f32 v144, v4, v6
    v_add_f32 v145, v5, v7
    v_lshlrev_b32 v6, 3, v8
    v_lshlrev_b32 v7, 28, v9
    v_or_b32 v6, v6, v7
    s_lshl_b32 s33, s37, 10
    s_lshl_b32 s43, s35, 7
    s_add_u32 s33, s33, s43
    buffer_store_dwordx2 v[144:145], v6, s[56:59], s33 offen sc1
    s_waitcnt vmcnt(0)
    s_barrier
    s_branch sequential_preLN__sliding_block__geglu_ffn__prompt_kernel_p3_join35
    s_nop 0
sequential_preLN__sliding_block__geglu_ffn__prompt_kernel_p3_r33:
    s_barrier
    s_barrier
    s_branch sequential_preLN__sliding_block__geglu_ffn__prompt_kernel_p3_join35
    s_nop 0
sequential_preLN__sliding_block__geglu_ffn__prompt_kernel_p3_r34:
    s_and_b32 s60, s25, 1
    s_sub_u32 s33, 14, s60
    s_cmp_ge_u32 s26, s33
    s_cselect_b32 s61, 1, 0
    s_sub_u32 s33, s60, s61
    s_mul_i32 s33, s33, 14
    s_add_u32 s62, s26, s33
    s_and_b32 s63, s25, 6
    s_add_u32 s63, s63, s61
    s_sub_u32 s66, s3, 8
    s_mul_i32 s64, s66, 55296
    s_lshl_b32 s33, s62, 7
    s_add_u32 s64, s64, s33
    s_lshl_b32 s65, s66, 11
    v_lshrrev_b32 v4, 3, v1
    v_mul_u32_u24 v4, 3456, v4
    v_bfe_u32 v5, v1, 4, 1
    v_lshlrev_b32 v5, 2, v5
    v_and_b32 v6, 7, v1
    v_xor_b32 v6, v6, v5
    v_lshl_add_u32 v14, v6, 4, v4
    s_mov_b32 s68, s12
    s_and_b32 s69, s13, 0xffff
    s_mov_b32 s70, 0x21c000
    s_mov_b32 s71, 0x20000
    s_mov_b32 s72, s14
    s_and_b32 s73, s15, 0xffff
    s_mov_b32 s74, 0x21c000
    s_mov_b32 s75, 0x20000
    s_cmp_ge_u32 s26, 27
    s_cbranch_scc1 sequential_preLN__sliding_block__geglu_ffn__prompt_kernel_nop438
    s_add_u32 m0, s65, 0
    s_add_u32 s33, s64, 0
    buffer_load_dwordx4 v14, s[68:71], s33 offen lds
    s_add_u32 m0, s65, 8192
    s_add_u32 s33, s64, 0
    buffer_load_dwordx4 v14, s[72:75], s33 offen lds
    s_add_u32 m0, s65, 1024
    s_add_u32 s33, s64, 27648
    buffer_load_dwordx4 v14, s[68:71], s33 offen lds
    s_add_u32 m0, s65, 9216
    s_add_u32 s33, s64, 27648
    buffer_load_dwordx4 v14, s[72:75], s33 offen lds
    s_add_u32 m0, s65, 16384
    s_add_u32 s33, s64, 221184
    buffer_load_dwordx4 v14, s[68:71], s33 offen lds
    s_add_u32 m0, s65, 24576
    s_add_u32 s33, s64, 221184
    buffer_load_dwordx4 v14, s[72:75], s33 offen lds
    s_add_u32 m0, s65, 17408
    s_add_u32 s33, s64, 248832
    buffer_load_dwordx4 v14, s[68:71], s33 offen lds
    s_add_u32 m0, s65, 25600
    s_add_u32 s33, s64, 248832
    buffer_load_dwordx4 v14, s[72:75], s33 offen lds
    s_nop 1
sequential_preLN__sliding_block__geglu_ffn__prompt_kernel_nop438:
    s_cmp_lg_u32 s3, 11
    s_cbranch_scc1 sequential_preLN__sliding_block__geglu_ffn__prompt_kernel_wj37
    s_lshl_b32 s37, s25, 12
    s_add_u32 s37, s37, 65536
    s_mov_b32 s30, -1
    s_mov_b32 s31, 0
    s_mov_b32 s32, 0x40000
    v_lshlrev_b32 v8, 7, v1
    s_mov_b64 exec, s[30:31]
    s_nop 3
sequential_preLN__sliding_block__geglu_ffn__prompt_kernel_poll39:
    buffer_load_dword v4, v8, s[92:95], s37 offen sc1
    s_waitcnt vmcnt(0)
    v_xor_b32 v4, s24, v4
    v_cmp_ne_u32 vcc, 0, v4
    s_nop 0
    s_and_b64 s[28:29], vcc, s[30:31]
    s_cbranch_scc0 sequential_preLN__sliding_block__geglu_ffn__prompt_kernel_pdone40
    s_sub_u32 s32, s32, 1
    s_cbranch_scc1 sequential_preLN__sliding_block__geglu_ffn__prompt_kernel_pdone40
    s_sleep 1
    s_branch sequential_preLN__sliding_block__geglu_ffn__prompt_kernel_poll39
    s_nop 0
sequential_preLN__sliding_block__geglu_ffn__prompt_kernel_pdone40:
    s_mov_b64 exec, -1
    s_nop 0
sequential_preLN__sliding_block__geglu_ffn__prompt_kernel_wj37:
    s_barrier
    s_waitcnt vmcnt(0)
    s_barrier
    s_cmp_lg_u32 s3, 11
    s_cbranch_scc1 sequential_preLN__sliding_block__geglu_ffn__prompt_kernel_nosig41
    s_lshl_b32 s33, s25, 5
    s_add_u32 s33, s33, s26
    s_lshl_b32 s33, s33, 7
    s_add_u32 s33, s33, 98304
    v_mov_b32 v4, s24
    v_mov_b32 v5, 0
    s_mov_b64 exec, 1
    buffer_store_dword v4, v5, s[92:95], s33 offen sc1
    s_mov_b64 exec, -1
    s_nop 1
sequential_preLN__sliding_block__geglu_ffn__prompt_kernel_nosig41:
sequential_preLN__sliding_block__geglu_ffn__prompt_kernel_p3_join35:
ph4:
    s_cmp_lg_u32 s3, 9
    s_cbranch_scc1 sequential_preLN__sliding_block__geglu_ffn__prompt_kernel_nocpf42
    s_mul_i32 s33, s26, 3072
    s_add_u32 s33, s33, ph5-sequential_preLN__sliding_block__geglu_ffn__prompt_kernel
    v_lshl_add_u32 v5, v1, 7, s33
    s_mov_b32 s33, sequential_preLN__sliding_block__geglu_ffn__prompt_kernel_end-sequential_preLN__sliding_block__geglu_ffn__prompt_kernel-4
    v_cmp_ge_u32 vcc, s33, v5
    s_nop 0
    s_and_b64 exec, vcc, 0xffffff
    s_cbranch_scc0 sequential_preLN__sliding_block__geglu_ffn__prompt_kernel_nocpf42
    global_load_dword v166, v5, s[96:97]
    s_nop 1
sequential_preLN__sliding_block__geglu_ffn__prompt_kernel_nocpf42:
    s_mov_b64 exec, -1
    s_and_b32 s60, s25, 1
    s_sub_u32 s33, 14, s60
    s_cmp_ge_u32 s26, s33
    s_cselect_b32 s61, 1, 0
    s_sub_u32 s33, s60, s61
    s_mul_i32 s33, s33, 14
    s_add_u32 s62, s26, s33
    s_and_b32 s63, s25, 6
    s_add_u32 s63, s63, s61
    s_cmp_ge_u32 s26, 27
    s_cbranch_scc1 sequential_preLN__sliding_block__geglu_ffn__prompt_kernel_p4spare43
    s_cmp_ge_u32 s3, 8
    s_cbranch_scc1 sequential_preLN__sliding_block__geglu_ffn__prompt_kernel_p4_r46
    s_lshl_b32 s34, s63, 3
    s_add_u32 s34, s34, s3
    s_mul_i32 s35, s34, 40960
    s_add_u32 s44, s22, 0xa00000
    s_addc_u32 s45, s23, 0
    s_and_b32 s45, s45, 0xffff
    s_mov_b32 s46, 0x280000
    s_mov_b32 s47, 0x20000
    s_add_u32 s48, s22, 0xd00000
    s_addc_u32 s49, s23, 0
    s_and_b32 s49, s49, 0xffff
    s_mov_b32 s50, 0x6c0000
    s_mov_b32 s51, 0x20000
    s_add_u32 s52, s22, 0xc80000
    s_addc_u32 s53, s23, 0
    s_and_b32 s53, s53, 0xffff
    s_mov_b32 s54, 0x20000
    s_mov_b32 s55, 0x20000
    v_and_b32 v9, 15, v1
    v_lshlrev_b32 v9, 3, v9
    v_bfe_u32 v10, v1, 4, 1
    v_lshl_add_u32 v9, v10, 10, v9
    v_lshl_add_u32 v9, v3, 9, v9
    s_lshl_b32 s36, s34, 11
    v_bfe_u32 v4, v1, 2, 2
    v_lshl_add_u32 v5, v3, 3, v4
    v_lshlrev_b32 v5, 7, v5
    v_bfe_u32 v6, v1, 4, 1
    v_lshl_add_u32 v5, v6, 5, v5
    v_and_b32 v6, 3, v1
    v_lshl_add_u32 v5, v6, 3, v5
    v_lshrrev_b32 v4, 1, v4
    v_lshl_add_u32 v15, v4, 6, v5
    v_xor_b32 v16, 64, v15
    v_add_u32 v17, 65536, v15
    v_add_u32 v18, 65536, v16
    v_add_u32 v19, 131072, v15
    v_add_u32 v20, 131072, v16
    v_bfe_u32 v4, v1, 4, 1
    v_mul_u32_u24 v4, 55296, v4
    v_and_b32 v5, 15, v1
    v_lshl_add_u32 v4, v5, 4, v4
    v_lshl_add_u32 v14, v3, 8, v4
    s_mul_i32 s37, s34, 110592
    s_lshl_b32 s33, s62, 11
    s_add_u32 s37, s37, s33
    s_barrier
    s_add_u32 s33, s35, 0
    buffer_load_dwordx4 v[32:35], v13, s[44:47], s33 offen sc1
    s_add_u32 s33, s35, 1024
    buffer_load_dwordx4 v[36:39], v13, s[44:47], s33 offen sc1
    s_add_u32 s33, s35, 2048
    buffer_load_dwordx4 v[40:43], v13, s[44:47], s33 offen sc1
    s_add_u32 s33, s35, 3072
    buffer_load_dwordx4 v[44:47], v13, s[44:47], s33 offen sc1
    s_add_u32 s33, s35, 4096
    buffer_load_dwordx4 v[48:51], v13, s[44:47], s33 offen sc1
    s_add_u32 s33, s35, 5120
    buffer_load_dwordx4 v[52:55], v13, s[44:47], s33 offen sc1
    ds_read_b64_tr_b16 v[64:65], v15 offset:0
    ds_read_b64_tr_b16 v[66:67], v15 offset:512
    ds_read_b64_tr_b16 v[68:69], v16 offset:0
    ds_read_b64_tr_b16 v[70:71], v16 offset:512
    ds_read_b64_tr_b16 v[72:73], v15 offset:8192
    ds_read_b64_tr_b16 v[74:75], v15 offset:8704
    ds_read_b64_tr_b16 v[76:77], v16 offset:8192
    ds_read_b64_tr_b16 v[78:79], v16 offset:8704
    s_waitcnt vmcnt(5)
    s_waitcnt lgkmcnt(6)
    v_mfma_f32_32x32x16_bf16 v[96:111], v[64:67], v[32:35], 0
    ds_read_b64_tr_b16 v[80:81], v15 offset:2048
    ds_read_b64_tr_b16 v[82:83], v15 offset:2560
    s_add_u32 s33, s35, 6144
    buffer_load_dwordx4 v[56:59], v13, s[44:47], s33 offen sc1
    s_waitcnt lgkmcnt(6)
    v_mfma_f32_32x32x16_bf16 v[112:127], v[68:71], v[32:35], 0
    ds_read_b64_tr_b16 v[84:85], v16 offset:2048
    ds_read_b64_tr_b16 v[86:87], v16 offset:2560
    s_waitcnt lgkmcnt(6)
    v_mfma_f32_32x32x16_bf16 v[128:143], v[72:75], v[32:35], 0
    ds_read_b64_tr_b16 v[88:89], v15 offset:10240
    ds_read_b64_tr_b16 v[90:91], v15 offset:10752
    s_waitcnt lgkmcnt(6)
    v_mfma_f32_32x32x16_bf16 v[144:159], v[76:79], v[32:35], 0
    ds_read_b64_tr_b16 v[92:93], v16 offset:10240
    ds_read_b64_tr_b16 v[94:95], v16 offset:10752
    s_waitcnt vmcnt(5)
    s_waitcnt lgkmcnt(6)
    v_mfma_f32_32x32x16_bf16 v[96:111], v[80:83], v[36:39], v[96:111]
    ds_read_b64_tr_b16 v[64:65], v15 offset:4096
    ds_read_b64_tr_b16 v[66:67], v15 offset:4608
    s_add_u32 s33, s35, 7168
    buffer_load_dwordx4 v[60:63], v13, s[44:47], s33 offen sc1
    s_waitcnt lgkmcnt(6)
    v_mfma_f32_32x32x16_bf16 v[112:127], v[84:87], v[36:39], v[112:127]
    ds_read_b64_tr_b16 v[68:69], v16 offset:4096
    ds_read_b64_tr_b16 v[70:71], v16 offset:4608
    s_waitcnt lgkmcnt(6)
    v_mfma_f32_32x32x16_bf16 v[128:143], v[88:91], v[36:39], v[128:143]
    ds_read_b64_tr_b16 v[72:73], v15 offset:12288
    ds_read_b64_tr_b16 v[74:75], v15 offset:12800
    s_waitcnt lgkmcnt(6)
    v_mfma_f32_32x32x16_bf16 v[144:159], v[92:95], v[36:39], v[144:159]
    ds_read_b64_tr_b16 v[76:77], v16 offset:12288
    ds_read_b64_tr_b16 v[78:79], v16 offset:12800
    s_waitcnt vmcnt(5)
    s_waitcnt lgkmcnt(6)
    v_mfma_f32_32x32x16_bf16 v[96:111], v[64:67], v[40:43], v[96:111]
    ds_read_b64_tr_b16 v[80:81], v15 offset:6144
    ds_read_b64_tr_b16 v[82:83], v15 offset:6656
    s_add_u32 s33, s35, 8192
    buffer_load_dwordx4 v[32:35], v13, s[44:47], s33 offen sc1
    s_waitcnt lgkmcnt(6)
    v_mfma_f32_32x32x16_bf16 v[112:127], v[68:71], v[40:43], v[112:127]
    ds_read_b64_tr_b16 v[84:85], v16 offset:6144
    ds_read_b64_tr_b16 v[86:87], v16 offset:6656
    s_waitcnt lgkmcnt(6)
    v_mfma_f32_32x32x16_bf16 v[128:143], v[72:75], v[40:43], v[128:143]
    ds_read_b64_tr_b16 v[88:89], v15 offset:14336
    ds_read_b64_tr_b16 v[90:91], v15 offset:14848
    s_waitcnt lgkmcnt(6)
    v_mfma_f32_32x32x16_bf16 v[144:159], v[76:79], v[40:43], v[144:159]
    ds_read_b64_tr_b16 v[92:93], v16 offset:14336
    ds_read_b64_tr_b16 v[94:95], v16 offset:14848
    s_waitcnt vmcnt(5)
    s_waitcnt lgkmcnt(6)
    v_mfma_f32_32x32x16_bf16 v[96:111], v[80:83], v[44:47], v[96:111]
    ds_read_b64_tr_b16 v[64:65], v15 offset:16384
    ds_read_b64_tr_b16 v[66:67], v15 offset:16896
    s_add_u32 s33, s35, 9216
    buffer_load_dwordx4 v[36:39], v13, s[44:47], s33 offen sc1
    s_waitcnt lgkmcnt(6)
    v_mfma_f32_32x32x16_bf16 v[112:127], v[84:87], v[44:47], v[112:127]
    ds_read_b64_tr_b16 v[68:69], v16 offset:16384
    ds_read_b64_tr_b16 v[70:71], v16 offset:16896
    s_waitcnt lgkmcnt(6)
    v_mfma_f32_32x32x16_bf16 v[128:143], v[88:91], v[44:47], v[128:143]
    ds_read_b64_tr_b16 v[72:73], v15 offset:24576
    ds_read_b64_tr_b16 v[74:75], v15 offset:25088
    s_waitcnt lgkmcnt(6)
    v_mfma_f32_32x32x16_bf16 v[144:159], v[92:95], v[44:47], v[144:159]
    ds_read_b64_tr_b16 v[76:77], v16 offset:24576
    ds_read_b64_tr_b16 v[78:79], v16 offset:25088
    s_waitcnt vmcnt(5)
    s_waitcnt lgkmcnt(6)
    v_mfma_f32_32x32x16_bf16 v[96:111], v[64:67], v[48:51], v[96:111]
    ds_read_b64_tr_b16 v[80:81], v15 offset:18432
    ds_read_b64_tr_b16 v[82:83], v15 offset:18944
    s_add_u32 s33, s35, 10240
    buffer_load_dwordx4 v[40:43], v13, s[44:47], s33 offen sc1
    s_waitcnt lgkmcnt(6)
    v_mfma_f32_32x32x16_bf16 v[112:127], v[68:71], v[48:51], v[112:127]
    ds_read_b64_tr_b16 v[84:85], v16 offset:18432
    ds_read_b64_tr_b16 v[86:87], v16 offset:18944
    s_waitcnt lgkmcnt(6)
    v_mfma_f32_32x32x16_bf16 v[128:143], v[72:75], v[48:51], v[128:143]
    ds_read_b64_tr_b16 v[88:89], v15 offset:26624
    ds_read_b64_tr_b16 v[90:91], v15 offset:27136
    s_waitcnt lgkmcnt(6)
    v_mfma_f32_32x32x16_bf16 v[144:159], v[76:79], v[48:51], v[144:159]
    ds_read_b64_tr_b16 v[92:93], v16 offset:26624
    ds_read_b64_tr_b16 v[94:95], v16 offset:27136
    s_waitcnt vmcnt(5)
    s_waitcnt lgkmcnt(6)
    v_mfma_f32_32x32x16_bf16 v[96:111], v[80:83], v[52:55], v[96:111]
    ds_read_b64_tr_b16 v[64:65], v15 offset:20480
    ds_read_b64_tr_b16 v[66:67], v15 offset:20992
    s_add_u32 s33, s35, 11264
    buffer_load_dwordx4 v[44:47], v13, s[44:47], s33 offen sc1
    s_waitcnt lgkmcnt(6)
    v_mfma_f32_32x32x16_bf16 v[112:127], v[84:87], v[52:55], v[112:127]
    ds_read_b64_tr_b16 v[68:69], v16 offset:20480
    ds_read_b64_tr_b16 v[70:71], v16 offset:20992
    buffer_load_dwordx2 v[24:25], v9, s[52:55], s36 offen offset:0 sc1
    buffer_load_dwordx2 v[26:27], v9, s[52:55], s36 offen offset:128 sc1
    buffer_load_dwordx2 v[28:29], v9, s[52:55], s36 offen offset:256 sc1
    buffer_load_dwordx2 v[30:31], v9, s[52:55], s36 offen offset:384 sc1
    s_waitcnt lgkmcnt(6)
    v_mfma_f32_32x32x16_bf16 v[128:143], v[88:91], v[52:55], v[128:143]
    ds_read_b64_tr_b16 v[72:73], v15 offset:28672
    ds_read_b64_tr_b16 v[74:75], v15 offset:29184
    s_waitcnt lgkmcnt(6)
    v_mfma_f32_32x32x16_bf16 v[144:159], v[92:95], v[52:55], v[144:159]
    ds_read_b64_tr_b16 v[76:77], v16 offset:28672
    ds_read_b64_tr_b16 v[78:79], v16 offset:29184
    s_waitcnt vmcnt(9)
    s_waitcnt lgkmcnt(6)
    v_mfma_f32_32x32x16_bf16 v[96:111], v[64:67], v[56:59], v[96:111]
    ds_read_b64_tr_b16 v[80:81], v15 offset:22528
    ds_read_b64_tr_b16 v[82:83], v15 offset:23040
    s_add_u32 s33, s35, 12288
    buffer_load_dwordx4 v[48:51], v13, s[44:47], s33 offen sc1
    s_waitcnt lgkmcnt(6)
    v_mfma_f32_32x32x16_bf16 v[112:127], v[68:71], v[56:59], v[112:127]
    ds_read_b64_tr_b16 v[84:85], v16 offset:22528
    ds_read_b64_tr_b16 v[86:87], v16 offset:23040
    s_waitcnt lgkmcnt(6)
    v_mfma_f32_32x32x16_bf16 v[128:143], v[72:75], v[56:59], v[128:143]
    ds_read_b64_tr_b16 v[88:89], v15 offset:30720
    ds_read_b64_tr_b16 v[90:91], v15 offset:31232
    s_waitcnt lgkmcnt(6)
    v_mfma_f32_32x32x16_bf16 v[144:159], v[76:79], v[56:59], v[144:159]
    ds_read_b64_tr_b16 v[92:93], v16 offset:30720
    ds_read_b64_tr_b16 v[94:95], v16 offset:31232
    s_waitcnt vmcnt(9)
    s_waitcnt lgkmcnt(6)
    v_mfma_f32_32x32x16_bf16 v[96:111], v[80:83], v[60:63], v[96:111]
    s_barrier
    ds_read_b64_tr_b16 v[64:65], v15 offset:45056
    ds_read_b64_tr_b16 v[66:67], v15 offset:45568
    s_add_u32 s33, s35, 13312
    buffer_load_dwordx4 v[52:55], v13, s[44:47], s33 offen sc1
    s_waitcnt lgkmcnt(6)
    v_mfma_f32_32x32x16_bf16 v[112:127], v[84:87], v[60:63], v[112:127]
    ds_read_b64_tr_b16 v[68:69], v16 offset:45056
    ds_read_b64_tr_b16 v[70:71], v16 offset:45568
    s_waitcnt lgkmcnt(6)
    v_mfma_f32_32x32x16_bf16 v[128:143], v[88:91], v[60:63], v[128:143]
    ds_read_b64_tr_b16 v[72:73], v15 offset:53248
    ds_read_b64_tr_b16 v[74:75], v15 offset:53760
    s_waitcnt lgkmcnt(6)
    v_mfma_f32_32x32x16_bf16 v[144:159], v[92:95], v[60:63], v[144:159]
    ds_read_b64_tr_b16 v[76:77], v16 offset:53248
    ds_read_b64_tr_b16 v[78:79], v16 offset:53760
    s_waitcnt vmcnt(9)
    s_waitcnt lgkmcnt(6)
    v_mfma_f32_32x32x16_bf16 v[96:111], v[64:67], v[32:35], v[96:111]
    ds_read_b64_tr_b16 v[80:81], v15 offset:47104
    ds_read_b64_tr_b16 v[82:83], v15 offset:47616
    s_add_u32 s33, s35, 14336
    buffer_load_dwordx4 v[56:59], v13, s[44:47], s33 offen sc1
    s_waitcnt lgkmcnt(6)
    v_mfma_f32_32x32x16_bf16 v[112:127], v[68:71], v[32:35], v[112:127]
    ds_read_b64_tr_b16 v[84:85], v16 offset:47104
    ds_read_b64_tr_b16 v[86:87], v16 offset:47616
    s_waitcnt lgkmcnt(6)
    v_mfma_f32_32x32x16_bf16 v[128:143], v[72:75], v[32:35], v[128:143]
    ds_read_b64_tr_b16 v[88:89], v15 offset:55296
    ds_read_b64_tr_b16 v[90:91], v15 offset:55808
    s_waitcnt lgkmcnt(6)
    v_mfma_f32_32x32x16_bf16 v[144:159], v[76:79], v[32:35], v[144:159]
    ds_read_b64_tr_b16 v[92:93], v16 offset:55296
    ds_read_b64_tr_b16 v[94:95], v16 offset:55808
    s_waitcnt vmcnt(9)
    s_waitcnt lgkmcnt(6)
    v_mfma_f32_32x32x16_bf16 v[96:111], v[80:83], v[36:39], v[96:111]
    ds_read_b64_tr_b16 v[64:65], v15 offset:49152
    ds_read_b64_tr_b16 v[66:67], v15 offset:49664
    s_add_u32 s33, s35, 15360
    buffer_load_dwordx4 v[60:63], v13, s[44:47], s33 offen sc1
    s_waitcnt lgkmcnt(6)
    v_mfma_f32_32x32x16_bf16 v[112:127], v[84:87], v[36:39], v[112:127]
    ds_read_b64_tr_b16 v[68:69], v16 offset:49152
    ds_read_b64_tr_b16 v[70:71], v16 offset:49664
    s_waitcnt lgkmcnt(6)
    v_mfma_f32_32x32x16_bf16 v[128:143], v[88:91], v[36:39], v[128:143]
    ds_read_b64_tr_b16 v[72:73], v15 offset:57344
    ds_read_b64_tr_b16 v[74:75], v15 offset:57856
    s_waitcnt lgkmcnt(6)
    v_mfma_f32_32x32x16_bf16 v[144:159], v[92:95], v[36:39], v[144:159]
    ds_read_b64_tr_b16 v[76:77], v16 offset:57344
    ds_read_b64_tr_b16 v[78:79], v16 offset:57856
    s_waitcnt vmcnt(9)
    s_waitcnt lgkmcnt(6)
    v_mfma_f32_32x32x16_bf16 v[96:111], v[64:67], v[40:43], v[96:111]
    ds_read_b64_tr_b16 v[80:81], v15 offset:51200
    ds_read_b64_tr_b16 v[82:83], v15 offset:51712
    s_add_u32 s33, s35, 16384
    buffer_load_dwordx4 v[32:35], v13, s[44:47], s33 offen sc1
    s_waitcnt lgkmcnt(6)
    v_mfma_f32_32x32x16_bf16 v[112:127], v[68:71], v[40:43], v[112:127]
    ds_read_b64_tr_b16 v[84:85], v16 offset:51200
    ds_read_b64_tr_b16 v[86:87], v16 offset:51712
    s_waitcnt lgkmcnt(6)
    v_mfma_f32_32x32x16_bf16 v[128:143], v[72:75], v[40:43], v[128:143]
    ds_read_b64_tr_b16 v[88:89], v15 offset:59392
    ds_read_b64_tr_b16 v[90:91], v15 offset:59904
    s_waitcnt lgkmcnt(6)
    v_mfma_f32_32x32x16_bf16 v[144:159], v[76:79], v[40:43], v[144:159]
    ds_read_b64_tr_b16 v[92:93], v16 offset:59392
    ds_read_b64_tr_b16 v[94:95], v16 offset:59904
    s_waitcnt vmcnt(9)
    s_waitcnt lgkmcnt(6)
    v_mfma_f32_32x32x16_bf16 v[96:111], v[80:83], v[44:47], v[96:111]
    s_barrier
    ds_read_b64_tr_b16 v[64:65], v15 offset:61440
    ds_read_b64_tr_b16 v[66:67], v15 offset:61952
    s_add_u32 s33, s35, 17408
    buffer_load_dwordx4 v[36:39], v13, s[44:47], s33 offen sc1
    s_waitcnt lgkmcnt(6)
    v_mfma_f32_32x32x16_bf16 v[112:127], v[84:87], v[44:47], v[112:127]
    ds_read_b64_tr_b16 v[68:69], v16 offset:61440
    ds_read_b64_tr_b16 v[70:71], v16 offset:61952
    s_waitcnt lgkmcnt(6)
    v_mfma_f32_32x32x16_bf16 v[128:143], v[88:91], v[44:47], v[128:143]
    ds_read_b64_tr_b16 v[72:73], v17 offset:4096
    ds_read_b64_tr_b16 v[74:75], v17 offset:4608
    s_waitcnt lgkmcnt(6)
    v_mfma_f32_32x32x16_bf16 v[144:159], v[92:95], v[44:47], v[144:159]
    ds_read_b64_tr_b16 v[76:77], v18 offset:4096
    ds_read_b64_tr_b16 v[78:79], v18 offset:4608
    s_waitcnt vmcnt(5)
    s_waitcnt lgkmcnt(6)
    v_mfma_f32_32x32x16_bf16 v[96:111], v[64:67], v[48:51], v[96:111]
    ds_read_b64_tr_b16 v[80:81], v15 offset:63488
    ds_read_b64_tr_b16 v[82:83], v15 offset:64000
    s_add_u32 s33, s35, 18432
    buffer_load_dwordx4 v[40:43], v13, s[44:47], s33 offen sc1
    s_waitcnt lgkmcnt(6)
    v_mfma_f32_32x32x16_bf16 v[112:127], v[68:71], v[48:51], v[112:127]
    ds_read_b64_tr_b16 v[84:85], v16 offset:63488
    ds_read_b64_tr_b16 v[86:87], v16 offset:64000
    s_waitcnt lgkmcnt(6)
    v_mfma_f32_32x32x16_bf16 v[128:143], v[72:75], v[48:51], v[128:143]
    ds_read_b64_tr_b16 v[88:89], v17 offset:6144
    ds_read_b64_tr_b16 v[90:91], v17 offset:6656
    s_waitcnt lgkmcnt(6)
    v_mfma_f32_32x32x16_bf16 v[144:159], v[76:79], v[48:51], v[144:159]
    ds_read_b64_tr_b16 v[92:93], v18 offset:6144
    ds_read_b64_tr_b16 v[94:95], v18 offset:6656
    s_waitcnt vmcnt(5)
    s_waitcnt lgkmcnt(6)
    v_mfma_f32_32x32x16_bf16 v[96:111], v[80:83], v[52:55], v[96:111]
    ds_read_b64_tr_b16 v[64:65], v17 offset:0
    ds_read_b64_tr_b16 v[66:67], v17 offset:512
    s_add_u32 s33, s35, 19456
    buffer_load_dwordx4 v[44:47], v13, s[44:47], s33 offen sc1
    s_waitcnt lgkmcnt(6)
    v_mfma_f32_32x32x16_bf16 v[112:127], v[84:87], v[52:55], v[112:127]
    ds_read_b64_tr_b16 v[68:69], v18 offset:0
    ds_read_b64_tr_b16 v[70:71], v18 offset:512
    s_waitcnt lgkmcnt(6)
    v_mfma_f32_32x32x16_bf16 v[128:143], v[88:91], v[52:55], v[128:143]
    ds_read_b64_tr_b16 v[72:73], v17 offset:8192
    ds_read_b64_tr_b16 v[74:75], v17 offset:8704
    s_waitcnt lgkmcnt(6)
    v_mfma_f32_32x32x16_bf16 v[144:159], v[92:95], v[52:55], v[144:159]
    ds_read_b64_tr_b16 v[76:77], v18 offset:8192
    ds_read_b64_tr_b16 v[78:79], v18 offset:8704
    s_waitcnt vmcnt(5)
    s_waitcnt lgkmcnt(6)
    v_mfma_f32_32x32x16_bf16 v[96:111], v[64:67], v[56:59], v[96:111]
    ds_read_b64_tr_b16 v[80:81], v17 offset:2048
    ds_read_b64_tr_b16 v[82:83], v17 offset:2560
    s_add_u32 s33, s35, 20480
    buffer_load_dwordx4 v[48:51], v13, s[44:47], s33 offen sc1
    s_waitcnt lgkmcnt(6)
    v_mfma_f32_32x32x16_bf16 v[112:127], v[68:71], v[56:59], v[112:127]
    ds_read_b64_tr_b16 v[84:85], v18 offset:2048
    ds_read_b64_tr_b16 v[86:87], v18 offset:2560
    s_waitcnt lgkmcnt(6)
    v_mfma_f32_32x32x16_bf16 v[128:143], v[72:75], v[56:59], v[128:143]
    ds_read_b64_tr_b16 v[88:89], v17 offset:10240
    ds_read_b64_tr_b16 v[90:91], v17 offset:10752
    s_waitcnt lgkmcnt(6)
    v_mfma_f32_32x32x16_bf16 v[144:159], v[76:79], v[56:59], v[144:159]
    ds_read_b64_tr_b16 v[92:93], v18 offset:10240
    ds_read_b64_tr_b16 v[94:95], v18 offset:10752
    s_waitcnt vmcnt(5)
    s_waitcnt lgkmcnt(6)
    v_mfma_f32_32x32x16_bf16 v[96:111], v[80:83], v[60:63], v[96:111]
    s_barrier
    ds_read_b64_tr_b16 v[64:65], v17 offset:12288
    ds_read_b64_tr_b16 v[66:67], v17 offset:12800
    s_add_u32 s33, s35, 21504
    buffer_load_dwordx4 v[52:55], v13, s[44:47], s33 offen sc1
    s_waitcnt lgkmcnt(6)
    v_mfma_f32_32x32x16_bf16 v[112:127], v[84:87], v[60:63], v[112:127]
    ds_read_b64_tr_b16 v[68:69], v18 offset:12288
    ds_read_b64_tr_b16 v[70:71], v18 offset:12800
    s_waitcnt lgkmcnt(6)
    v_mfma_f32_32x32x16_bf16 v[128:143], v[88:91], v[60:63], v[128:143]
    ds_read_b64_tr_b16 v[72:73], v17 offset:20480
    ds_read_b64_tr_b16 v[74:75], v17 offset:20992
    s_waitcnt lgkmcnt(6)
    v_mfma_f32_32x32x16_bf16 v[144:159], v[92:95], v[60:63], v[144:159]
    ds_read_b64_tr_b16 v[76:77], v18 offset:20480
    ds_read_b64_tr_b16 v[78:79], v18 offset:20992
    s_waitcnt vmcnt(5)
    s_waitcnt lgkmcnt(6)
    v_mfma_f32_32x32x16_bf16 v[96:111], v[64:67], v[32:35], v[96:111]
    ds_read_b64_tr_b16 v[80:81], v17 offset:14336
    ds_read_b64_tr_b16 v[82:83], v17 offset:14848
    s_add_u32 s33, s35, 22528
    buffer_load_dwordx4 v[56:59], v13, s[44:47], s33 offen sc1
    s_waitcnt lgkmcnt(6)
    v_mfma_f32_32x32x16_bf16 v[112:127], v[68:71], v[32:35], v[112:127]
    ds_read_b64_tr_b16 v[84:85], v18 offset:14336
    ds_read_b64_tr_b16 v[86:87], v18 offset:14848
    s_waitcnt lgkmcnt(6)
    v_mfma_f32_32x32x16_bf16 v[128:143], v[72:75], v[32:35], v[128:143]
    ds_read_b64_tr_b16 v[88:89], v17 offset:22528
    ds_read_b64_tr_b16 v[90:91], v17 offset:23040
    s_waitcnt lgkmcnt(6)
    v_mfma_f32_32x32x16_bf16 v[144:159], v[76:79], v[32:35], v[144:159]
    ds_read_b64_tr_b16 v[92:93], v18 offset:22528
    ds_read_b64_tr_b16 v[94:95], v18 offset:23040
    s_waitcnt vmcnt(5)
    s_waitcnt lgkmcnt(6)
    v_mfma_f32_32x32x16_bf16 v[96:111], v[80:83], v[36:39], v[96:111]
    ds_read_b64_tr_b16 v[64:65], v17 offset:16384
    ds_read_b64_tr_b16 v[66:67], v17 offset:16896
    s_add_u32 s33, s35, 23552
    buffer_load_dwordx4 v[60:63], v13, s[44:47], s33 offen sc1
    s_waitcnt lgkmcnt(6)
    v_mfma_f32_32x32x16_bf16 v[112:127], v[84:87], v[36:39], v[112:127]
    ds_read_b64_tr_b16 v[68:69], v18 offset:16384
    ds_read_b64_tr_b16 v[70:71], v18 offset:16896
    s_waitcnt lgkmcnt(6)
    v_mfma_f32_32x32x16_bf16 v[128:143], v[88:91], v[36:39], v[128:143]
    ds_read_b64_tr_b16 v[72:73], v17 offset:24576
    ds_read_b64_tr_b16 v[74:75], v17 offset:25088
    s_waitcnt lgkmcnt(6)
    v_mfma_f32_32x32x16_bf16 v[144:159], v[92:95], v[36:39], v[144:159]
    ds_read_b64_tr_b16 v[76:77], v18 offset:24576
    ds_read_b64_tr_b16 v[78:79], v18 offset:25088
    s_waitcnt vmcnt(5)
    s_waitcnt lgkmcnt(6)
    v_mfma_f32_32x32x16_bf16 v[96:111], v[64:67], v[40:43], v[96:111]
    ds_read_b64_tr_b16 v[80:81], v17 offset:18432
    ds_read_b64_tr_b16 v[82:83], v17 offset:18944
    s_add_u32 s33, s35, 24576
    buffer_load_dwordx4 v[32:35], v13, s[44:47], s33 offen sc1
    s_waitcnt lgkmcnt(6)
    v_mfma_f32_32x32x16_bf16 v[112:127], v[68:71], v[40:43], v[112:127]
    ds_read_b64_tr_b16 v[84:85], v18 offset:18432
    ds_read_b64_tr_b16 v[86:87], v18 offset:18944
    s_waitcnt lgkmcnt(6)
    v_mfma_f32_32x32x16_bf16 v[128:143], v[72:75], v[40:43], v[128:143]
    ds_read_b64_tr_b16 v[88:89], v17 offset:26624
    ds_read_b64_tr_b16 v[90:91], v17 offset:27136
    s_waitcnt lgkmcnt(6)
    v_mfma_f32_32x32x16_bf16 v[144:159], v[76:79], v[40:43], v[144:159]
    ds_read_b64_tr_b16 v[92:93], v18 offset:26624
    ds_read_b64_tr_b16 v[94:95], v18 offset:27136
    s_waitcnt vmcnt(5)
    s_waitcnt lgkmcnt(6)
    v_mfma_f32_32x32x16_bf16 v[96:111], v[80:83], v[44:47], v[96:111]
    s_barrier
    ds_read_b64_tr_b16 v[64:65], v15 offset:0
    ds_read_b64_tr_b16 v[66:67], v15 offset:512
    s_add_u32 s33, s35, 25600
    buffer_load_dwordx4 v[36:39], v13, s[44:47], s33 offen sc1
    s_waitcnt lgkmcnt(6)
    v_mfma_f32_32x32x16_bf16 v[112:127], v[84:87], v[44:47], v[112:127]
    ds_read_b64_tr_b16 v[68:69], v16 offset:0
    ds_read_b64_tr_b16 v[70:71], v16 offset:512
    s_waitcnt lgkmcnt(6)
    v_mfma_f32_32x32x16_bf16 v[128:143], v[88:91], v[44:47], v[128:143]
    ds_read_b64_tr_b16 v[72:73], v15 offset:8192
    ds_read_b64_tr_b16 v[74:75], v15 offset:8704
    s_waitcnt lgkmcnt(6)
    v_mfma_f32_32x32x16_bf16 v[144:159], v[92:95], v[44:47], v[144:159]
    ds_read_b64_tr_b16 v[76:77], v16 offset:8192
    ds_read_b64_tr_b16 v[78:79], v16 offset:8704
    s_waitcnt vmcnt(5)
    s_waitcnt lgkmcnt(6)
    v_mfma_f32_32x32x16_bf16 v[96:111], v[64:67], v[48:51], v[96:111]
    ds_read_b64_tr_b16 v[80:81], v15 offset:2048
    ds_read_b64_tr_b16 v[82:83], v15 offset:2560
    s_add_u32 s33, s35, 26624
    buffer_load_dwordx4 v[40:43], v13, s[44:47], s33 offen sc1
    s_waitcnt lgkmcnt(6)
    v_mfma_f32_32x32x16_bf16 v[112:127], v[68:71], v[48:51], v[112:127]
    ds_read_b64_tr_b16 v[84:85], v16 offset:2048
    ds_read_b64_tr_b16 v[86:87], v16 offset:2560
    s_waitcnt lgkmcnt(6)
    v_mfma_f32_32x32x16_bf16 v[128:143], v[72:75], v[48:51], v[128:143]
    ds_read_b64_tr_b16 v[88:89], v15 offset:10240
    ds_read_b64_tr_b16 v[90:91], v15 offset:10752
    s_waitcnt lgkmcnt(6)
    v_mfma_f32_32x32x16_bf16 v[144:159], v[76:79], v[48:51], v[144:159]
    ds_read_b64_tr_b16 v[92:93], v16 offset:10240
    ds_read_b64_tr_b16 v[94:95], v16 offset:10752
    v_add_f32 v24, v24, v26
    v_add_f32 v25, v25, v27
    v_add_f32 v28, v28, v30
    v_add_f32 v29, v29, v31
    v_add_f32 v24, v24, v28
    v_add_f32 v25, v25, v29
    v_mov_b32 v26, v24
    v_mov_b32 v27, v25
    s_nop 0
    v_permlane32_swap_b32 v24, v26
    v_permlane32_swap_b32 v25, v27
    v_add_f32 v24, v24, v26
    v_add_f32 v25, v25, v27
    v_mul_f32 v4, 0x3acccccd, v24
    v_mul_f32 v8, 0x3acccccd, v25
    v_fma_f32 v8, -v4, v4, v8
    v_max_f32 v8, 0, v8
    v_add_f32 v8, 0x3727c5ac, v8
    v_rsq_f32 v5, v8
    s_nop 0
    v_mul_f32 v7, v5, v5
    v_mul_f32 v7, v7, v5
    v_mul_f32 v7, 0xbdd2d3e8, v7
    v_mul_f32 v5, 0xc0135761, v5
    v_lshlrev_b32 v6, 4, v3
    v_add_u32 v6, 32768, v6
    s_waitcnt vmcnt(5)
    s_waitcnt lgkmcnt(6)
    v_mfma_f32_32x32x16_bf16 v[96:111], v[80:83], v[52:55], v[96:111]
    ds_read_b64_tr_b16 v[64:65], v15 offset:4096
    ds_read_b64_tr_b16 v[66:67], v15 offset:4608
    s_add_u32 s33, s35, 27648
    buffer_load_dwordx4 v[44:47], v13, s[44:47], s33 offen sc1
    s_waitcnt lgkmcnt(6)
    v_mfma_f32_32x32x16_bf16 v[112:127], v[84:87], v[52:55], v[112:127]
    ds_read_b64_tr_b16 v[68:69], v16 offset:4096
    ds_read_b64_tr_b16 v[70:71], v16 offset:4608
    s_waitcnt lgkmcnt(6)
    v_mfma_f32_32x32x16_bf16 v[128:143], v[88:91], v[52:55], v[128:143]
    ds_read_b64_tr_b16 v[72:73], v15 offset:12288
    ds_read_b64_tr_b16 v[74:75], v15 offset:12800
    s_waitcnt lgkmcnt(6)
    v_mfma_f32_32x32x16_bf16 v[144:159], v[92:95], v[52:55], v[144:159]
    ds_read_b64_tr_b16 v[76:77], v16 offset:12288
    ds_read_b64_tr_b16 v[78:79], v16 offset:12800
    s_waitcnt vmcnt(5)
    s_waitcnt lgkmcnt(6)
    v_mfma_f32_32x32x16_bf16 v[96:111], v[64:67], v[56:59], v[96:111]
    ds_read_b64_tr_b16 v[80:81], v15 offset:6144
    ds_read_b64_tr_b16 v[82:83], v15 offset:6656
    s_add_u32 s33, s35, 28672
    buffer_load_dwordx4 v[48:51], v13, s[44:47], s33 offen sc1
    s_waitcnt lgkmcnt(6)
    v_mfma_f32_32x32x16_bf16 v[112:127], v[68:71], v[56:59], v[112:127]
    ds_read_b64_tr_b16 v[84:85], v16 offset:6144
    ds_read_b64_tr_b16 v[86:87], v16 offset:6656
    s_waitcnt lgkmcnt(6)
    v_mfma_f32_32x32x16_bf16 v[128:143], v[72:75], v[56:59], v[128:143]
    ds_read_b64_tr_b16 v[88:89], v15 offset:14336
    ds_read_b64_tr_b16 v[90:91], v15 offset:14848
    s_waitcnt lgkmcnt(6)
    v_mfma_f32_32x32x16_bf16 v[144:159], v[76:79], v[56:59], v[144:159]
    ds_read_b64_tr_b16 v[92:93], v16 offset:14336
    ds_read_b64_tr_b16 v[94:95], v16 offset:14848
    s_waitcnt vmcnt(5)
    s_waitcnt lgkmcnt(6)
    v_mfma_f32_32x32x16_bf16 v[96:111], v[80:83], v[60:63], v[96:111]
    s_barrier
    ds_read_b64_tr_b16 v[64:65], v15 offset:16384
    ds_read_b64_tr_b16 v[66:67], v15 offset:16896
    s_add_u32 s33, s35, 29696
    buffer_load_dwordx4 v[52:55], v13, s[44:47], s33 offen sc1
    s_waitcnt lgkmcnt(6)
    v_mfma_f32_32x32x16_bf16 v[112:127], v[84:87], v[60:63], v[112:127]
    ds_read_b64_tr_b16 v[68:69], v16 offset:16384
    ds_read_b64_tr_b16 v[70:71], v16 offset:16896
    s_waitcnt lgkmcnt(6)
    v_mfma_f32_32x32x16_bf16 v[128:143], v[88:91], v[60:63], v[128:143]
    ds_read_b64_tr_b16 v[72:73], v15 offset:24576
    ds_read_b64_tr_b16 v[74:75], v15 offset:25088
    s_waitcnt lgkmcnt(6)
    v_mfma_f32_32x32x16_bf16 v[144:159], v[92:95], v[60:63], v[144:159]
    ds_read_b64_tr_b16 v[76:77], v16 offset:24576
    ds_read_b64_tr_b16 v[78:79], v16 offset:25088
    s_waitcnt vmcnt(5)
    s_waitcnt lgkmcnt(6)
    v_mfma_f32_32x32x16_bf16 v[96:111], v[64:67], v[32:35], v[96:111]
    ds_read_b64_tr_b16 v[80:81], v15 offset:18432
    ds_read_b64_tr_b16 v[82:83], v15 offset:18944
    s_add_u32 s33, s35, 30720
    buffer_load_dwordx4 v[56:59], v13, s[44:47], s33 offen sc1
    s_waitcnt lgkmcnt(6)
    v_mfma_f32_32x32x16_bf16 v[112:127], v[68:71], v[32:35], v[112:127]
    ds_read_b64_tr_b16 v[84:85], v16 offset:18432
    ds_read_b64_tr_b16 v[86:87], v16 offset:18944
    s_waitcnt lgkmcnt(6)
    v_mfma_f32_32x32x16_bf16 v[128:143], v[72:75], v[32:35], v[128:143]
    ds_read_b64_tr_b16 v[88:89], v15 offset:26624
    ds_read_b64_tr_b16 v[90:91], v15 offset:27136
    s_waitcnt lgkmcnt(6)
    v_mfma_f32_32x32x16_bf16 v[144:159], v[76:79], v[32:35], v[144:159]
    ds_read_b64_tr_b16 v[92:93], v16 offset:26624
    ds_read_b64_tr_b16 v[94:95], v16 offset:27136
    s_waitcnt vmcnt(5)
    s_waitcnt lgkmcnt(6)
    v_mfma_f32_32x32x16_bf16 v[96:111], v[80:83], v[36:39], v[96:111]
    ds_read_b64_tr_b16 v[64:65], v15 offset:20480
    ds_read_b64_tr_b16 v[66:67], v15 offset:20992
    s_add_u32 s33, s35, 31744
    buffer_load_dwordx4 v[60:63], v13, s[44:47], s33 offen sc1
    s_waitcnt lgkmcnt(6)
    v_mfma_f32_32x32x16_bf16 v[112:127], v[84:87], v[36:39], v[112:127]
    ds_read_b64_tr_b16 v[68:69], v16 offset:20480
    ds_read_b64_tr_b16 v[70:71], v16 offset:20992
    s_waitcnt lgkmcnt(6)
    v_mfma_f32_32x32x16_bf16 v[128:143], v[88:91], v[36:39], v[128:143]
    ds_read_b64_tr_b16 v[72:73], v15 offset:28672
    ds_read_b64_tr_b16 v[74:75], v15 offset:29184
    s_waitcnt lgkmcnt(6)
    v_mfma_f32_32x32x16_bf16 v[144:159], v[92:95], v[36:39], v[144:159]
    ds_read_b64_tr_b16 v[76:77], v16 offset:28672
    ds_read_b64_tr_b16 v[78:79], v16 offset:29184
    s_waitcnt vmcnt(5)
    s_waitcnt lgkmcnt(6)
    v_mfma_f32_32x32x16_bf16 v[96:111], v[64:67], v[40:43], v[96:111]
    ds_read_b64_tr_b16 v[80:81], v15 offset:22528
    ds_read_b64_tr_b16 v[82:83], v15 offset:23040
    s_add_u32 s33, s35, 32768
    buffer_load_dwordx4 v[32:35], v13, s[44:47], s33 offen sc1
    s_waitcnt lgkmcnt(6)
    v_mfma_f32_32x32x16_bf16 v[112:127], v[68:71], v[40:43], v[112:127]
    ds_read_b64_tr_b16 v[84:85], v16 offset:22528
    ds_read_b64_tr_b16 v[86:87], v16 offset:23040
    s_waitcnt lgkmcnt(6)
    v_mfma_f32_32x32x16_bf16 v[128:143], v[72:75], v[40:43], v[128:143]
    ds_read_b64_tr_b16 v[88:89], v15 offset:30720
    ds_read_b64_tr_b16 v[90:91], v15 offset:31232
    s_waitcnt lgkmcnt(6)
    v_mfma_f32_32x32x16_bf16 v[144:159], v[76:79], v[40:43], v[144:159]
    ds_read_b64_tr_b16 v[92:93], v16 offset:30720
    ds_read_b64_tr_b16 v[94:95], v16 offset:31232
    s_waitcnt vmcnt(5)
    s_waitcnt lgkmcnt(6)
    v_mfma_f32_32x32x16_bf16 v[96:111], v[80:83], v[44:47], v[96:111]
    s_barrier
    ds_read_b64_tr_b16 v[64:65], v15 offset:45056
    ds_read_b64_tr_b16 v[66:67], v15 offset:45568
    s_add_u32 s33, s35, 33792
    buffer_load_dwordx4 v[36:39], v13, s[44:47], s33 offen sc1
    s_waitcnt lgkmcnt(6)
    v_mfma_f32_32x32x16_bf16 v[112:127], v[84:87], v[44:47], v[112:127]
    ds_read_b64_tr_b16 v[68:69], v16 offset:45056
    ds_read_b64_tr_b16 v[70:71], v16 offset:45568
    s_waitcnt lgkmcnt(6)
    v_mfma_f32_32x32x16_bf16 v[128:143], v[88:91], v[44:47], v[128:143]
    ds_read_b64_tr_b16 v[72:73], v15 offset:53248
    ds_read_b64_tr_b16 v[74:75], v15 offset:53760
    s_waitcnt lgkmcnt(6)
    v_mfma_f32_32x32x16_bf16 v[144:159], v[92:95], v[44:47], v[144:159]
    ds_read_b64_tr_b16 v[76:77], v16 offset:53248
    ds_read_b64_tr_b16 v[78:79], v16 offset:53760
    s_waitcnt vmcnt(5)
    s_waitcnt lgkmcnt(6)
    v_mfma_f32_32x32x16_bf16 v[96:111], v[64:67], v[48:51], v[96:111]
    ds_read_b64_tr_b16 v[80:81], v15 offset:47104
    ds_read_b64_tr_b16 v[82:83], v15 offset:47616
    s_add_u32 s33, s35, 34816
    buffer_load_dwordx4 v[40:43], v13, s[44:47], s33 offen sc1
    s_waitcnt lgkmcnt(6)
    v_mfma_f32_32x32x16_bf16 v[112:127], v[68:71], v[48:51], v[112:127]
    ds_read_b64_tr_b16 v[84:85], v16 offset:47104
    ds_read_b64_tr_b16 v[86:87], v16 offset:47616
    s_waitcnt lgkmcnt(6)
    v_mfma_f32_32x32x16_bf16 v[128:143], v[72:75], v[48:51], v[128:143]
    ds_read_b64_tr_b16 v[88:89], v15 offset:55296
    ds_read_b64_tr_b16 v[90:91], v15 offset:55808
    s_waitcnt lgkmcnt(6)
    v_mfma_f32_32x32x16_bf16 v[144:159], v[76:79], v[48:51], v[144:159]
    ds_read_b64_tr_b16 v[92:93], v16 offset:55296
    ds_read_b64_tr_b16 v[94:95], v16 offset:55808
    s_waitcnt vmcnt(5)
    s_waitcnt lgkmcnt(6)
    v_mfma_f32_32x32x16_bf16 v[96:111], v[80:83], v[52:55], v[96:111]
    ds_read_b64_tr_b16 v[64:65], v15 offset:49152
    ds_read_b64_tr_b16 v[66:67], v15 offset:49664
    s_add_u32 s33, s35, 35840
    buffer_load_dwordx4 v[44:47], v13, s[44:47], s33 offen sc1
    s_waitcnt lgkmcnt(6)
    v_mfma_f32_32x32x16_bf16 v[112:127], v[84:87], v[52:55], v[112:127]
    ds_read_b64_tr_b16 v[68:69], v16 offset:49152
    ds_read_b64_tr_b16 v[70:71], v16 offset:49664
    s_waitcnt lgkmcnt(6)
    v_mfma_f32_32x32x16_bf16 v[128:143], v[88:91], v[52:55], v[128:143]
    ds_read_b64_tr_b16 v[72:73], v15 offset:57344
    ds_read_b64_tr_b16 v[74:75], v15 offset:57856
    s_waitcnt lgkmcnt(6)
    v_mfma_f32_32x32x16_bf16 v[144:159], v[92:95], v[52:55], v[144:159]
    ds_read_b64_tr_b16 v[76:77], v16 offset:57344
    ds_read_b64_tr_b16 v[78:79], v16 offset:57856
    s_waitcnt vmcnt(5)
    s_waitcnt lgkmcnt(6)
    v_mfma_f32_32x32x16_bf16 v[96:111], v[64:67], v[56:59], v[96:111]
    ds_read_b64_tr_b16 v[80:81], v15 offset:51200
    ds_read_b64_tr_b16 v[82:83], v15 offset:51712
    s_add_u32 s33, s35, 36864
    buffer_load_dwordx4 v[48:51], v13, s[44:47], s33 offen sc1
    s_waitcnt lgkmcnt(6)
    v_mfma_f32_32x32x16_bf16 v[112:127], v[68:71], v[56:59], v[112:127]
    ds_read_b64_tr_b16 v[84:85], v16 offset:51200
    ds_read_b64_tr_b16 v[86:87], v16 offset:51712
    s_waitcnt lgkmcnt(6)
    v_mfma_f32_32x32x16_bf16 v[128:143], v[72:75], v[56:59], v[128:143]
    ds_read_b64_tr_b16 v[88:89], v15 offset:59392
    ds_read_b64_tr_b16 v[90:91], v15 offset:59904
    s_waitcnt lgkmcnt(6)
    v_mfma_f32_32x32x16_bf16 v[144:159], v[76:79], v[56:59], v[144:159]
    ds_read_b64_tr_b16 v[92:93], v16 offset:59392
    ds_read_b64_tr_b16 v[94:95], v16 offset:59904
    s_waitcnt vmcnt(5)
    s_waitcnt lgkmcnt(6)
    v_mfma_f32_32x32x16_bf16 v[96:111], v[80:83], v[60:63], v[96:111]
    s_barrier
    ds_read_b64_tr_b16 v[64:65], v15 offset:61440
    ds_read_b64_tr_b16 v[66:67], v15 offset:61952
    s_add_u32 s33, s35, 37888
    buffer_load_dwordx4 v[52:55], v13, s[44:47], s33 offen sc1
    s_waitcnt lgkmcnt(6)
    v_mfma_f32_32x32x16_bf16 v[112:127], v[84:87], v[60:63], v[112:127]
    ds_read_b64_tr_b16 v[68:69], v16 offset:61440
    ds_read_b64_tr_b16 v[70:71], v16 offset:61952
    s_waitcnt lgkmcnt(6)
    v_mfma_f32_32x32x16_bf16 v[128:143], v[88:91], v[60:63], v[128:143]
    ds_read_b64_tr_b16 v[72:73], v17 offset:4096
    ds_read_b64_tr_b16 v[74:75], v17 offset:4608
    s_waitcnt lgkmcnt(6)
    v_mfma_f32_32x32x16_bf16 v[144:159], v[92:95], v[60:63], v[144:159]
    ds_read_b64_tr_b16 v[76:77], v18 offset:4096
    ds_read_b64_tr_b16 v[78:79], v18 offset:4608
    s_waitcnt vmcnt(5)
    s_waitcnt lgkmcnt(6)
    v_mfma_f32_32x32x16_bf16 v[96:111], v[64:67], v[32:35], v[96:111]
    ds_read_b64_tr_b16 v[80:81], v15 offset:63488
    ds_read_b64_tr_b16 v[82:83], v15 offset:64000
    s_add_u32 s33, s35, 38912
    buffer_load_dwordx4 v[56:59], v13, s[44:47], s33 offen sc1
    s_waitcnt lgkmcnt(6)
    v_mfma_f32_32x32x16_bf16 v[112:127], v[68:71], v[32:35], v[112:127]
    ds_read_b64_tr_b16 v[84:85], v16 offset:63488
    ds_read_b64_tr_b16 v[86:87], v16 offset:64000
    s_waitcnt lgkmcnt(6)
    v_mfma_f32_32x32x16_bf16 v[128:143], v[72:75], v[32:35], v[128:143]
    ds_read_b64_tr_b16 v[88:89], v17 offset:6144
    ds_read_b64_tr_b16 v[90:91], v17 offset:6656
    s_waitcnt lgkmcnt(6)
    v_mfma_f32_32x32x16_bf16 v[144:159], v[76:79], v[32:35], v[144:159]
    ds_read_b64_tr_b16 v[92:93], v18 offset:6144
    ds_read_b64_tr_b16 v[94:95], v18 offset:6656
    s_waitcnt vmcnt(5)
    s_waitcnt lgkmcnt(6)
    v_mfma_f32_32x32x16_bf16 v[96:111], v[80:83], v[36:39], v[96:111]
    ds_read_b64_tr_b16 v[64:65], v17 offset:0
    ds_read_b64_tr_b16 v[66:67], v17 offset:512
    s_add_u32 s33, s35, 39936
    buffer_load_dwordx4 v[60:63], v13, s[44:47], s33 offen sc1
    s_waitcnt lgkmcnt(6)
    v_mfma_f32_32x32x16_bf16 v[112:127], v[84:87], v[36:39], v[112:127]
    ds_read_b64_tr_b16 v[68:69], v18 offset:0
    ds_read_b64_tr_b16 v[70:71], v18 offset:512
    s_waitcnt lgkmcnt(6)
    v_mfma_f32_32x32x16_bf16 v[128:143], v[88:91], v[36:39], v[128:143]
    ds_read_b64_tr_b16 v[72:73], v17 offset:8192
    ds_read_b64_tr_b16 v[74:75], v17 offset:8704
    s_waitcnt lgkmcnt(6)
    v_mfma_f32_32x32x16_bf16 v[144:159], v[92:95], v[36:39], v[144:159]
    ds_read_b64_tr_b16 v[76:77], v18 offset:8192
    ds_read_b64_tr_b16 v[78:79], v18 offset:8704
    s_waitcnt vmcnt(5)
    s_waitcnt lgkmcnt(6)
    v_mfma_f32_32x32x16_bf16 v[96:111], v[64:67], v[40:43], v[96:111]
    ds_read_b64_tr_b16 v[80:81], v17 offset:2048
    ds_read_b64_tr_b16 v[82:83], v17 offset:2560
    s_waitcnt lgkmcnt(6)
    v_mfma_f32_32x32x16_bf16 v[112:127], v[68:71], v[40:43], v[112:127]
    ds_read_b64_tr_b16 v[84:85], v18 offset:2048
    ds_read_b64_tr_b16 v[86:87], v18 offset:2560
    s_waitcnt lgkmcnt(6)
    v_mfma_f32_32x32x16_bf16 v[128:143], v[72:75], v[40:43], v[128:143]
    ds_read_b64_tr_b16 v[88:89], v17 offset:10240
    ds_read_b64_tr_b16 v[90:91], v17 offset:10752
    s_waitcnt lgkmcnt(6)
    v_mfma_f32_32x32x16_bf16 v[144:159], v[76:79], v[40:43], v[144:159]
    ds_read_b64_tr_b16 v[92:93], v18 offset:10240
    ds_read_b64_tr_b16 v[94:95], v18 offset:10752
    s_waitcnt vmcnt(4)
    s_waitcnt lgkmcnt(6)
    v_mfma_f32_32x32x16_bf16 v[96:111], v[80:83], v[44:47], v[96:111]
    s_barrier
    ds_read_b64_tr_b16 v[64:65], v17 offset:12288
    ds_read_b64_tr_b16 v[66:67], v17 offset:12800
    s_waitcnt lgkmcnt(6)
    v_mfma_f32_32x32x16_bf16 v[112:127], v[84:87], v[44:47], v[112:127]
    ds_read_b64_tr_b16 v[68:69], v18 offset:12288
    ds_read_b64_tr_b16 v[70:71], v18 offset:12800
    s_waitcnt lgkmcnt(6)
    v_mfma_f32_32x32x16_bf16 v[128:143], v[88:91], v[44:47], v[128:143]
    ds_read_b64_tr_b16 v[72:73], v17 offset:20480
    ds_read_b64_tr_b16 v[74:75], v17 offset:20992
    s_waitcnt lgkmcnt(6)
    v_mfma_f32_32x32x16_bf16 v[144:159], v[92:95], v[44:47], v[144:159]
    ds_read_b64_tr_b16 v[76:77], v18 offset:20480
    ds_read_b64_tr_b16 v[78:79], v18 offset:20992
    s_waitcnt vmcnt(3)
    s_waitcnt lgkmcnt(6)
    v_mfma_f32_32x32x16_bf16 v[96:111], v[64:67], v[48:51], v[96:111]
    ds_read_b64_tr_b16 v[80:81], v17 offset:14336
    ds_read_b64_tr_b16 v[82:83], v17 offset:14848
    s_waitcnt lgkmcnt(6)
    v_mfma_f32_32x32x16_bf16 v[112:127], v[68:71], v[48:51], v[112:127]
    ds_read_b64_tr_b16 v[84:85], v18 offset:14336
    ds_read_b64_tr_b16 v[86:87], v18 offset:14848
    s_waitcnt lgkmcnt(6)
    v_mfma_f32_32x32x16_bf16 v[128:143], v[72:75], v[48:51], v[128:143]
    ds_read_b64_tr_b16 v[88:89], v17 offset:22528
    ds_read_b64_tr_b16 v[90:91], v17 offset:23040
    s_waitcnt lgkmcnt(6)
    v_mfma_f32_32x32x16_bf16 v[144:159], v[76:79], v[48:51], v[144:159]
    ds_read_b64_tr_b16 v[92:93], v18 offset:22528
    ds_read_b64_tr_b16 v[94:95], v18 offset:23040
    s_waitcnt vmcnt(2)
    s_waitcnt lgkmcnt(6)
    v_mfma_f32_32x32x16_bf16 v[96:111], v[80:83], v[52:55], v[96:111]
    ds_read_b64_tr_b16 v[64:65], v17 offset:16384
    ds_read_b64_tr_b16 v[66:67], v17 offset:16896
    s_waitcnt lgkmcnt(6)
    v_mfma_f32_32x32x16_bf16 v[112:127], v[84:87], v[52:55], v[112:127]
    ds_read_b64_tr_b16 v[68:69], v18 offset:16384
    ds_read_b64_tr_b16 v[70:71], v18 offset:16896
    s_waitcnt lgkmcnt(6)
    v_mfma_f32_32x32x16_bf16 v[128:143], v[88:91], v[52:55], v[128:143]
    ds_read_b64_tr_b16 v[72:73], v17 offset:24576
    ds_read_b64_tr_b16 v[74:75], v17 offset:25088
    s_waitcnt lgkmcnt(6)
    v_mfma_f32_32x32x16_bf16 v[144:159], v[92:95], v[52:55], v[144:159]
    ds_read_b64_tr_b16 v[76:77], v18 offset:24576
    ds_read_b64_tr_b16 v[78:79], v18 offset:25088
    s_waitcnt vmcnt(1)
    s_waitcnt lgkmcnt(6)
    v_mfma_f32_32x32x16_bf16 v[96:111], v[64:67], v[56:59], v[96:111]
    s_barrier
    ds_read_b64_tr_b16 v[80:81], v17 offset:18432
    ds_read_b64_tr_b16 v[82:83], v17 offset:18944
    s_waitcnt lgkmcnt(6)
    v_mfma_f32_32x32x16_bf16 v[112:127], v[68:71], v[56:59], v[112:127]
    ds_read_b64_tr_b16 v[84:85], v18 offset:18432
    ds_read_b64_tr_b16 v[86:87], v18 offset:18944
    s_waitcnt lgkmcnt(6)
    v_mfma_f32_32x32x16_bf16 v[128:143], v[72:75], v[56:59], v[128:143]
    ds_read_b64_tr_b16 v[88:89], v17 offset:26624
    ds_read_b64_tr_b16 v[90:91], v17 offset:27136
    s_waitcnt lgkmcnt(6)
    v_mfma_f32_32x32x16_bf16 v[144:159], v[76:79], v[56:59], v[144:159]
    ds_read_b64_tr_b16 v[92:93], v18 offset:26624
    ds_read_b64_tr_b16 v[94:95], v18 offset:27136
    s_waitcnt vmcnt(0)
    s_waitcnt lgkmcnt(6)
    v_mfma_f32_32x32x16_bf16 v[96:111], v[80:83], v[60:63], v[96:111]
    s_waitcnt lgkmcnt(4)
    v_mfma_f32_32x32x16_bf16 v[112:127], v[84:87], v[60:63], v[112:127]
    s_waitcnt lgkmcnt(2)
    v_mfma_f32_32x32x16_bf16 v[128:143], v[88:91], v[60:63], v[128:143]
    s_waitcnt lgkmcnt(0)
    v_mfma_f32_32x32x16_bf16 v[144:159], v[92:95], v[60:63], v[144:159]
    s_barrier
    s_cmp_lt_u32 s3, 4
    s_cbranch_scc1 sequential_preLN__sliding_block__geglu_ffn__prompt_kernel_py48
    s_setprio 1
sequential_preLN__sliding_block__geglu_ffn__prompt_kernel_py48:
    s_add_u32 s38, s37, 0
    ds_read_b128 v[32:35], v6 offset:0
    ds_read_b128 v[48:51], v6 offset:256
    ds_read_b128 v[36:39], v6 offset:32
    ds_read_b128 v[52:55], v6 offset:288
    ds_read_b128 v[40:43], v6 offset:64
    ds_read_b128 v[56:59], v6 offset:320
    ds_read_b128 v[44:47], v6 offset:96
    ds_read_b128 v[60:63], v6 offset:352
    s_waitcnt lgkmcnt(4)
    v_fma_f32 v96, -v4, v32, v96
    v_fma_f32 v97, -v4, v33, v97
    v_fma_f32 v98, -v4, v34, v98
    v_fma_f32 v99, -v4, v35, v99
    v_fma_f32 v100, -v4, v36, v100
    v_fma_f32 v101, -v4, v37, v101
    v_fma_f32 v102, -v4, v38, v102
    v_fma_f32 v103, -v4, v39, v103
    v_mul_f32 v64, v96, v96
    v_mul_f32 v65, v97, v97
    v_mul_f32 v66, v98, v98
    v_mul_f32 v67, v99, v99
    v_mul_f32 v68, v100, v100
    v_mul_f32 v69, v101, v101
    v_mul_f32 v70, v102, v102
    v_mul_f32 v71, v103, v103
    v_fma_f32 v64, v64, v7, v5
    v_fma_f32 v65, v65, v7, v5
    v_fma_f32 v66, v66, v7, v5
    v_fma_f32 v67, v67, v7, v5
    v_fma_f32 v68, v68, v7, v5
    v_fma_f32 v69, v69, v7, v5
    v_fma_f32 v70, v70, v7, v5
    v_fma_f32 v71, v71, v7, v5
    v_mul_f32 v64, v64, v96
    v_mul_f32 v65, v65, v97
    v_mul_f32 v66, v66, v98
    v_mul_f32 v67, v67, v99
    v_mul_f32 v68, v68, v100
    v_mul_f32 v69, v69, v101
    v_mul_f32 v70, v70, v102
    v_mul_f32 v71, v71, v103
    v_exp_f32 v64, v64
    v_fma_f32 v128, -v4, v48, v128
    v_exp_f32 v65, v65
    v_fma_f32 v129, -v4, v49, v129
    v_exp_f32 v66, v66
    v_fma_f32 v130, -v4, v50, v130
    v_exp_f32 v67, v67
    v_fma_f32 v131, -v4, v51, v131
    v_exp_f32 v68, v68
    v_fma_f32 v132, -v4, v52, v132
    v_exp_f32 v69, v69
    v_fma_f32 v133, -v4, v53, v133
    v_exp_f32 v70, v70
    v_fma_f32 v134, -v4, v54, v134
    v_exp_f32 v71, v71
    v_fma_f32 v135, -v4, v55, v135
    v_fma_f32 v64, v64, v8, v8
    v_fma_f32 v65, v65, v8, v8
    v_fma_f32 v66, v66, v8, v8
    v_fma_f32 v67, v67, v8, v8
    v_fma_f32 v68, v68, v8, v8
    v_fma_f32 v69, v69, v8, v8
    v_fma_f32 v70, v70, v8, v8
    v_fma_f32 v71, v71, v8, v8
    v_rcp_f32 v64, v64
    v_mul_f32 v96, v96, v128
    v_rcp_f32 v65, v65
    v_mul_f32 v97, v97, v129
    v_rcp_f32 v66, v66
    v_mul_f32 v98, v98, v130
    v_rcp_f32 v67, v67
    v_mul_f32 v99, v99, v131
    v_rcp_f32 v68, v68
    v_mul_f32 v100, v100, v132
    v_rcp_f32 v69, v69
    v_mul_f32 v101, v101, v133
    v_rcp_f32 v70, v70
    v_mul_f32 v102, v102, v134
    v_rcp_f32 v71, v71
    v_mul_f32 v103, v103, v135
    v_mul_f32 v96, v96, v64
    v_mul_f32 v97, v97, v65
    v_mul_f32 v98, v98, v66
    v_mul_f32 v99, v99, v67
    v_mul_f32 v100, v100, v68
    v_mul_f32 v101, v101, v69
    v_mul_f32 v102, v102, v70
    v_mul_f32 v103, v103, v71
    v_cvt_pk_bf16_f32 v128, v96, v97
    v_cvt_pk_bf16_f32 v129, v98, v99
    v_cvt_pk_bf16_f32 v130, v100, v101
    v_cvt_pk_bf16_f32 v131, v102, v103
    buffer_store_dwordx4 v[128:131], v14, s[48:51], s38 offen offset:0 sc1
    s_waitcnt lgkmcnt(0)
    v_fma_f32 v104, -v4, v40, v104
    v_fma_f32 v105, -v4, v41, v105
    v_fma_f32 v106, -v4, v42, v106
    v_fma_f32 v107, -v4, v43, v107
    v_fma_f32 v108, -v4, v44, v108
    v_fma_f32 v109, -v4, v45, v109
    v_fma_f32 v110, -v4, v46, v110
    v_fma_f32 v111, -v4, v47, v111
    v_mul_f32 v64, v104, v104
    v_mul_f32 v65, v105, v105
    v_mul_f32 v66, v106, v106
    v_mul_f32 v67, v107, v107
    v_mul_f32 v68, v108, v108
    v_mul_f32 v69, v109, v109
    v_mul_f32 v70, v110, v110
    v_mul_f32 v71, v111, v111
    v_fma_f32 v64, v64, v7, v5
    v_fma_f32 v65, v65, v7, v5
    v_fma_f32 v66, v66, v7, v5
    v_fma_f32 v67, v67, v7, v5
    v_fma_f32 v68, v68, v7, v5
    v_fma_f32 v69, v69, v7, v5
    v_fma_f32 v70, v70, v7, v5
    v_fma_f32 v71, v71, v7, v5
    v_mul_f32 v64, v64, v104
    v_mul_f32 v65, v65, v105
    v_mul_f32 v66, v66, v106
    v_mul_f32 v67, v67, v107
    v_mul_f32 v68, v68, v108
    v_mul_f32 v69, v69, v109
    v_mul_f32 v70, v70, v110
    v_mul_f32 v71, v71, v111
    v_exp_f32 v64, v64
    v_fma_f32 v136, -v4, v56, v136
    v_exp_f32 v65, v65
    v_fma_f32 v137, -v4, v57, v137
    v_exp_f32 v66, v66
    v_fma_f32 v138, -v4, v58, v138
    v_exp_f32 v67, v67
    v_fma_f32 v139, -v4, v59, v139
    v_exp_f32 v68, v68
    v_fma_f32 v140, -v4, v60, v140
    v_exp_f32 v69, v69
    v_fma_f32 v141, -v4, v61, v141
    v_exp_f32 v70, v70
    v_fma_f32 v142, -v4, v62, v142
    v_exp_f32 v71, v71
    v_fma_f32 v143, -v4, v63, v143
    v_fma_f32 v64, v64, v8, v8
    v_fma_f32 v65, v65, v8, v8
    v_fma_f32 v66, v66, v8, v8
    v_fma_f32 v67, v67, v8, v8
    v_fma_f32 v68, v68, v8, v8
    v_fma_f32 v69, v69, v8, v8
    v_fma_f32 v70, v70, v8, v8
    v_fma_f32 v71, v71, v8, v8
    v_rcp_f32 v64, v64
    v_mul_f32 v104, v104, v136
    v_rcp_f32 v65, v65
    v_mul_f32 v105, v105, v137
    v_rcp_f32 v66, v66
    v_mul_f32 v106, v106, v138
    v_rcp_f32 v67, v67
    v_mul_f32 v107, v107, v139
    v_rcp_f32 v68, v68
    v_mul_f32 v108, v108, v140
    v_rcp_f32 v69, v69
    v_mul_f32 v109, v109, v141
    v_rcp_f32 v70, v70
    v_mul_f32 v110, v110, v142
    v_rcp_f32 v71, v71
    v_mul_f32 v111, v111, v143
    v_mul_f32 v104, v104, v64
    v_mul_f32 v105, v105, v65
    v_mul_f32 v106, v106, v66
    v_mul_f32 v107, v107, v67
    v_mul_f32 v108, v108, v68
    v_mul_f32 v109, v109, v69
    v_mul_f32 v110, v110, v70
    v_mul_f32 v111, v111, v71
    v_cvt_pk_bf16_f32 v136, v104, v105
    v_cvt_pk_bf16_f32 v137, v106, v107
    v_cvt_pk_bf16_f32 v138, v108, v109
    v_cvt_pk_bf16_f32 v139, v110, v111
    buffer_store_dwordx4 v[136:139], v14, s[48:51], s38 offen offset:512 sc1
    s_add_u32 s38, s37, 1024
    ds_read_b128 v[32:35], v6 offset:128
    ds_read_b128 v[48:51], v6 offset:384
    ds_read_b128 v[36:39], v6 offset:160
    ds_read_b128 v[52:55], v6 offset:416
    ds_read_b128 v[40:43], v6 offset:192
    ds_read_b128 v[56:59], v6 offset:448
    ds_read_b128 v[44:47], v6 offset:224
    ds_read_b128 v[60:63], v6 offset:480
    s_waitcnt lgkmcnt(4)
    s_setprio 0
    v_fma_f32 v112, -v4, v32, v112
    v_fma_f32 v113, -v4, v33, v113
    v_fma_f32 v114, -v4, v34, v114
    v_fma_f32 v115, -v4, v35, v115
    v_fma_f32 v116, -v4, v36, v116
    v_fma_f32 v117, -v4, v37, v117
    v_fma_f32 v118, -v4, v38, v118
    v_fma_f32 v119, -v4, v39, v119
    v_mul_f32 v64, v112, v112
    v_mul_f32 v65, v113, v113
    v_mul_f32 v66, v114, v114
    v_mul_f32 v67, v115, v115
    v_mul_f32 v68, v116, v116
    v_mul_f32 v69, v117, v117
    v_mul_f32 v70, v118, v118
    v_mul_f32 v71, v119, v119
    v_fma_f32 v64, v64, v7, v5
    v_fma_f32 v65, v65, v7, v5
    v_fma_f32 v66, v66, v7, v5
    v_fma_f32 v67, v67, v7, v5
    v_fma_f32 v68, v68, v7, v5
    v_fma_f32 v69, v69, v7, v5
    v_fma_f32 v70, v70, v7, v5
    v_fma_f32 v71, v71, v7, v5
    v_mul_f32 v64, v64, v112
    v_mul_f32 v65, v65, v113
    v_mul_f32 v66, v66, v114
    v_mul_f32 v67, v67, v115
    v_mul_f32 v68, v68, v116
    v_mul_f32 v69, v69, v117
    v_mul_f32 v70, v70, v118
    v_mul_f32 v71, v71, v119
    v_exp_f32 v64, v64
    v_fma_f32 v144, -v4, v48, v144
    v_exp_f32 v65, v65
    v_fma_f32 v145, -v4, v49, v145
    v_exp_f32 v66, v66
    v_fma_f32 v146, -v4, v50, v146
    v_exp_f32 v67, v67
    v_fma_f32 v147, -v4, v51, v147
    v_exp_f32 v68, v68
    v_fma_f32 v148, -v4, v52, v148
    v_exp_f32 v69, v69
    v_fma_f32 v149, -v4, v53, v149
    v_exp_f32 v70, v70
    v_fma_f32 v150, -v4, v54, v150
    v_exp_f32 v71, v71
    v_fma_f32 v151, -v4, v55, v151
    v_fma_f32 v64, v64, v8, v8
    v_fma_f32 v65, v65, v8, v8
    v_fma_f32 v66, v66, v8, v8
    v_fma_f32 v67, v67, v8, v8
    v_fma_f32 v68, v68, v8, v8
    v_fma_f32 v69, v69, v8, v8
    v_fma_f32 v70, v70, v8, v8
    v_fma_f32 v71, v71, v8, v8
    v_rcp_f32 v64, v64
    v_mul_f32 v112, v112, v144
    v_rcp_f32 v65, v65
    v_mul_f32 v113, v113, v145
    v_rcp_f32 v66, v66
    v_mul_f32 v114, v114, v146
    v_rcp_f32 v67, v67
    v_mul_f32 v115, v115, v147
    v_rcp_f32 v68, v68
    v_mul_f32 v116, v116, v148
    v_rcp_f32 v69, v69
    v_mul_f32 v117, v117, v149
    v_rcp_f32 v70, v70
    v_mul_f32 v118, v118, v150
    v_rcp_f32 v71, v71
    v_mul_f32 v119, v119, v151
    v_mul_f32 v112, v112, v64
    v_mul_f32 v113, v113, v65
    v_mul_f32 v114, v114, v66
    v_mul_f32 v115, v115, v67
    v_mul_f32 v116, v116, v68
    v_mul_f32 v117, v117, v69
    v_mul_f32 v118, v118, v70
    v_mul_f32 v119, v119, v71
    v_cvt_pk_bf16_f32 v144, v112, v113
    v_cvt_pk_bf16_f32 v145, v114, v115
    v_cvt_pk_bf16_f32 v146, v116, v117
    v_cvt_pk_bf16_f32 v147, v118, v119
    buffer_store_dwordx4 v[144:147], v14, s[48:51], s38 offen offset:0 sc1
    s_waitcnt lgkmcnt(0)
    v_fma_f32 v120, -v4, v40, v120
    v_fma_f32 v121, -v4, v41, v121
    v_fma_f32 v122, -v4, v42, v122
    v_fma_f32 v123, -v4, v43, v123
    v_fma_f32 v124, -v4, v44, v124
    v_fma_f32 v125, -v4, v45, v125
    v_fma_f32 v126, -v4, v46, v126
    v_fma_f32 v127, -v4, v47, v127
    v_mul_f32 v64, v120, v120
    v_mul_f32 v65, v121, v121
    v_mul_f32 v66, v122, v122
    v_mul_f32 v67, v123, v123
    v_mul_f32 v68, v124, v124
    v_mul_f32 v69, v125, v125
    v_mul_f32 v70, v126, v126
    v_mul_f32 v71, v127, v127
    v_fma_f32 v64, v64, v7, v5
    v_fma_f32 v65, v65, v7, v5
    v_fma_f32 v66, v66, v7, v5
    v_fma_f32 v67, v67, v7, v5
    v_fma_f32 v68, v68, v7, v5
    v_fma_f32 v69, v69, v7, v5
    v_fma_f32 v70, v70, v7, v5
    v_fma_f32 v71, v71, v7, v5
    v_mul_f32 v64, v64, v120
    v_mul_f32 v65, v65, v121
    v_mul_f32 v66, v66, v122
    v_mul_f32 v67, v67, v123
    v_mul_f32 v68, v68, v124
    v_mul_f32 v69, v69, v125
    v_mul_f32 v70, v70, v126
    v_mul_f32 v71, v71, v127
    v_exp_f32 v64, v64
    v_fma_f32 v152, -v4, v56, v152
    v_exp_f32 v65, v65
    v_fma_f32 v153, -v4, v57, v153
    v_exp_f32 v66, v66
    v_fma_f32 v154, -v4, v58, v154
    v_exp_f32 v67, v67
    v_fma_f32 v155, -v4, v59, v155
    v_exp_f32 v68, v68
    v_fma_f32 v156, -v4, v60, v156
    v_exp_f32 v69, v69
    v_fma_f32 v157, -v4, v61, v157
    v_exp_f32 v70, v70
    v_fma_f32 v158, -v4, v62, v158
    v_exp_f32 v71, v71
    v_fma_f32 v159, -v4, v63, v159
    v_fma_f32 v64, v64, v8, v8
    v_fma_f32 v65, v65, v8, v8
    v_fma_f32 v66, v66, v8, v8
    v_fma_f32 v67, v67, v8, v8
    v_fma_f32 v68, v68, v8, v8
    v_fma_f32 v69, v69, v8, v8
    v_fma_f32 v70, v70, v8, v8
    v_fma_f32 v71, v71, v8, v8
    v_rcp_f32 v64, v64
    v_mul_f32 v120, v120, v152
    v_rcp_f32 v65, v65
    v_mul_f32 v121, v121, v153
    v_rcp_f32 v66, v66
    v_mul_f32 v122, v122, v154
    v_rcp_f32 v67, v67
    v_mul_f32 v123, v123, v155
    v_rcp_f32 v68, v68
    v_mul_f32 v124, v124, v156
    v_rcp_f32 v69, v69
    v_mul_f32 v125, v125, v157
    v_rcp_f32 v70, v70
    v_mul_f32 v126, v126, v158
    v_rcp_f32 v71, v71
    v_mul_f32 v127, v127, v159
    v_mul_f32 v120, v120, v64
    v_mul_f32 v121, v121, v65
    v_mul_f32 v122, v122, v66
    v_mul_f32 v123, v123, v67
    v_mul_f32 v124, v124, v68
    v_mul_f32 v125, v125, v69
    v_mul_f32 v126, v126, v70
    v_mul_f32 v127, v127, v71
    v_cvt_pk_bf16_f32 v152, v120, v121
    v_cvt_pk_bf16_f32 v153, v122, v123
    v_cvt_pk_bf16_f32 v154, v124, v125
    v_cvt_pk_bf16_f32 v155, v126, v127
    buffer_store_dwordx4 v[152:155], v14, s[48:51], s38 offen offset:512 sc1
    s_waitcnt vmcnt(0)
    s_setprio 0
    s_barrier
    s_branch sequential_preLN__sliding_block__geglu_ffn__prompt_kernel_p4_join47
    s_nop 0
sequential_preLN__sliding_block__geglu_ffn__prompt_kernel_p4_r46:
    s_sub_u32 s66, s3, 8
    s_mul_i32 s64, s66, 55296
    s_lshl_b32 s33, s62, 7
    s_add_u32 s64, s64, s33
    s_lshl_b32 s65, s66, 11
    v_lshrrev_b32 v4, 3, v1
    v_mul_u32_u24 v4, 3456, v4
    v_bfe_u32 v5, v1, 4, 1
    v_lshlrev_b32 v5, 2, v5
    v_and_b32 v6, 7, v1
    v_xor_b32 v6, v6, v5
    v_lshl_add_u32 v14, v6, 4, v4
    s_mov_b32 s68, s12
    s_and_b32 s69, s13, 0xffff
    s_mov_b32 s70, 0x21c000
    s_mov_b32 s71, 0x20000
    s_mov_b32 s72, s14
    s_and_b32 s73, s15, 0xffff
    s_mov_b32 s74, 0x21c000
    s_mov_b32 s75, 0x20000
    v_add_u32 v15, s65, v13
    v_add_u32 v16, 65536, v15
    v_add_u32 v17, 131072, v15
    v_lshlrev_b32 v18, 5, v6
    v_lshl_add_u32 v18, v5, 7, v18
    s_lshl_b32 s33, s66, 10
    s_add_u32 s33, s33, 33280
    v_add_u32 v18, s33, v18
    v_lshlrev_b32 v19, 3, v1
    v_add_u32 v19, 32768, v19
    v_mov_b32 v24, 0
    v_mov_b32 v25, 0
    v_mov_b32 v26, 0
    v_mov_b32 v27, 0
    v_mov_b32 v28, 0
    v_mov_b32 v29, 0
    v_mov_b32 v30, 0
    v_mov_b32 v31, 0
    v_mov_b32 v32, 0
    v_mov_b32 v33, 0
    v_mov_b32 v34, 0
    v_mov_b32 v35, 0
    v_mov_b32 v36, 0
    v_mov_b32 v37, 0
    v_mov_b32 v38, 0
    v_mov_b32 v39, 0
    s_add_u32 m0, s65, 45056
    s_add_u32 s33, s64, 442368
    buffer_load_dwordx4 v14, s[68:71], s33 offen lds
    s_add_u32 m0, s65, 53248
    s_add_u32 s33, s64, 442368
    buffer_load_dwordx4 v14, s[72:75], s33 offen lds
    s_add_u32 m0, s65, 46080
    s_add_u32 s33, s64, 470016
    buffer_load_dwordx4 v14, s[68:71], s33 offen lds
    s_add_u32 m0, s65, 54272
    s_add_u32 s33, s64, 470016
    buffer_load_dwordx4 v14, s[72:75], s33 offen lds
    s_add_u32 m0, s65, 61440
    s_add_u32 s33, s64, 663552
    buffer_load_dwordx4 v14, s[68:71], s33 offen lds
    s_add_u32 m0, s65, 69632
    s_add_u32 s33, s64, 663552
    buffer_load_dwordx4 v14, s[72:75], s33 offen lds
    s_add_u32 m0, s65, 62464
    s_add_u32 s33, s64, 691200
    buffer_load_dwordx4 v14, s[68:71], s33 offen lds
    s_add_u32 m0, s65, 70656
    s_add_u32 s33, s64, 691200
    buffer_load_dwordx4 v14, s[72:75], s33 offen lds
    s_add_u32 m0, s65, 77824
    s_add_u32 s33, s64, 884736
    buffer_load_dwordx4 v14, s[68:71], s33 offen lds
    s_add_u32 m0, s65, 86016
    s_add_u32 s33, s64, 884736
    buffer_load_dwordx4 v14, s[72:75], s33 offen lds
    s_add_u32 m0, s65, 78848
    s_add_u32 s33, s64, 912384
    buffer_load_dwordx4 v14, s[68:71], s33 offen lds
    s_add_u32 m0, s65, 87040
    s_add_u32 s33, s64, 912384
    buffer_load_dwordx4 v14, s[72:75], s33 offen lds
    s_cmp_lg_u32 s3, 11
    s_cbranch_scc1 sequential_preLN__sliding_block__geglu_ffn__prompt_kernel_wj50
    s_lshl_b32 s34, s63, 12
    s_add_u32 s34, s34, 98304
    s_mov_b32 s30, -1
    s_mov_b32 s31, 0
    s_mov_b32 s32, 0x40000
    v_lshlrev_b32 v8, 7, v1
    s_mov_b64 exec, s[30:31]
    s_nop 3
sequential_preLN__sliding_block__geglu_ffn__prompt_kernel_poll51:
    buffer_load_dword v4, v8, s[92:95], s34 offen sc1
    s_waitcnt vmcnt(0)
    v_xor_b32 v4, s24, v4
    v_cmp_ne_u32 vcc, 0, v4
    s_nop 0
    s_and_b64 s[28:29], vcc, s[30:31]
    s_cbranch_scc0 sequential_preLN__sliding_block__geglu_ffn__prompt_kernel_pdone52
    s_sub_u32 s32, s32, 1
    s_cbranch_scc1 sequential_preLN__sliding_block__geglu_ffn__prompt_kernel_pdone52
    s_sleep 1
    s_branch sequential_preLN__sliding_block__geglu_ffn__prompt_kernel_poll51
    s_nop 0
sequential_preLN__sliding_block__geglu_ffn__prompt_kernel_pdone52:
    s_mov_b64 exec, -1
    s_nop 0
sequential_preLN__sliding_block__geglu_ffn__prompt_kernel_wj50:
    s_barrier
    ds_read_b128 v[48:51], v15 offset:0
    ds_read_b128 v[52:55], v15 offset:1024
    ds_read_b128 v[56:59], v15 offset:8192
    ds_read_b128 v[60:63], v15 offset:9216
    s_waitcnt lgkmcnt(3)
    v_lshlrev_b32 v40, 16, v48
    v_and_b32 v41, 0xffff0000, v48
    v_lshlrev_b32 v42, 16, v49
    v_and_b32 v43, 0xffff0000, v49
    v_lshlrev_b32 v44, 16, v50
    v_and_b32 v45, 0xffff0000, v50
    v_lshlrev_b32 v46, 16, v51
    v_and_b32 v47, 0xffff0000, v51
    v_add_f32 v24, v24, v40
    v_add_f32 v25, v25, v41
    v_add_f32 v26, v26, v42
    v_add_f32 v27, v27, v43
    v_add_f32 v28, v28, v44
    v_add_f32 v29, v29, v45
    v_add_f32 v30, v30, v46
    v_add_f32 v31, v31, v47
    s_waitcnt lgkmcnt(2)
    v_lshlrev_b32 v40, 16, v52
    v_and_b32 v41, 0xffff0000, v52
    v_lshlrev_b32 v42, 16, v53
    v_and_b32 v43, 0xffff0000, v53
    v_lshlrev_b32 v44, 16, v54
    v_and_b32 v45, 0xffff0000, v54
    v_lshlrev_b32 v46, 16, v55
    v_and_b32 v47, 0xffff0000, v55
    v_add_f32 v24, v24, v40
    v_add_f32 v25, v25, v41
    v_add_f32 v26, v26, v42
    v_add_f32 v27, v27, v43
    v_add_f32 v28, v28, v44
    v_add_f32 v29, v29, v45
    v_add_f32 v30, v30, v46
    v_add_f32 v31, v31, v47
    s_waitcnt lgkmcnt(1)
    v_lshlrev_b32 v40, 16, v56
    v_and_b32 v41, 0xffff0000, v56
    v_lshlrev_b32 v42, 16, v57
    v_and_b32 v43, 0xffff0000, v57
    v_lshlrev_b32 v44, 16, v58
    v_and_b32 v45, 0xffff0000, v58
    v_lshlrev_b32 v46, 16, v59
    v_and_b32 v47, 0xffff0000, v59
    v_add_f32 v32, v32, v40
    v_add_f32 v33, v33, v41
    v_add_f32 v34, v34, v42
    v_add_f32 v35, v35, v43
    v_add_f32 v36, v36, v44
    v_add_f32 v37, v37, v45
    v_add_f32 v38, v38, v46
    v_add_f32 v39, v39, v47
    s_waitcnt lgkmcnt(0)
    v_lshlrev_b32 v40, 16, v60
    v_and_b32 v41, 0xffff0000, v60
    v_lshlrev_b32 v42, 16, v61
    v_and_b32 v43, 0xffff0000, v61
    v_lshlrev_b32 v44, 16, v62
    v_and_b32 v45, 0xffff0000, v62
    v_lshlrev_b32 v46, 16, v63
    v_and_b32 v47, 0xffff0000, v63
    v_add_f32 v32, v32, v40
    v_add_f32 v33, v33, v41
    v_add_f32 v34, v34, v42
    v_add_f32 v35, v35, v43
    v_add_f32 v36, v36, v44
    v_add_f32 v37, v37, v45
    v_add_f32 v38, v38, v46
    v_add_f32 v39, v39, v47
    ds_read_b128 v[48:51], v15 offset:16384
    ds_read_b128 v[52:55], v15 offset:17408
    ds_read_b128 v[56:59], v15 offset:24576
    ds_read_b128 v[60:63], v15 offset:25600
    s_waitcnt lgkmcnt(3)
    v_lshlrev_b32 v40, 16, v48
    v_and_b32 v41, 0xffff0000, v48
    v_lshlrev_b32 v42, 16, v49
    v_and_b32 v43, 0xffff0000, v49
    v_lshlrev_b32 v44, 16, v50
    v_and_b32 v45, 0xffff0000, v50
    v_lshlrev_b32 v46, 16, v51
    v_and_b32 v47, 0xffff0000, v51
    v_add_f32 v24, v24, v40
    v_add_f32 v25, v25, v41
    v_add_f32 v26, v26, v42
    v_add_f32 v27, v27, v43
    v_add_f32 v28, v28, v44
    v_add_f32 v29, v29, v45
    v_add_f32 v30, v30, v46
    v_add_f32 v31, v31, v47
    s_waitcnt lgkmcnt(2)
    v_lshlrev_b32 v40, 16, v52
    v_and_b32 v41, 0xffff0000, v52
    v_lshlrev_b32 v42, 16, v53
    v_and_b32 v43, 0xffff0000, v53
    v_lshlrev_b32 v44, 16, v54
    v_and_b32 v45, 0xffff0000, v54
    v_lshlrev_b32 v46, 16, v55
    v_and_b32 v47, 0xffff0000, v55
    v_add_f32 v24, v24, v40
    v_add_f32 v25, v25, v41
    v_add_f32 v26, v26, v42
    v_add_f32 v27, v27, v43
    v_add_f32 v28, v28, v44
    v_add_f32 v29, v29, v45
    v_add_f32 v30, v30, v46
    v_add_f32 v31, v31, v47
    s_waitcnt lgkmcnt(1)
    v_lshlrev_b32 v40, 16, v56
    v_and_b32 v41, 0xffff0000, v56
    v_lshlrev_b32 v42, 16, v57
    v_and_b32 v43, 0xffff0000, v57
    v_lshlrev_b32 v44, 16, v58
    v_and_b32 v45, 0xffff0000, v58
    v_lshlrev_b32 v46, 16, v59
    v_and_b32 v47, 0xffff0000, v59
    v_add_f32 v32, v32, v40
    v_add_f32 v33, v33, v41
    v_add_f32 v34, v34, v42
    v_add_f32 v35, v35, v43
    v_add_f32 v36, v36, v44
    v_add_f32 v37, v37, v45
    v_add_f32 v38, v38, v46
    v_add_f32 v39, v39, v47
    s_waitcnt lgkmcnt(0)
    v_lshlrev_b32 v40, 16, v60
    v_and_b32 v41, 0xffff0000, v60
    v_lshlrev_b32 v42, 16, v61
    v_and_b32 v43, 0xffff0000, v61
    v_lshlrev_b32 v44, 16, v62
    v_and_b32 v45, 0xffff0000, v62
    v_lshlrev_b32 v46, 16, v63
    v_and_b32 v47, 0xffff0000, v63
    v_add_f32 v32, v32, v40
    v_add_f32 v33, v33, v41
    v_add_f32 v34, v34, v42
    v_add_f32 v35, v35, v43
    v_add_f32 v36, v36, v44
    v_add_f32 v37, v37, v45
    v_add_f32 v38, v38, v46
    v_add_f32 v39, v39, v47
    s_waitcnt vmcnt(8)
    ds_read_b128 v[48:51], v15 offset:45056
    ds_read_b128 v[52:55], v15 offset:46080
    ds_read_b128 v[56:59], v15 offset:53248
    ds_read_b128 v[60:63], v15 offset:54272
    s_barrier
    s_add_u32 m0, s65, 0
    s_add_u32 s33, s64, 1105920
    buffer_load_dwordx4 v14, s[68:71], s33 offen lds
    s_waitcnt lgkmcnt(3)
    v_lshlrev_b32 v40, 16, v48
    v_and_b32 v41, 0xffff0000, v48
    v_lshlrev_b32 v42, 16, v49
    s_add_u32 m0, s65, 8192
    s_add_u32 s33, s64, 1105920
    buffer_load_dwordx4 v14, s[72:75], s33 offen lds
    v_and_b32 v43, 0xffff0000, v49
    v_lshlrev_b32 v44, 16, v50
    v_and_b32 v45, 0xffff0000, v50
    v_lshlrev_b32 v46, 16, v51
    s_add_u32 m0, s65, 1024
    s_add_u32 s33, s64, 1133568
    buffer_load_dwordx4 v14, s[68:71], s33 offen lds
    v_and_b32 v47, 0xffff0000, v51
    v_add_f32 v24, v24, v40
    v_add_f32 v25, v25, v41
    v_add_f32 v26, v26, v42
    s_add_u32 m0, s65, 9216
    s_add_u32 s33, s64, 1133568
    buffer_load_dwordx4 v14, s[72:75], s33 offen lds
    v_add_f32 v27, v27, v43
    v_add_f32 v28, v28, v44
    v_add_f32 v29, v29, v45
    v_add_f32 v30, v30, v46
    v_add_f32 v31, v31, v47
    s_waitcnt lgkmcnt(2)
    v_lshlrev_b32 v40, 16, v52
    v_and_b32 v41, 0xffff0000, v52
    v_lshlrev_b32 v42, 16, v53
    v_and_b32 v43, 0xffff0000, v53
    v_lshlrev_b32 v44, 16, v54
    v_and_b32 v45, 0xffff0000, v54
    v_lshlrev_b32 v46, 16, v55
    v_and_b32 v47, 0xffff0000, v55
    v_add_f32 v24, v24, v40
    v_add_f32 v25, v25, v41
    v_add_f32 v26, v26, v42
    v_add_f32 v27, v27, v43
    v_add_f32 v28, v28, v44
    v_add_f32 v29, v29, v45
    v_add_f32 v30, v30, v46
    v_add_f32 v31, v31, v47
    s_waitcnt lgkmcnt(1)
    v_lshlrev_b32 v40, 16, v56
    v_and_b32 v41, 0xffff0000, v56
    v_lshlrev_b32 v42, 16, v57
    v_and_b32 v43, 0xffff0000, v57
    v_lshlrev_b32 v44, 16, v58
    v_and_b32 v45, 0xffff0000, v58
    v_lshlrev_b32 v46, 16, v59
    v_and_b32 v47, 0xffff0000, v59
    v_add_f32 v32, v32, v40
    v_add_f32 v33, v33, v41
    v_add_f32 v34, v34, v42
    v_add_f32 v35, v35, v43
    v_add_f32 v36, v36, v44
    v_add_f32 v37, v37, v45
    v_add_f32 v38, v38, v46
    v_add_f32 v39, v39, v47
    s_waitcnt lgkmcnt(0)
    v_lshlrev_b32 v40, 16, v60
    v_and_b32 v41, 0xffff0000, v60
    v_lshlrev_b32 v42, 16, v61
    v_and_b32 v43, 0xffff0000, v61
    v_lshlrev_b32 v44, 16, v62
    v_and_b32 v45, 0xffff0000, v62
    v_lshlrev_b32 v46, 16, v63
    v_and_b32 v47, 0xffff0000, v63
    v_add_f32 v32, v32, v40
    v_add_f32 v33, v33, v41
    v_add_f32 v34, v34, v42
    v_add_f32 v35, v35, v43
    v_add_f32 v36, v36, v44
    v_add_f32 v37, v37, v45
    v_add_f32 v38, v38, v46
    v_add_f32 v39, v39, v47
    s_mov_b32 s34, 98304
    v_lshlrev_b32 v8, 12, v1
    v_mov_b32 v20, s24
    s_mov_b64 exec, 0xff
    buffer_load_dword v20, v8, s[92:95], s34 offen sc1
    s_mov_b64 exec, -1
    s_waitcnt vmcnt(9)
    ds_read_b128 v[48:51], v15 offset:61440
    ds_read_b128 v[52:55], v15 offset:62464
    ds_read_b128 v[56:59], v16 offset:4096
    ds_read_b128 v[60:63], v16 offset:5120
    s_barrier
    s_add_u32 m0, s65, 16384
    s_add_u32 s33, s64, 1327104
    buffer_load_dwordx4 v14, s[68:71], s33 offen lds
    s_waitcnt lgkmcnt(3)
    v_lshlrev_b32 v40, 16, v48
    v_and_b32 v41, 0xffff0000, v48
    v_lshlrev_b32 v42, 16, v49
    s_add_u32 m0, s65, 24576
    s_add_u32 s33, s64, 1327104
    buffer_load_dwordx4 v14, s[72:75], s33 offen lds
    v_and_b32 v43, 0xffff0000, v49
    v_lshlrev_b32 v44, 16, v50
    v_and_b32 v45, 0xffff0000, v50
    v_lshlrev_b32 v46, 16, v51
    s_add_u32 m0, s65, 17408
    s_add_u32 s33, s64, 1354752
    buffer_load_dwordx4 v14, s[68:71], s33 offen lds
    v_and_b32 v47, 0xffff0000, v51
    v_add_f32 v24, v24, v40
    v_add_f32 v25, v25, v41
    v_add_f32 v26, v26, v42
    s_add_u32 m0, s65, 25600
    s_add_u32 s33, s64, 1354752
    buffer_load_dwordx4 v14, s[72:75], s33 offen lds
    v_add_f32 v27, v27, v43
    v_add_f32 v28, v28, v44
    v_add_f32 v29, v29, v45
    v_add_f32 v30, v30, v46
    v_add_f32 v31, v31, v47
    s_waitcnt lgkmcnt(2)
    v_lshlrev_b32 v40, 16, v52
    v_and_b32 v41, 0xffff0000, v52
    v_lshlrev_b32 v42, 16, v53
    v_and_b32 v43, 0xffff0000, v53
    v_lshlrev_b32 v44, 16, v54
    v_and_b32 v45, 0xffff0000, v54
    v_lshlrev_b32 v46, 16, v55
    v_and_b32 v47, 0xffff0000, v55
    v_add_f32 v24, v24, v40
    v_add_f32 v25, v25, v41
    v_add_f32 v26, v26, v42
    v_add_f32 v27, v27, v43
    v_add_f32 v28, v28, v44
    v_add_f32 v29, v29, v45
    v_add_f32 v30, v30, v46
    v_add_f32 v31, v31, v47
    s_waitcnt lgkmcnt(1)
    v_lshlrev_b32 v40, 16, v56
    v_and_b32 v41, 0xffff0000, v56
    v_lshlrev_b32 v42, 16, v57
    v_and_b32 v43, 0xffff0000, v57
    v_lshlrev_b32 v44, 16, v58
    v_and_b32 v45, 0xffff0000, v58
    v_lshlrev_b32 v46, 16, v59
    v_and_b32 v47, 0xffff0000, v59
    v_add_f32 v32, v32, v40
    v_add_f32 v33, v33, v41
    v_add_f32 v34, v34, v42
    v_add_f32 v35, v35, v43
    v_add_f32 v36, v36, v44
    v_add_f32 v37, v37, v45
    v_add_f32 v38, v38, v46
    v_add_f32 v39, v39, v47
    s_waitcnt lgkmcnt(0)
    v_lshlrev_b32 v40, 16, v60
    v_and_b32 v41, 0xffff0000, v60
    v_lshlrev_b32 v42, 16, v61
    v_and_b32 v43, 0xffff0000, v61
    v_lshlrev_b32 v44, 16, v62
    v_and_b32 v45, 0xffff0000, v62
    v_lshlrev_b32 v46, 16, v63
    v_and_b32 v47, 0xffff0000, v63
    v_add_f32 v32, v32, v40
    v_add_f32 v33, v33, v41
    v_add_f32 v34, v34, v42
    v_add_f32 v35, v35, v43
    v_add_f32 v36, v36, v44
    v_add_f32 v37, v37, v45
    v_add_f32 v38, v38, v46
    v_add_f32 v39, v39, v47
    s_waitcnt vmcnt(9)
    ds_read_b128 v[48:51], v16 offset:12288
    ds_read_b128 v[52:55], v16 offset:13312
    ds_read_b128 v[56:59], v16 offset:20480
    ds_read_b128 v[60:63], v16 offset:21504
    s_barrier
    s_add_u32 m0, s65, 45056
    s_add_u32 s33, s64, 1548288
    buffer_load_dwordx4 v14, s[68:71], s33 offen lds
    s_waitcnt lgkmcnt(3)
    v_lshlrev_b32 v40, 16, v48
    v_and_b32 v41, 0xffff0000, v48
    v_lshlrev_b32 v42, 16, v49
    s_add_u32 m0, s65, 53248
    s_add_u32 s33, s64, 1548288
    buffer_load_dwordx4 v14, s[72:75], s33 offen lds
    v_and_b32 v43, 0xffff0000, v49
    v_lshlrev_b32 v44, 16, v50
    v_and_b32 v45, 0xffff0000, v50
    v_lshlrev_b32 v46, 16, v51
    s_add_u32 m0, s65, 46080
    s_add_u32 s33, s64, 1575936
    buffer_load_dwordx4 v14, s[68:71], s33 offen lds
    v_and_b32 v47, 0xffff0000, v51
    v_add_f32 v24, v24, v40
    v_add_f32 v25, v25, v41
    v_add_f32 v26, v26, v42
    s_add_u32 m0, s65, 54272
    s_add_u32 s33, s64, 1575936
    buffer_load_dwordx4 v14, s[72:75], s33 offen lds
    v_add_f32 v27, v27, v43
    v_add_f32 v28, v28, v44
    v_add_f32 v29, v29, v45
    v_add_f32 v30, v30, v46
    v_add_f32 v31, v31, v47
    s_waitcnt lgkmcnt(2)
    v_lshlrev_b32 v40, 16, v52
    v_and_b32 v41, 0xffff0000, v52
    v_lshlrev_b32 v42, 16, v53
    v_and_b32 v43, 0xffff0000, v53
    v_lshlrev_b32 v44, 16, v54
    v_and_b32 v45, 0xffff0000, v54
    v_lshlrev_b32 v46, 16, v55
    v_and_b32 v47, 0xffff0000, v55
    v_add_f32 v24, v24, v40
    v_add_f32 v25, v25, v41
    v_add_f32 v26, v26, v42
    v_add_f32 v27, v27, v43
    v_add_f32 v28, v28, v44
    v_add_f32 v29, v29, v45
    v_add_f32 v30, v30, v46
    v_add_f32 v31, v31, v47
    s_waitcnt lgkmcnt(1)
    v_lshlrev_b32 v40, 16, v56
    v_and_b32 v41, 0xffff0000, v56
    v_lshlrev_b32 v42, 16, v57
    v_and_b32 v43, 0xffff0000, v57
    v_lshlrev_b32 v44, 16, v58
    v_and_b32 v45, 0xffff0000, v58
    v_lshlrev_b32 v46, 16, v59
    v_and_b32 v47, 0xffff0000, v59
    v_add_f32 v32, v32, v40
    v_add_f32 v33, v33, v41
    v_add_f32 v34, v34, v42
    v_add_f32 v35, v35, v43
    v_add_f32 v36, v36, v44
    v_add_f32 v37, v37, v45
    v_add_f32 v38, v38, v46
    v_add_f32 v39, v39, v47
    s_waitcnt lgkmcnt(0)
    v_lshlrev_b32 v40, 16, v60
    v_and_b32 v41, 0xffff0000, v60
    v_lshlrev_b32 v42, 16, v61
    v_and_b32 v43, 0xffff0000, v61
    v_lshlrev_b32 v44, 16, v62
    v_and_b32 v45, 0xffff0000, v62
    v_lshlrev_b32 v46, 16, v63
    v_and_b32 v47, 0xffff0000, v63
    v_add_f32 v32, v32, v40
    v_add_f32 v33, v33, v41
    v_add_f32 v34, v34, v42
    v_add_f32 v35, v35, v43
    v_add_f32 v36, v36, v44
    v_add_f32 v37, v37, v45
    v_add_f32 v38, v38, v46
    v_add_f32 v39, v39, v47
    s_waitcnt vmcnt(8)
    v_cmp_ne_u32 vcc, s24, v20
    s_nop 0
    s_cmp_eq_u64 vcc, 0
    s_cbranch_scc1 sequential_preLN__sliding_block__geglu_ffn__prompt_kernel_flok53
    s_mov_b32 s34, 98304
    s_mov_b32 s30, 0xff
    s_mov_b32 s31, 0
    s_mov_b32 s32, 0x40000
    v_lshlrev_b32 v8, 12, v1
    s_mov_b64 exec, s[30:31]
    s_nop 3
sequential_preLN__sliding_block__geglu_ffn__prompt_kernel_poll54:
    buffer_load_dword v4, v8, s[92:95], s34 offen sc1
    s_waitcnt vmcnt(0)
    v_xor_b32 v4, s24, v4
    v_cmp_ne_u32 vcc, 0, v4
    s_nop 0
    s_and_b64 s[28:29], vcc, s[30:31]
    s_cbranch_scc0 sequential_preLN__sliding_block__geglu_ffn__prompt_kernel_pdone55
    s_sub_u32 s32, s32, 1
    s_cbranch_scc1 sequential_preLN__sliding_block__geglu_ffn__prompt_kernel_pdone55
    s_sleep 1
    s_branch sequential_preLN__sliding_block__geglu_ffn__prompt_kernel_poll54
    s_nop 0
sequential_preLN__sliding_block__geglu_ffn__prompt_kernel_pdone55:
    s_mov_b64 exec, -1
    s_nop 0
sequential_preLN__sliding_block__geglu_ffn__prompt_kernel_flok53:
    s_sub_u32 s78, s3, 8
    s_mul_i32 s77, s78, 3840
    s_and_b32 s76, s26, 7
    s_mul_i32 s76, s76, 276480
    s_add_u32 s76, s76, s77
    s_add_u32 s80, s22, 0x1488000
    s_addc_u32 s81, s23, 0
    s_and_b32 s81, s81, 0xffff
    s_mov_b32 s82, 0x21c000
    s_mov_b32 s83, 0x20000
    s_add_u32 m0, s77, 94208
    s_add_u32 s33, s76, 0
    buffer_load_dwordx4 v13, s[80:83], s33 offen sc1 lds
    s_add_u32 m0, s77, 95232
    s_add_u32 s33, s76, 1024
    buffer_load_dwordx4 v13, s[80:83], s33 offen sc1 lds
    s_add_u32 m0, s77, 96256
    s_add_u32 s33, s76, 2048
    buffer_load_dwordx4 v13, s[80:83], s33 offen sc1 lds
    s_add_u32 m0, s77, 97280
    s_add_u32 s33, s76, 3072
    s_mov_b32 exec_hi, 0xffff
    buffer_load_dwordx4 v13, s[80:83], s33 offen sc1 lds
    s_mov_b64 exec, -1
    ds_read_b128 v[48:51], v15 offset:0
    ds_read_b128 v[52:55], v15 offset:1024
    ds_read_b128 v[56:59], v15 offset:8192
    ds_read_b128 v[60:63], v15 offset:9216
    s_barrier
    s_add_u32 m0, s65, 61440
    s_add_u32 s33, s64, 1769472
    buffer_load_dwordx4 v14, s[68:71], s33 offen lds
    s_waitcnt lgkmcnt(3)
    v_lshlrev_b32 v40, 16, v48
    v_and_b32 v41, 0xffff0000, v48
    v_lshlrev_b32 v42, 16, v49
    s_add_u32 m0, s65, 69632
    s_add_u32 s33, s64, 1769472
    buffer_load_dwordx4 v14, s[72:75], s33 offen lds
    v_and_b32 v43, 0xffff0000, v49
    v_lshlrev_b32 v44, 16, v50
    v_and_b32 v45, 0xffff0000, v50
    v_lshlrev_b32 v46, 16, v51
    s_add_u32 m0, s65, 62464
    s_add_u32 s33, s64, 1797120
    buffer_load_dwordx4 v14, s[68:71], s33 offen lds
    v_and_b32 v47, 0xffff0000, v51
    v_add_f32 v24, v24, v40
    v_add_f32 v25, v25, v41
    v_add_f32 v26, v26, v42
    s_add_u32 m0, s65, 70656
    s_add_u32 s33, s64, 1797120
    buffer_load_dwordx4 v14, s[72:75], s33 offen lds
    v_add_f32 v27, v27, v43
    v_add_f32 v28, v28, v44
    v_add_f32 v29, v29, v45
    v_add_f32 v30, v30, v46
    v_add_f32 v31, v31, v47
    s_waitcnt lgkmcnt(2)
    v_lshlrev_b32 v40, 16, v52
    v_and_b32 v41, 0xffff0000, v52
    v_lshlrev_b32 v42, 16, v53
    v_and_b32 v43, 0xffff0000, v53
    v_lshlrev_b32 v44, 16, v54
    v_and_b32 v45, 0xffff0000, v54
    v_lshlrev_b32 v46, 16, v55
    v_and_b32 v47, 0xffff0000, v55
    v_add_f32 v24, v24, v40
    v_add_f32 v25, v25, v41
    v_add_f32 v26, v26, v42
    v_add_f32 v27, v27, v43
    v_add_f32 v28, v28, v44
    v_add_f32 v29, v29, v45
    v_add_f32 v30, v30, v46
    v_add_f32 v31, v31, v47
    s_waitcnt lgkmcnt(1)
    v_lshlrev_b32 v40, 16, v56
    v_and_b32 v41, 0xffff0000, v56
    v_lshlrev_b32 v42, 16, v57
    v_and_b32 v43, 0xffff0000, v57
    v_lshlrev_b32 v44, 16, v58
    v_and_b32 v45, 0xffff0000, v58
    v_lshlrev_b32 v46, 16, v59
    v_and_b32 v47, 0xffff0000, v59
    v_add_f32 v32, v32, v40
    v_add_f32 v33, v33, v41
    v_add_f32 v34, v34, v42
    v_add_f32 v35, v35, v43
    v_add_f32 v36, v36, v44
    v_add_f32 v37, v37, v45
    v_add_f32 v38, v38, v46
    v_add_f32 v39, v39, v47
    s_waitcnt lgkmcnt(0)
    v_lshlrev_b32 v40, 16, v60
    v_and_b32 v41, 0xffff0000, v60
    v_lshlrev_b32 v42, 16, v61
    v_and_b32 v43, 0xffff0000, v61
    v_lshlrev_b32 v44, 16, v62
    v_and_b32 v45, 0xffff0000, v62
    v_lshlrev_b32 v46, 16, v63
    v_and_b32 v47, 0xffff0000, v63
    v_add_f32 v32, v32, v40
    v_add_f32 v33, v33, v41
    v_add_f32 v34, v34, v42
    v_add_f32 v35, v35, v43
    v_add_f32 v36, v36, v44
    v_add_f32 v37, v37, v45
    v_add_f32 v38, v38, v46
    v_add_f32 v39, v39, v47
    s_add_u32 m0, s77, 109568
    s_add_u32 s33, s76, 15360
    buffer_load_dwordx4 v13, s[80:83], s33 offen sc1 lds
    s_add_u32 m0, s77, 110592
    s_add_u32 s33, s76, 16384
    buffer_load_dwordx4 v13, s[80:83], s33 offen sc1 lds
    s_add_u32 m0, s77, 111616
    s_add_u32 s33, s76, 17408
    buffer_load_dwordx4 v13, s[80:83], s33 offen sc1 lds
    s_add_u32 m0, s77, 112640
    s_add_u32 s33, s76, 18432
    s_mov_b32 exec_hi, 0xffff
    buffer_load_dwordx4 v13, s[80:83], s33 offen sc1 lds
    s_mov_b64 exec, -1
    s_waitcnt vmcnt(16)
    ds_read_b128 v[48:51], v15 offset:16384
    ds_read_b128 v[52:55], v15 offset:17408
    ds_read_b128 v[56:59], v15 offset:24576
    ds_read_b128 v[60:63], v15 offset:25600
    s_barrier
    s_add_u32 m0, s65, 77824
    s_add_u32 s33, s64, 1990656
    buffer_load_dwordx4 v14, s[68:71], s33 offen lds
    s_waitcnt lgkmcnt(3)
    v_lshlrev_b32 v40, 16, v48
    v_and_b32 v41, 0xffff0000, v48
    v_lshlrev_b32 v42, 16, v49
    s_add_u32 m0, s65, 86016
    s_add_u32 s33, s64, 1990656
    buffer_load_dwordx4 v14, s[72:75], s33 offen lds
    v_and_b32 v43, 0xffff0000, v49
    v_lshlrev_b32 v44, 16, v50
    v_and_b32 v45, 0xffff0000, v50
    v_lshlrev_b32 v46, 16, v51
    s_add_u32 m0, s65, 78848
    s_add_u32 s33, s64, 2018304
    buffer_load_dwordx4 v14, s[68:71], s33 offen lds
    v_and_b32 v47, 0xffff0000, v51
    v_add_f32 v24, v24, v40
    v_add_f32 v25, v25, v41
    v_add_f32 v26, v26, v42
    s_add_u32 m0, s65, 87040
    s_add_u32 s33, s64, 2018304
    buffer_load_dwordx4 v14, s[72:75], s33 offen lds
    v_add_f32 v27, v27, v43
    v_add_f32 v28, v28, v44
    v_add_f32 v29, v29, v45
    v_add_f32 v30, v30, v46
    v_add_f32 v31, v31, v47
    s_waitcnt lgkmcnt(2)
    v_lshlrev_b32 v40, 16, v52
    v_and_b32 v41, 0xffff0000, v52
    v_lshlrev_b32 v42, 16, v53
    v_and_b32 v43, 0xffff0000, v53
    v_lshlrev_b32 v44, 16, v54
    v_and_b32 v45, 0xffff0000, v54
    v_lshlrev_b32 v46, 16, v55
    v_and_b32 v47, 0xffff0000, v55
    v_add_f32 v24, v24, v40
    v_add_f32 v25, v25, v41
    v_add_f32 v26, v26, v42
    v_add_f32 v27, v27, v43
    v_add_f32 v28, v28, v44
    v_add_f32 v29, v29, v45
    v_add_f32 v30, v30, v46
    v_add_f32 v31, v31, v47
    s_waitcnt lgkmcnt(1)
    v_lshlrev_b32 v40, 16, v56
    v_and_b32 v41, 0xffff0000, v56
    v_lshlrev_b32 v42, 16, v57
    v_and_b32 v43, 0xffff0000, v57
    v_lshlrev_b32 v44, 16, v58
    v_and_b32 v45, 0xffff0000, v58
    v_lshlrev_b32 v46, 16, v59
    v_and_b32 v47, 0xffff0000, v59
    v_add_f32 v32, v32, v40
    v_add_f32 v33, v33, v41
    v_add_f32 v34, v34, v42
    v_add_f32 v35, v35, v43
    v_add_f32 v36, v36, v44
    v_add_f32 v37, v37, v45
    v_add_f32 v38, v38, v46
    v_add_f32 v39, v39, v47
    s_waitcnt lgkmcnt(0)
    v_lshlrev_b32 v40, 16, v60
    v_and_b32 v41, 0xffff0000, v60
    v_lshlrev_b32 v42, 16, v61
    v_and_b32 v43, 0xffff0000, v61
    v_lshlrev_b32 v44, 16, v62
    v_and_b32 v45, 0xffff0000, v62
    v_lshlrev_b32 v46, 16, v63
    v_and_b32 v47, 0xffff0000, v63
    v_add_f32 v32, v32, v40
    v_add_f32 v33, v33, v41
    v_add_f32 v34, v34, v42
    v_add_f32 v35, v35, v43
    v_add_f32 v36, v36, v44
    v_add_f32 v37, v37, v45
    v_add_f32 v38, v38, v46
    v_add_f32 v39, v39, v47
    s_add_u32 m0, s77, 124928
    s_add_u32 s33, s76, 30720
    buffer_load_dwordx4 v13, s[80:83], s33 offen sc1 lds
    s_add_u32 m0, s77, 125952
    s_add_u32 s33, s76, 31744
    buffer_load_dwordx4 v13, s[80:83], s33 offen sc1 lds
    s_add_u32 m0, s77, 126976
    s_add_u32 s33, s76, 32768
    buffer_load_dwordx4 v13, s[80:83], s33 offen sc1 lds
    s_add_u32 m0, s77, 128000
    s_add_u32 s33, s76, 33792
    s_mov_b32 exec_hi, 0xffff
    buffer_load_dwordx4 v13, s[80:83], s33 offen sc1 lds
    s_mov_b64 exec, -1
    s_waitcnt vmcnt(20)
    ds_read_b128 v[48:51], v15 offset:45056
    ds_read_b128 v[52:55], v15 offset:46080
    ds_read_b128 v[56:59], v15 offset:53248
    ds_read_b128 v[60:63], v15 offset:54272
    s_barrier
    s_waitcnt lgkmcnt(3)
    v_lshlrev_b32 v40, 16, v48
    v_and_b32 v41, 0xffff0000, v48
    v_lshlrev_b32 v42, 16, v49
    v_and_b32 v43, 0xffff0000, v49
    v_lshlrev_b32 v44, 16, v50
    v_and_b32 v45, 0xffff0000, v50
    v_lshlrev_b32 v46, 16, v51
    v_and_b32 v47, 0xffff0000, v51
    v_add_f32 v24, v24, v40
    v_add_f32 v25, v25, v41
    v_add_f32 v26, v26, v42
    v_add_f32 v27, v27, v43
    v_add_f32 v28, v28, v44
    v_add_f32 v29, v29, v45
    v_add_f32 v30, v30, v46
    v_add_f32 v31, v31, v47
    s_waitcnt lgkmcnt(2)
    v_lshlrev_b32 v40, 16, v52
    v_and_b32 v41, 0xffff0000, v52
    v_lshlrev_b32 v42, 16, v53
    v_and_b32 v43, 0xffff0000, v53
    v_lshlrev_b32 v44, 16, v54
    v_and_b32 v45, 0xffff0000, v54
    v_lshlrev_b32 v46, 16, v55
    v_and_b32 v47, 0xffff0000, v55
    v_add_f32 v24, v24, v40
    v_add_f32 v25, v25, v41
    v_add_f32 v26, v26, v42
    v_add_f32 v27, v27, v43
    v_add_f32 v28, v28, v44
    v_add_f32 v29, v29, v45
    v_add_f32 v30, v30, v46
    v_add_f32 v31, v31, v47
    s_waitcnt lgkmcnt(1)
    v_lshlrev_b32 v40, 16, v56
    v_and_b32 v41, 0xffff0000, v56
    v_lshlrev_b32 v42, 16, v57
    v_and_b32 v43, 0xffff0000, v57
    v_lshlrev_b32 v44, 16, v58
    v_and_b32 v45, 0xffff0000, v58
    v_lshlrev_b32 v46, 16, v59
    v_and_b32 v47, 0xffff0000, v59
    v_add_f32 v32, v32, v40
    v_add_f32 v33, v33, v41
    v_add_f32 v34, v34, v42
    v_add_f32 v35, v35, v43
    v_add_f32 v36, v36, v44
    v_add_f32 v37, v37, v45
    v_add_f32 v38, v38, v46
    v_add_f32 v39, v39, v47
    s_waitcnt lgkmcnt(0)
    v_lshlrev_b32 v40, 16, v60
    v_and_b32 v41, 0xffff0000, v60
    v_lshlrev_b32 v42, 16, v61
    v_and_b32 v43, 0xffff0000, v61
    v_lshlrev_b32 v44, 16, v62
    v_and_b32 v45, 0xffff0000, v62
    v_lshlrev_b32 v46, 16, v63
    v_and_b32 v47, 0xffff0000, v63
    v_add_f32 v32, v32, v40
    v_add_f32 v33, v33, v41
    v_add_f32 v34, v34, v42
    v_add_f32 v35, v35, v43
    v_add_f32 v36, v36, v44
    v_add_f32 v37, v37, v45
    v_add_f32 v38, v38, v46
    v_add_f32 v39, v39, v47
    s_add_u32 m0, s77, 140288
    s_add_u32 s33, s76, 46080
    buffer_load_dwordx4 v13, s[80:83], s33 offen sc1 lds
    s_add_u32 m0, s77, 141312
    s_add_u32 s33, s76, 47104
    buffer_load_dwordx4 v13, s[80:83], s33 offen sc1 lds
    s_add_u32 m0, s77, 142336
    s_add_u32 s33, s76, 48128
    buffer_load_dwordx4 v13, s[80:83], s33 offen sc1 lds
    s_add_u32 m0, s77, 143360
    s_add_u32 s33, s76, 49152
    s_mov_b32 exec_hi, 0xffff
    buffer_load_dwordx4 v13, s[80:83], s33 offen sc1 lds
    s_mov_b64 exec, -1
    s_waitcnt vmcnt(16)
    ds_read_b128 v[48:51], v15 offset:61440
    ds_read_b128 v[52:55], v15 offset:62464
    ds_read_b128 v[56:59], v16 offset:4096
    ds_read_b128 v[60:63], v16 offset:5120
    s_barrier
    s_waitcnt lgkmcnt(3)
    v_lshlrev_b32 v40, 16, v48
    v_and_b32 v41, 0xffff0000, v48
    v_lshlrev_b32 v42, 16, v49
    v_and_b32 v43, 0xffff0000, v49
    v_lshlrev_b32 v44, 16, v50
    v_and_b32 v45, 0xffff0000, v50
    v_lshlrev_b32 v46, 16, v51
    v_and_b32 v47, 0xffff0000, v51
    v_add_f32 v24, v24, v40
    v_add_f32 v25, v25, v41
    v_add_f32 v26, v26, v42
    v_add_f32 v27, v27, v43
    v_add_f32 v28, v28, v44
    v_add_f32 v29, v29, v45
    v_add_f32 v30, v30, v46
    v_add_f32 v31, v31, v47
    s_waitcnt lgkmcnt(2)
    v_lshlrev_b32 v40, 16, v52
    v_and_b32 v41, 0xffff0000, v52
    v_lshlrev_b32 v42, 16, v53
    v_and_b32 v43, 0xffff0000, v53
    v_lshlrev_b32 v44, 16, v54
    v_and_b32 v45, 0xffff0000, v54
    v_lshlrev_b32 v46, 16, v55
    v_and_b32 v47, 0xffff0000, v55
    v_add_f32 v24, v24, v40
    v_add_f32 v25, v25, v41
    v_add_f32 v26, v26, v42
    v_add_f32 v27, v27, v43
    v_add_f32 v28, v28, v44
    v_add_f32 v29, v29, v45
    v_add_f32 v30, v30, v46
    v_add_f32 v31, v31, v47
    s_waitcnt lgkmcnt(1)
    v_lshlrev_b32 v40, 16, v56
    v_and_b32 v41, 0xffff0000, v56
    v_lshlrev_b32 v42, 16, v57
    v_and_b32 v43, 0xffff0000, v57
    v_lshlrev_b32 v44, 16, v58
    v_and_b32 v45, 0xffff0000, v58
    v_lshlrev_b32 v46, 16, v59
    v_and_b32 v47, 0xffff0000, v59
    v_add_f32 v32, v32, v40
    v_add_f32 v33, v33, v41
    v_add_f32 v34, v34, v42
    v_add_f32 v35, v35, v43
    v_add_f32 v36, v36, v44
    v_add_f32 v37, v37, v45
    v_add_f32 v38, v38, v46
    v_add_f32 v39, v39, v47
    s_waitcnt lgkmcnt(0)
    v_lshlrev_b32 v40, 16, v60
    v_and_b32 v41, 0xffff0000, v60
    v_lshlrev_b32 v42, 16, v61
    v_and_b32 v43, 0xffff0000, v61
    v_lshlrev_b32 v44, 16, v62
    v_and_b32 v45, 0xffff0000, v62
    v_lshlrev_b32 v46, 16, v63
    v_and_b32 v47, 0xffff0000, v63
    v_add_f32 v32, v32, v40
    v_add_f32 v33, v33, v41
    v_add_f32 v34, v34, v42
    v_add_f32 v35, v35, v43
    v_add_f32 v36, v36, v44
    v_add_f32 v37, v37, v45
    v_add_f32 v38, v38, v46
    v_add_f32 v39, v39, v47
    s_waitcnt vmcnt(8)
    ds_read_b128 v[48:51], v16 offset:12288
    ds_read_b128 v[52:55], v16 offset:13312
    ds_read_b128 v[56:59], v16 offset:20480
    ds_read_b128 v[60:63], v16 offset:21504
    s_barrier
    s_waitcnt lgkmcnt(3)
    v_lshlrev_b32 v40, 16, v48
    v_and_b32 v41, 0xffff0000, v48
    v_lshlrev_b32 v42, 16, v49
    v_and_b32 v43, 0xffff0000, v49
    v_lshlrev_b32 v44, 16, v50
    v_and_b32 v45, 0xffff0000, v50
    v_lshlrev_b32 v46, 16, v51
    v_and_b32 v47, 0xffff0000, v51
    v_add_f32 v24, v24, v40
    v_add_f32 v25, v25, v41
    v_add_f32 v26, v26, v42
    v_add_f32 v27, v27, v43
    v_add_f32 v28, v28, v44
    v_add_f32 v29, v29, v45
    v_add_f32 v30, v30, v46
    v_add_f32 v31, v31, v47
    s_waitcnt lgkmcnt(2)
    v_lshlrev_b32 v40, 16, v52
    v_and_b32 v41, 0xffff0000, v52
    v_lshlrev_b32 v42, 16, v53
    v_and_b32 v43, 0xffff0000, v53
    v_lshlrev_b32 v44, 16, v54
    v_and_b32 v45, 0xffff0000, v54
    v_lshlrev_b32 v46, 16, v55
    v_and_b32 v47, 0xffff0000, v55
    v_add_f32 v24, v24, v40
    v_add_f32 v25, v25, v41
    v_add_f32 v26, v26, v42
    v_add_f32 v27, v27, v43
    v_add_f32 v28, v28, v44
    v_add_f32 v29, v29, v45
    v_add_f32 v30, v30, v46
    v_add_f32 v31, v31, v47
    s_waitcnt lgkmcnt(1)
    v_lshlrev_b32 v40, 16, v56
    v_and_b32 v41, 0xffff0000, v56
    v_lshlrev_b32 v42, 16, v57
    v_and_b32 v43, 0xffff0000, v57
    v_lshlrev_b32 v44, 16, v58
    v_and_b32 v45, 0xffff0000, v58
    v_lshlrev_b32 v46, 16, v59
    v_and_b32 v47, 0xffff0000, v59
    v_add_f32 v32, v32, v40
    v_add_f32 v33, v33, v41
    v_add_f32 v34, v34, v42
    v_add_f32 v35, v35, v43
    v_add_f32 v36, v36, v44
    v_add_f32 v37, v37, v45
    v_add_f32 v38, v38, v46
    v_add_f32 v39, v39, v47
    s_waitcnt lgkmcnt(0)
    v_lshlrev_b32 v40, 16, v60
    v_and_b32 v41, 0xffff0000, v60
    v_lshlrev_b32 v42, 16, v61
    v_and_b32 v43, 0xffff0000, v61
    v_lshlrev_b32 v44, 16, v62
    v_and_b32 v45, 0xffff0000, v62
    v_lshlrev_b32 v46, 16, v63
    v_and_b32 v47, 0xffff0000, v63
    v_add_f32 v32, v32, v40
    v_add_f32 v33, v33, v41
    v_add_f32 v34, v34, v42
    v_add_f32 v35, v35, v43
    v_add_f32 v36, v36, v44
    v_add_f32 v37, v37, v45
    v_add_f32 v38, v38, v46
    v_add_f32 v39, v39, v47
    v_add_f32_dpp v24, v24, v24 row_ror:8 row_mask:0xf bank_mask:0xf
    v_add_f32_dpp v25, v25, v25 row_ror:8 row_mask:0xf bank_mask:0xf
    v_add_f32_dpp v26, v26, v26 row_ror:8 row_mask:0xf bank_mask:0xf
    v_add_f32_dpp v27, v27, v27 row_ror:8 row_mask:0xf bank_mask:0xf
    v_add_f32_dpp v28, v28, v28 row_ror:8 row_mask:0xf bank_mask:0xf
    v_add_f32_dpp v29, v29, v29 row_ror:8 row_mask:0xf bank_mask:0xf
    v_add_f32_dpp v30, v30, v30 row_ror:8 row_mask:0xf bank_mask:0xf
    v_add_f32_dpp v31, v31, v31 row_ror:8 row_mask:0xf bank_mask:0xf
    v_add_f32_dpp v32, v32, v32 row_ror:8 row_mask:0xf bank_mask:0xf
    v_add_f32_dpp v33, v33, v33 row_ror:8 row_mask:0xf bank_mask:0xf
    v_add_f32_dpp v34, v34, v34 row_ror:8 row_mask:0xf bank_mask:0xf
    v_add_f32_dpp v35, v35, v35 row_ror:8 row_mask:0xf bank_mask:0xf
    v_add_f32_dpp v36, v36, v36 row_ror:8 row_mask:0xf bank_mask:0xf
    v_add_f32_dpp v37, v37, v37 row_ror:8 row_mask:0xf bank_mask:0xf
    v_add_f32_dpp v38, v38, v38 row_ror:8 row_mask:0xf bank_mask:0xf
    v_add_f32_dpp v39, v39, v39 row_ror:8 row_mask:0xf bank_mask:0xf
    v_mov_b32 v40, v24
    v_mov_b32 v41, v25
    v_mov_b32 v42, v26
    v_mov_b32 v43, v27
    v_mov_b32 v44, v28
    v_mov_b32 v45, v29
    v_mov_b32 v46, v30
    v_mov_b32 v47, v31
    v_permlane32_swap_b32 v24, v40
    v_permlane32_swap_b32 v25, v41
    v_permlane32_swap_b32 v26, v42
    v_permlane32_swap_b32 v27, v43
    v_permlane32_swap_b32 v28, v44
    v_permlane32_swap_b32 v29, v45
    v_permlane32_swap_b32 v30, v46
    v_permlane32_swap_b32 v31, v47
    v_add_f32 v24, v24, v40
    v_add_f32 v25, v25, v41
    v_add_f32 v26, v26, v42
    v_add_f32 v27, v27, v43
    v_add_f32 v28, v28, v44
    v_add_f32 v29, v29, v45
    v_add_f32 v30, v30, v46
    v_add_f32 v31, v31, v47
    v_mov_b32 v40, v32
    v_mov_b32 v41, v33
    v_mov_b32 v42, v34
    v_mov_b32 v43, v35
    v_mov_b32 v44, v36
    v_mov_b32 v45, v37
    v_mov_b32 v46, v38
    v_mov_b32 v47, v39
    v_permlane32_swap_b32 v32, v40
    v_permlane32_swap_b32 v33, v41
    v_permlane32_swap_b32 v34, v42
    v_permlane32_swap_b32 v35, v43
    v_permlane32_swap_b32 v36, v44
    v_permlane32_swap_b32 v37, v45
    v_permlane32_swap_b32 v38, v46
    v_permlane32_swap_b32 v39, v47
    v_add_f32 v32, v32, v40
    v_add_f32 v33, v33, v41
    v_add_f32 v34, v34, v42
    v_add_f32 v35, v35, v43
    v_add_f32 v36, v36, v44
    v_add_f32 v37, v37, v45
    v_add_f32 v38, v38, v46
    v_add_f32 v39, v39, v47
    s_mov_b64 exec, 0x00ff00ff
    ds_write_b128 v18, v[24:27] offset:0
    ds_write_b128 v18, v[28:31] offset:16
    ds_write_b128 v18, v[32:35] offset:256
    ds_write_b128 v18, v[36:39] offset:272
    s_mov_b64 exec, -1
    s_waitcnt lgkmcnt(0)
    s_barrier
    s_cmp_lg_u32 s66, 0
    s_cbranch_scc1 sequential_preLN__sliding_block__geglu_ffn__prompt_kernel_nofin56
    ds_read_b64 v[24:25], v19 offset:512
    ds_read_b64 v[26:27], v19 offset:1024
    ds_read_b64 v[28:29], v19 offset:1536
    ds_read_b64 v[30:31], v19 offset:2048
    ds_read_b64 v[32:33], v19 offset:2560
    ds_read_b64 v[34:35], v19 offset:3072
    ds_read_b64 v[36:37], v19 offset:3584
    ds_read_b64 v[38:39], v19 offset:4096
    s_waitcnt lgkmcnt(0)
    v_add_f32 v24, v24, v32
    v_add_f32 v25, v25, v33
    v_add_f32 v26, v26, v34
    v_add_f32 v27, v27, v35
    v_add_f32 v28, v28, v36
    v_add_f32 v29, v29, v37
    v_add_f32 v30, v30, v38
    v_add_f32 v31, v31, v39
    v_add_f32 v24, v24, v28
    v_add_f32 v25, v25, v29
    v_add_f32 v26, v26, v30
    v_add_f32 v27, v27, v31
    v_add_f32 v24, v24, v26
    v_add_f32 v25, v25, v27
    ds_write_b64 v19, v[24:25]
    s_waitcnt lgkmcnt(0)
    s_nop 2
sequential_preLN__sliding_block__geglu_ffn__prompt_kernel_nofin56:
    s_barrier
    s_waitcnt vmcnt(0)
    s_barrier
    s_cmp_lg_u32 s3, 11
    s_cbranch_scc1 sequential_preLN__sliding_block__geglu_ffn__prompt_kernel_nosig57
    s_lshl_b32 s33, s63, 5
    s_add_u32 s33, s33, s62
    s_lshl_b32 s33, s33, 7
    s_add_u32 s33, s33, 131072
    v_mov_b32 v4, s24
    v_mov_b32 v5, 0
    s_mov_b64 exec, 1
    buffer_store_dword v4, v5, s[92:95], s33 offen sc1
    s_mov_b64 exec, -1
    s_nop 1
sequential_preLN__sliding_block__geglu_ffn__prompt_kernel_nosig57:
sequential_preLN__sliding_block__geglu_ffn__prompt_kernel_p4_join47:
    s_branch sequential_preLN__sliding_block__geglu_ffn__prompt_kernel_p4end44
    s_nop 0
sequential_preLN__sliding_block__geglu_ffn__prompt_kernel_p4spare43:
    s_cmp_lt_u32 s3, 8
    s_cbranch_scc1 sequential_preLN__sliding_block__geglu_ffn__prompt_kernel_p4idle58
    s_mov_b32 s34, 98304
    s_mov_b32 s30, 0xff
    s_mov_b32 s31, 0
    s_mov_b32 s32, 0x40000
    v_lshlrev_b32 v8, 12, v1
    s_mov_b64 exec, s[30:31]
    s_nop 3
sequential_preLN__sliding_block__geglu_ffn__prompt_kernel_poll59:
    buffer_load_dword v4, v8, s[92:95], s34 offen sc1
    s_waitcnt vmcnt(0)
    v_xor_b32 v4, s24, v4
    v_cmp_ne_u32 vcc, 0, v4
    s_nop 0
    s_and_b64 s[28:29], vcc, s[30:31]
    s_cbranch_scc0 sequential_preLN__sliding_block__geglu_ffn__prompt_kernel_pdone60
    s_sub_u32 s32, s32, 1
    s_cbranch_scc1 sequential_preLN__sliding_block__geglu_ffn__prompt_kernel_pdone60
    s_sleep 1
    s_branch sequential_preLN__sliding_block__geglu_ffn__prompt_kernel_poll59
    s_nop 0
sequential_preLN__sliding_block__geglu_ffn__prompt_kernel_pdone60:
    s_mov_b64 exec, -1
    s_sub_u32 s78, s3, 8
    s_mul_i32 s77, s78, 3840
    s_and_b32 s76, s26, 7
    s_mul_i32 s76, s76, 276480
    s_add_u32 s76, s76, s77
    s_add_u32 s80, s22, 0x1488000
    s_addc_u32 s81, s23, 0
    s_and_b32 s81, s81, 0xffff
    s_mov_b32 s82, 0x21c000
    s_mov_b32 s83, 0x20000
    s_add_u32 m0, s77, 94208
    s_add_u32 s33, s76, 0
    buffer_load_dwordx4 v13, s[80:83], s33 offen sc1 lds
    s_add_u32 m0, s77, 95232
    s_add_u32 s33, s76, 1024
    buffer_load_dwordx4 v13, s[80:83], s33 offen sc1 lds
    s_add_u32 m0, s77, 96256
    s_add_u32 s33, s76, 2048
    buffer_load_dwordx4 v13, s[80:83], s33 offen sc1 lds
    s_add_u32 m0, s77, 97280
    s_add_u32 s33, s76, 3072
    s_mov_b32 exec_hi, 0xffff
    buffer_load_dwordx4 v13, s[80:83], s33 offen sc1 lds
    s_mov_b64 exec, -1
    s_add_u32 m0, s77, 109568
    s_add_u32 s33, s76, 15360
    buffer_load_dwordx4 v13, s[80:83], s33 offen sc1 lds
    s_add_u32 m0, s77, 110592
    s_add_u32 s33, s76, 16384
    buffer_load_dwordx4 v13, s[80:83], s33 offen sc1 lds
    s_add_u32 m0, s77, 111616
    s_add_u32 s33, s76, 17408
    buffer_load_dwordx4 v13, s[80:83], s33 offen sc1 lds
    s_add_u32 m0, s77, 112640
    s_add_u32 s33, s76, 18432
    s_mov_b32 exec_hi, 0xffff
    buffer_load_dwordx4 v13, s[80:83], s33 offen sc1 lds
    s_mov_b64 exec, -1
    s_add_u32 m0, s77, 124928
    s_add_u32 s33, s76, 30720
    buffer_load_dwordx4 v13, s[80:83], s33 offen sc1 lds
    s_add_u32 m0, s77, 125952
    s_add_u32 s33, s76, 31744
    buffer_load_dwordx4 v13, s[80:83], s33 offen sc1 lds
    s_add_u32 m0, s77, 126976
    s_add_u32 s33, s76, 32768
    buffer_load_dwordx4 v13, s[80:83], s33 offen sc1 lds
    s_add_u32 m0, s77, 128000
    s_add_u32 s33, s76, 33792
    s_mov_b32 exec_hi, 0xffff
    buffer_load_dwordx4 v13, s[80:83], s33 offen sc1 lds
    s_mov_b64 exec, -1
    s_add_u32 m0, s77, 140288
    s_add_u32 s33, s76, 46080
    buffer_load_dwordx4 v13, s[80:83], s33 offen sc1 lds
    s_add_u32 m0, s77, 141312
    s_add_u32 s33, s76, 47104
    buffer_load_dwordx4 v13, s[80:83], s33 offen sc1 lds
    s_add_u32 m0, s77, 142336
    s_add_u32 s33, s76, 48128
    buffer_load_dwordx4 v13, s[80:83], s33 offen sc1 lds
    s_add_u32 m0, s77, 143360
    s_add_u32 s33, s76, 49152
    s_mov_b32 exec_hi, 0xffff
    buffer_load_dwordx4 v13, s[80:83], s33 offen sc1 lds
    s_mov_b64 exec, -1
    s_waitcnt vmcnt(0)
    s_nop 0
sequential_preLN__sliding_block__geglu_ffn__prompt_kernel_p4idle58:
    s_barrier
    s_nop 0
sequential_preLN__sliding_block__geglu_ffn__prompt_kernel_p4end44:
ph5:
    s_lshr_b32 s34, s26, 3
    s_and_b32 s35, s26, 7
    s_lshl_b32 s36, s25, 2
    s_add_u32 s36, s36, s34
    s_cmp_ge_u32 s3, 8
    s_cbranch_scc1 sequential_preLN__sliding_block__geglu_ffn__prompt_kernel_p5_r63
    s_cmp_ge_u32 s3, 4
    s_cbranch_scc1 sequential_preLN__sliding_block__geglu_ffn__prompt_kernel_p5_r62
    s_lshl_b32 s37, s36, 2
    s_add_u32 s37, s37, s3
    s_mul_i32 s38, s37, 55296
    s_mul_i32 s39, s35, 160
    v_mul_u32_u24 v5, 6554, v1
    v_lshrrev_b32 v5, 16, v5
    v_mul_u32_u24 v6, 10, v5
    v_sub_u32 v6, v1, v6
    v_mul_u32_u24 v5, 1280, v5
    v_lshl_add_u32 v14, v6, 4, v5
    v_add_u32 v4, 64, v1
    v_mul_u32_u24 v5, 6554, v4
    v_lshrrev_b32 v5, 16, v5
    v_mul_u32_u24 v6, 10, v5
    v_sub_u32 v6, v4, v6
    v_mul_u32_u24 v5, 1280, v5
    v_lshl_add_u32 v15, v6, 4, v5
    v_add_u32 v4, 128, v1
    v_mul_u32_u24 v5, 6554, v4
    v_lshrrev_b32 v5, 16, v5
    v_mul_u32_u24 v6, 10, v5
    v_sub_u32 v6, v4, v6
    v_mul_u32_u24 v5, 1280, v5
    v_lshl_add_u32 v16, v6, 4, v5
    s_add_u32 s44, s22, 0xd00000
    s_addc_u32 s45, s23, 0
    s_and_b32 s45, s45, 0xffff
    s_mov_b32 s46, 0x6c0000
    s_mov_b32 s47, 0x20000
    s_mov_b32 s48, s18
    s_and_b32 s49, s19, 0xffff
    s_mov_b32 s50, 0x280000
    s_mov_b32 s51, 0x20000
    s_add_u32 s52, s22, 0xa00000
    s_addc_u32 s53, s23, 0
    s_and_b32 s53, s53, 0xffff
    s_mov_b32 s54, 0x280000
    s_mov_b32 s55, 0x20000
    s_mul_i32 s40, s3, 2560
    s_add_u32 s40, s40, 32768
    v_and_b32 v8, 15, v1
    v_lshrrev_b32 v9, 4, v1
    v_lshrrev_b32 v4, 1, v9
    v_lshlrev_b32 v4, 9, v4
    v_lshl_add_u32 v4, v8, 4, v4
    v_and_b32 v5, 1, v9
    v_lshl_add_u32 v20, v5, 3, v4
    v_lshl_add_u32 v23, v5, 10, v4
    s_lshr_b32 s41, s37, 1
    s_mul_i32 s41, s41, 40960
    s_and_b32 s33, s37, 1
    s_lshl_b32 s33, s33, 8
    s_add_u32 s41, s41, s33
    s_mul_i32 s33, s35, 5120
    s_add_u32 s41, s41, s33
    s_mul_i32 s42, s37, 20480
    s_add_u32 s42, s42, s39
    v_bfe_u32 v4, v1, 2, 2
    v_and_b32 v5, 3, v1
    v_lshrrev_b32 v6, 1, v9
    v_and_b32 v7, 1, v9
    v_lshlrev_b32 v6, 4, v6
    v_lshl_add_u32 v6, v7, 2, v6
    v_add_u32 v6, v6, v4
    v_mul_u32_u24 v6, 160, v6
    v_lshl_add_u32 v17, v5, 3, v6
    v_add_u32 v18, 65536, v17
    v_add_u32 v19, 131072, v17
    v_mul_u32_u24 v4, 160, v8
    v_lshl_add_u32 v4, v9, 3, v4
    v_add_u32 v21, s40, v4
    v_add_u32 v22, s40, v13
    s_add_u32 s33, s41, 0
    buffer_load_dwordx2 v[132:133], v20, s[52:55], s33 offen sc1
    s_add_u32 s33, s41, 1024
    buffer_load_dwordx2 v[134:135], v20, s[52:55], s33 offen sc1
    s_add_u32 s33, s41, 2048
    buffer_load_dwordx2 v[136:137], v20, s[52:55], s33 offen sc1
    s_add_u32 s33, s41, 3072
    buffer_load_dwordx2 v[138:139], v20, s[52:55], s33 offen sc1
    s_add_u32 s33, s41, 4096
    buffer_load_dwordx2 v[140:141], v20, s[52:55], s33 offen sc1
    s_barrier
    s_add_u32 s33, s38, 0
    buffer_load_dwordx4 v[24:27], v13, s[44:47], s33 offen sc1
    s_add_u32 s33, s38, 1024
    buffer_load_dwordx4 v[28:31], v13, s[44:47], s33 offen sc1
    s_add_u32 s33, s38, 2048
    buffer_load_dwordx4 v[32:35], v13, s[44:47], s33 offen sc1
    s_add_u32 s33, s38, 3072
    buffer_load_dwordx4 v[36:39], v13, s[44:47], s33 offen sc1
    s_add_u32 s33, s38, 4096
    buffer_load_dwordx4 v[40:43], v13, s[44:47], s33 offen sc1
    s_add_u32 s33, s38, 5120
    buffer_load_dwordx4 v[44:47], v13, s[44:47], s33 offen sc1
    s_add_u32 s33, s38, 6144
    buffer_load_dwordx4 v[48:51], v13, s[44:47], s33 offen sc1
    s_add_u32 s33, s38, 7168
    buffer_load_dwordx4 v[52:55], v13, s[44:47], s33 offen sc1
    s_add_u32 s33, s38, 8192
    buffer_load_dwordx4 v[56:59], v13, s[44:47], s33 offen sc1
    s_add_u32 s33, s38, 9216
    buffer_load_dwordx4 v[60:63], v13, s[44:47], s33 offen sc1
    ds_read_b64_tr_b16 v[72:73], v18 offset:28672
    ds_read_b64_tr_b16 v[74:75], v18 offset:29952
    ds_read_b64_tr_b16 v[76:77], v18 offset:28704
    ds_read_b64_tr_b16 v[78:79], v18 offset:29984
    ds_read_b64_tr_b16 v[80:81], v18 offset:28736
    ds_read_b64_tr_b16 v[82:83], v18 offset:30016
    ds_read_b64_tr_b16 v[84:85], v18 offset:28768
    ds_read_b64_tr_b16 v[86:87], v18 offset:30048
    ds_read_b64_tr_b16 v[88:89], v18 offset:28800
    ds_read_b64_tr_b16 v[90:91], v18 offset:30080
    s_waitcnt vmcnt(9)
    s_waitcnt lgkmcnt(8)
    v_mfma_f32_16x16x32_bf16 v[112:115], v[72:75], v[24:27], 0
    ds_read_b64_tr_b16 v[92:93], v18 offset:33792
    ds_read_b64_tr_b16 v[94:95], v18 offset:35072
    s_add_u32 s33, s38, 10240
    buffer_load_dwordx4 v[64:67], v13, s[44:47], s33 offen sc1
    s_waitcnt lgkmcnt(8)
    v_mfma_f32_16x16x32_bf16 v[116:119], v[76:79], v[24:27], 0
    ds_read_b64_tr_b16 v[96:97], v18 offset:33824
    ds_read_b64_tr_b16 v[98:99], v18 offset:35104
    s_waitcnt lgkmcnt(8)
    v_mfma_f32_16x16x32_bf16 v[120:123], v[80:83], v[24:27], 0
    ds_read_b64_tr_b16 v[100:101], v18 offset:33856
    ds_read_b64_tr_b16 v[102:103], v18 offset:35136
    s_waitcnt lgkmcnt(8)
    v_mfma_f32_16x16x32_bf16 v[124:127], v[84:87], v[24:27], 0
    ds_read_b64_tr_b16 v[104:105], v18 offset:33888
    ds_read_b64_tr_b16 v[106:107], v18 offset:35168
    s_waitcnt lgkmcnt(8)
    v_mfma_f32_16x16x32_bf16 v[128:131], v[88:91], v[24:27], 0
    ds_read_b64_tr_b16 v[108:109], v18 offset:33920
    ds_read_b64_tr_b16 v[110:111], v18 offset:35200
    s_waitcnt vmcnt(9)
    s_waitcnt lgkmcnt(8)
    v_mfma_f32_16x16x32_bf16 v[112:115], v[92:95], v[28:31], v[112:115]
    ds_read_b64_tr_b16 v[72:73], v18 offset:38912
    ds_read_b64_tr_b16 v[74:75], v18 offset:40192
    s_add_u32 s33, s38, 11264
    buffer_load_dwordx4 v[68:71], v13, s[44:47], s33 offen sc1
    s_waitcnt lgkmcnt(8)
    v_mfma_f32_16x16x32_bf16 v[116:119], v[96:99], v[28:31], v[116:119]
    ds_read_b64_tr_b16 v[76:77], v18 offset:38944
    ds_read_b64_tr_b16 v[78:79], v18 offset:40224
    s_waitcnt lgkmcnt(8)
    v_mfma_f32_16x16x32_bf16 v[120:123], v[100:103], v[28:31], v[120:123]
    ds_read_b64_tr_b16 v[80:81], v18 offset:38976
    ds_read_b64_tr_b16 v[82:83], v18 offset:40256
    s_waitcnt lgkmcnt(8)
    v_mfma_f32_16x16x32_bf16 v[124:127], v[104:107], v[28:31], v[124:127]
    ds_read_b64_tr_b16 v[84:85], v18 offset:39008
    ds_read_b64_tr_b16 v[86:87], v18 offset:40288
    s_waitcnt lgkmcnt(8)
    v_mfma_f32_16x16x32_bf16 v[128:131], v[108:111], v[28:31], v[128:131]
    ds_read_b64_tr_b16 v[88:89], v18 offset:39040
    ds_read_b64_tr_b16 v[90:91], v18 offset:40320
    s_waitcnt vmcnt(9)
    s_waitcnt lgkmcnt(8)
    v_mfma_f32_16x16x32_bf16 v[112:115], v[72:75], v[32:35], v[112:115]
    ds_read_b64_tr_b16 v[92:93], v18 offset:44032
    ds_read_b64_tr_b16 v[94:95], v18 offset:45312
    s_add_u32 s33, s38, 12288
    buffer_load_dwordx4 v[24:27], v13, s[44:47], s33 offen sc1
    s_waitcnt lgkmcnt(8)
    v_mfma_f32_16x16x32_bf16 v[116:119], v[76:79], v[32:35], v[116:119]
    ds_read_b64_tr_b16 v[96:97], v18 offset:44064
    ds_read_b64_tr_b16 v[98:99], v18 offset:45344
    s_waitcnt lgkmcnt(8)
    v_mfma_f32_16x16x32_bf16 v[120:123], v[80:83], v[32:35], v[120:123]
    ds_read_b64_tr_b16 v[100:101], v18 offset:44096
    ds_read_b64_tr_b16 v[102:103], v18 offset:45376
    s_waitcnt lgkmcnt(8)
    v_mfma_f32_16x16x32_bf16 v[124:127], v[84:87], v[32:35], v[124:127]
    ds_read_b64_tr_b16 v[104:105], v18 offset:44128
    ds_read_b64_tr_b16 v[106:107], v18 offset:45408
    s_waitcnt lgkmcnt(8)
    v_mfma_f32_16x16x32_bf16 v[128:131], v[88:91], v[32:35], v[128:131]
    ds_read_b64_tr_b16 v[108:109], v18 offset:44160
    ds_read_b64_tr_b16 v[110:111], v18 offset:45440
    s_waitcnt vmcnt(9)
    s_waitcnt lgkmcnt(8)
    v_mfma_f32_16x16x32_bf16 v[112:115], v[92:95], v[36:39], v[112:115]
    ds_read_b64_tr_b16 v[72:73], v18 offset:49152
    ds_read_b64_tr_b16 v[74:75], v18 offset:50432
    s_add_u32 s33, s38, 13312
    buffer_load_dwordx4 v[28:31], v13, s[44:47], s33 offen sc1
    s_waitcnt lgkmcnt(8)
    v_mfma_f32_16x16x32_bf16 v[116:119], v[96:99], v[36:39], v[116:119]
    ds_read_b64_tr_b16 v[76:77], v18 offset:49184
    ds_read_b64_tr_b16 v[78:79], v18 offset:50464
    s_waitcnt lgkmcnt(8)
    v_mfma_f32_16x16x32_bf16 v[120:123], v[100:103], v[36:39], v[120:123]
    ds_read_b64_tr_b16 v[80:81], v18 offset:49216
    ds_read_b64_tr_b16 v[82:83], v18 offset:50496
    s_waitcnt lgkmcnt(8)
    v_mfma_f32_16x16x32_bf16 v[124:127], v[104:107], v[36:39], v[124:127]
    ds_read_b64_tr_b16 v[84:85], v18 offset:49248
    ds_read_b64_tr_b16 v[86:87], v18 offset:50528
    s_waitcnt lgkmcnt(8)
    v_mfma_f32_16x16x32_bf16 v[128:131], v[108:111], v[36:39], v[128:131]
    ds_read_b64_tr_b16 v[88:89], v18 offset:49280
    ds_read_b64_tr_b16 v[90:91], v18 offset:50560
    s_waitcnt vmcnt(9)
    s_waitcnt lgkmcnt(8)
    v_mfma_f32_16x16x32_bf16 v[112:115], v[72:75], v[40:43], v[112:115]
    ds_read_b64_tr_b16 v[92:93], v18 offset:54272
    ds_read_b64_tr_b16 v[94:95], v18 offset:55552
    s_add_u32 s33, s38, 14336
    buffer_load_dwordx4 v[32:35], v13, s[44:47], s33 offen sc1
    s_waitcnt lgkmcnt(8)
    v_mfma_f32_16x16x32_bf16 v[116:119], v[76:79], v[40:43], v[116:119]
    ds_read_b64_tr_b16 v[96:97], v18 offset:54304
    ds_read_b64_tr_b16 v[98:99], v18 offset:55584
    s_waitcnt lgkmcnt(8)
    v_mfma_f32_16x16x32_bf16 v[120:123], v[80:83], v[40:43], v[120:123]
    ds_read_b64_tr_b16 v[100:101], v18 offset:54336
    ds_read_b64_tr_b16 v[102:103], v18 offset:55616
    s_waitcnt lgkmcnt(8)
    v_mfma_f32_16x16x32_bf16 v[124:127], v[84:87], v[40:43], v[124:127]
    ds_read_b64_tr_b16 v[104:105], v18 offset:54368
    ds_read_b64_tr_b16 v[106:107], v18 offset:55648
    s_waitcnt lgkmcnt(8)
    v_mfma_f32_16x16x32_bf16 v[128:131], v[88:91], v[40:43], v[128:131]
    ds_read_b64_tr_b16 v[108:109], v18 offset:54400
    ds_read_b64_tr_b16 v[110:111], v18 offset:55680
    s_waitcnt vmcnt(9)
    s_waitcnt lgkmcnt(8)
    v_mfma_f32_16x16x32_bf16 v[112:115], v[92:95], v[44:47], v[112:115]
    ds_read_b64_tr_b16 v[72:73], v18 offset:59392
    ds_read_b64_tr_b16 v[74:75], v18 offset:60672
    s_add_u32 s33, s38, 15360
    buffer_load_dwordx4 v[36:39], v13, s[44:47], s33 offen sc1
    s_waitcnt lgkmcnt(8)
    v_mfma_f32_16x16x32_bf16 v[116:119], v[96:99], v[44:47], v[116:119]
    ds_read_b64_tr_b16 v[76:77], v18 offset:59424
    ds_read_b64_tr_b16 v[78:79], v18 offset:60704
    s_waitcnt lgkmcnt(8)
    v_mfma_f32_16x16x32_bf16 v[120:123], v[100:103], v[44:47], v[120:123]
    ds_read_b64_tr_b16 v[80:81], v18 offset:59456
    ds_read_b64_tr_b16 v[82:83], v18 offset:60736
    s_waitcnt lgkmcnt(8)
    v_mfma_f32_16x16x32_bf16 v[124:127], v[104:107], v[44:47], v[124:127]
    ds_read_b64_tr_b16 v[84:85], v18 offset:59488
    ds_read_b64_tr_b16 v[86:87], v18 offset:60768
    s_waitcnt lgkmcnt(8)
    v_mfma_f32_16x16x32_bf16 v[128:131], v[108:111], v[44:47], v[128:131]
    ds_read_b64_tr_b16 v[88:89], v18 offset:59520
    ds_read_b64_tr_b16 v[90:91], v18 offset:60800
    s_waitcnt vmcnt(9)
    s_waitcnt lgkmcnt(8)
    v_mfma_f32_16x16x32_bf16 v[112:115], v[72:75], v[48:51], v[112:115]
    ds_read_b64_tr_b16 v[92:93], v18 offset:64512
    ds_read_b64_tr_b16 v[94:95], v19 offset:256
    s_add_u32 s33, s38, 16384
    buffer_load_dwordx4 v[40:43], v13, s[44:47], s33 offen sc1
    s_waitcnt lgkmcnt(8)
    v_mfma_f32_16x16x32_bf16 v[116:119], v[76:79], v[48:51], v[116:119]
    ds_read_b64_tr_b16 v[96:97], v18 offset:64544
    ds_read_b64_tr_b16 v[98:99], v19 offset:288
    s_waitcnt lgkmcnt(8)
    v_mfma_f32_16x16x32_bf16 v[120:123], v[80:83], v[48:51], v[120:123]
    ds_read_b64_tr_b16 v[100:101], v18 offset:64576
    ds_read_b64_tr_b16 v[102:103], v19 offset:320
    s_waitcnt lgkmcnt(8)
    v_mfma_f32_16x16x32_bf16 v[124:127], v[84:87], v[48:51], v[124:127]
    ds_read_b64_tr_b16 v[104:105], v18 offset:64608
    ds_read_b64_tr_b16 v[106:107], v19 offset:352
    s_waitcnt lgkmcnt(8)
    v_mfma_f32_16x16x32_bf16 v[128:131], v[88:91], v[48:51], v[128:131]
    ds_read_b64_tr_b16 v[108:109], v18 offset:64640
    ds_read_b64_tr_b16 v[110:111], v19 offset:384
    s_waitcnt vmcnt(9)
    s_waitcnt lgkmcnt(8)
    v_mfma_f32_16x16x32_bf16 v[112:115], v[92:95], v[52:55], v[112:115]
    ds_read_b64_tr_b16 v[72:73], v19 offset:4096
    ds_read_b64_tr_b16 v[74:75], v19 offset:5376
    s_add_u32 s33, s38, 17408
    buffer_load_dwordx4 v[44:47], v13, s[44:47], s33 offen sc1
    s_waitcnt lgkmcnt(8)
    v_mfma_f32_16x16x32_bf16 v[116:119], v[96:99], v[52:55], v[116:119]
    ds_read_b64_tr_b16 v[76:77], v19 offset:4128
    ds_read_b64_tr_b16 v[78:79], v19 offset:5408
    s_waitcnt lgkmcnt(8)
    v_mfma_f32_16x16x32_bf16 v[120:123], v[100:103], v[52:55], v[120:123]
    ds_read_b64_tr_b16 v[80:81], v19 offset:4160
    ds_read_b64_tr_b16 v[82:83], v19 offset:5440
    s_waitcnt lgkmcnt(8)
    v_mfma_f32_16x16x32_bf16 v[124:127], v[104:107], v[52:55], v[124:127]
    ds_read_b64_tr_b16 v[84:85], v19 offset:4192
    ds_read_b64_tr_b16 v[86:87], v19 offset:5472
    s_waitcnt lgkmcnt(8)
    v_mfma_f32_16x16x32_bf16 v[128:131], v[108:111], v[52:55], v[128:131]
    ds_read_b64_tr_b16 v[88:89], v19 offset:4224
    ds_read_b64_tr_b16 v[90:91], v19 offset:5504
    s_waitcnt vmcnt(9)
    s_waitcnt lgkmcnt(8)
    v_mfma_f32_16x16x32_bf16 v[112:115], v[72:75], v[56:59], v[112:115]
    ds_read_b64_tr_b16 v[92:93], v19 offset:9216
    ds_read_b64_tr_b16 v[94:95], v19 offset:10496
    s_add_u32 s33, s38, 18432
    buffer_load_dwordx4 v[48:51], v13, s[44:47], s33 offen sc1
    s_waitcnt lgkmcnt(8)
    v_mfma_f32_16x16x32_bf16 v[116:119], v[76:79], v[56:59], v[116:119]
    ds_read_b64_tr_b16 v[96:97], v19 offset:9248
    ds_read_b64_tr_b16 v[98:99], v19 offset:10528
    s_waitcnt lgkmcnt(8)
    v_mfma_f32_16x16x32_bf16 v[120:123], v[80:83], v[56:59], v[120:123]
    ds_read_b64_tr_b16 v[100:101], v19 offset:9280
    ds_read_b64_tr_b16 v[102:103], v19 offset:10560
    s_waitcnt lgkmcnt(8)
    v_mfma_f32_16x16x32_bf16 v[124:127], v[84:87], v[56:59], v[124:127]
    ds_read_b64_tr_b16 v[104:105], v19 offset:9312
    ds_read_b64_tr_b16 v[106:107], v19 offset:10592
    s_waitcnt lgkmcnt(8)
    v_mfma_f32_16x16x32_bf16 v[128:131], v[88:91], v[56:59], v[128:131]
    ds_read_b64_tr_b16 v[108:109], v19 offset:9344
    ds_read_b64_tr_b16 v[110:111], v19 offset:10624
    s_waitcnt vmcnt(9)
    s_waitcnt lgkmcnt(8)
    v_mfma_f32_16x16x32_bf16 v[112:115], v[92:95], v[60:63], v[112:115]
    ds_read_b64_tr_b16 v[72:73], v19 offset:14336
    ds_read_b64_tr_b16 v[74:75], v19 offset:15616
    s_add_u32 s33, s38, 19456
    buffer_load_dwordx4 v[52:55], v13, s[44:47], s33 offen sc1
    s_waitcnt lgkmcnt(8)
    v_mfma_f32_16x16x32_bf16 v[116:119], v[96:99], v[60:63], v[116:119]
    ds_read_b64_tr_b16 v[76:77], v19 offset:14368
    ds_read_b64_tr_b16 v[78:79], v19 offset:15648
    s_waitcnt lgkmcnt(8)
    v_mfma_f32_16x16x32_bf16 v[120:123], v[100:103], v[60:63], v[120:123]
    ds_read_b64_tr_b16 v[80:81], v19 offset:14400
    ds_read_b64_tr_b16 v[82:83], v19 offset:15680
    s_waitcnt lgkmcnt(8)
    v_mfma_f32_16x16x32_bf16 v[124:127], v[104:107], v[60:63], v[124:127]
    ds_read_b64_tr_b16 v[84:85], v19 offset:14432
    ds_read_b64_tr_b16 v[86:87], v19 offset:15712
    s_waitcnt lgkmcnt(8)
    v_mfma_f32_16x16x32_bf16 v[128:131], v[108:111], v[60:63], v[128:131]
    ds_read_b64_tr_b16 v[88:89], v19 offset:14464
    ds_read_b64_tr_b16 v[90:91], v19 offset:15744
    s_waitcnt vmcnt(9)
    s_waitcnt lgkmcnt(8)
    v_mfma_f32_16x16x32_bf16 v[112:115], v[72:75], v[64:67], v[112:115]
    ds_read_b64_tr_b16 v[92:93], v19 offset:19456
    ds_read_b64_tr_b16 v[94:95], v19 offset:20736
    s_add_u32 s33, s38, 20480
    buffer_load_dwordx4 v[56:59], v13, s[44:47], s33 offen sc1
    s_waitcnt lgkmcnt(8)
    v_mfma_f32_16x16x32_bf16 v[116:119], v[76:79], v[64:67], v[116:119]
    ds_read_b64_tr_b16 v[96:97], v19 offset:19488
    ds_read_b64_tr_b16 v[98:99], v19 offset:20768
    s_waitcnt lgkmcnt(8)
    v_mfma_f32_16x16x32_bf16 v[120:123], v[80:83], v[64:67], v[120:123]
    ds_read_b64_tr_b16 v[100:101], v19 offset:19520
    ds_read_b64_tr_b16 v[102:103], v19 offset:20800
    s_waitcnt lgkmcnt(8)
    v_mfma_f32_16x16x32_bf16 v[124:127], v[84:87], v[64:67], v[124:127]
    ds_read_b64_tr_b16 v[104:105], v19 offset:19552
    ds_read_b64_tr_b16 v[106:107], v19 offset:20832
    s_waitcnt lgkmcnt(8)
    v_mfma_f32_16x16x32_bf16 v[128:131], v[88:91], v[64:67], v[128:131]
    ds_read_b64_tr_b16 v[108:109], v19 offset:19584
    ds_read_b64_tr_b16 v[110:111], v19 offset:20864
    s_waitcnt vmcnt(9)
    s_waitcnt lgkmcnt(8)
    v_mfma_f32_16x16x32_bf16 v[112:115], v[92:95], v[68:71], v[112:115]
    s_barrier
    ds_read_b64_tr_b16 v[72:73], v17 offset:0
    ds_read_b64_tr_b16 v[74:75], v17 offset:1280
    s_add_u32 s33, s38, 21504
    buffer_load_dwordx4 v[60:63], v13, s[44:47], s33 offen sc1
    s_waitcnt lgkmcnt(8)
    v_mfma_f32_16x16x32_bf16 v[116:119], v[96:99], v[68:71], v[116:119]
    ds_read_b64_tr_b16 v[76:77], v17 offset:32
    ds_read_b64_tr_b16 v[78:79], v17 offset:1312
    s_waitcnt lgkmcnt(8)
    v_mfma_f32_16x16x32_bf16 v[120:123], v[100:103], v[68:71], v[120:123]
    ds_read_b64_tr_b16 v[80:81], v17 offset:64
    ds_read_b64_tr_b16 v[82:83], v17 offset:1344
    s_waitcnt lgkmcnt(8)
    v_mfma_f32_16x16x32_bf16 v[124:127], v[104:107], v[68:71], v[124:127]
    ds_read_b64_tr_b16 v[84:85], v17 offset:96
    ds_read_b64_tr_b16 v[86:87], v17 offset:1376
    s_waitcnt lgkmcnt(8)
    v_mfma_f32_16x16x32_bf16 v[128:131], v[108:111], v[68:71], v[128:131]
    ds_read_b64_tr_b16 v[88:89], v17 offset:128
    ds_read_b64_tr_b16 v[90:91], v17 offset:1408
    s_waitcnt vmcnt(9)
    s_waitcnt lgkmcnt(8)
    v_mfma_f32_16x16x32_bf16 v[112:115], v[72:75], v[24:27], v[112:115]
    ds_read_b64_tr_b16 v[92:93], v17 offset:5120
    ds_read_b64_tr_b16 v[94:95], v17 offset:6400
    s_add_u32 s33, s38, 22528
    buffer_load_dwordx4 v[64:67], v13, s[44:47], s33 offen sc1
    s_waitcnt lgkmcnt(8)
    v_mfma_f32_16x16x32_bf16 v[116:119], v[76:79], v[24:27], v[116:119]
    ds_read_b64_tr_b16 v[96:97], v17 offset:5152
    ds_read_b64_tr_b16 v[98:99], v17 offset:6432
    s_waitcnt lgkmcnt(8)
    v_mfma_f32_16x16x32_bf16 v[120:123], v[80:83], v[24:27], v[120:123]
    ds_read_b64_tr_b16 v[100:101], v17 offset:5184
    ds_read_b64_tr_b16 v[102:103], v17 offset:6464
    s_waitcnt lgkmcnt(8)
    v_mfma_f32_16x16x32_bf16 v[124:127], v[84:87], v[24:27], v[124:127]
    ds_read_b64_tr_b16 v[104:105], v17 offset:5216
    ds_read_b64_tr_b16 v[106:107], v17 offset:6496
    s_waitcnt lgkmcnt(8)
    v_mfma_f32_16x16x32_bf16 v[128:131], v[88:91], v[24:27], v[128:131]
    ds_read_b64_tr_b16 v[108:109], v17 offset:5248
    ds_read_b64_tr_b16 v[110:111], v17 offset:6528
    s_waitcnt vmcnt(9)
    s_waitcnt lgkmcnt(8)
    v_mfma_f32_16x16x32_bf16 v[112:115], v[92:95], v[28:31], v[112:115]
    ds_read_b64_tr_b16 v[72:73], v17 offset:10240
    ds_read_b64_tr_b16 v[74:75], v17 offset:11520
    s_add_u32 s33, s38, 23552
    buffer_load_dwordx4 v[68:71], v13, s[44:47], s33 offen sc1
    s_waitcnt lgkmcnt(8)
    v_mfma_f32_16x16x32_bf16 v[116:119], v[96:99], v[28:31], v[116:119]
    ds_read_b64_tr_b16 v[76:77], v17 offset:10272
    ds_read_b64_tr_b16 v[78:79], v17 offset:11552
    s_waitcnt lgkmcnt(8)
    v_mfma_f32_16x16x32_bf16 v[120:123], v[100:103], v[28:31], v[120:123]
    ds_read_b64_tr_b16 v[80:81], v17 offset:10304
    ds_read_b64_tr_b16 v[82:83], v17 offset:11584
    s_waitcnt lgkmcnt(8)
    v_mfma_f32_16x16x32_bf16 v[124:127], v[104:107], v[28:31], v[124:127]
    ds_read_b64_tr_b16 v[84:85], v17 offset:10336
    ds_read_b64_tr_b16 v[86:87], v17 offset:11616
    s_waitcnt lgkmcnt(8)
    v_mfma_f32_16x16x32_bf16 v[128:131], v[108:111], v[28:31], v[128:131]
    ds_read_b64_tr_b16 v[88:89], v17 offset:10368
    ds_read_b64_tr_b16 v[90:91], v17 offset:11648
    s_waitcnt vmcnt(9)
    s_waitcnt lgkmcnt(8)
    v_mfma_f32_16x16x32_bf16 v[112:115], v[72:75], v[32:35], v[112:115]
    s_barrier
    ds_read_b64_tr_b16 v[92:93], v17 offset:15360
    ds_read_b64_tr_b16 v[94:95], v17 offset:16640
    s_add_u32 s33, s38, 24576
    buffer_load_dwordx4 v[24:27], v13, s[44:47], s33 offen sc1
    s_waitcnt lgkmcnt(8)
    v_mfma_f32_16x16x32_bf16 v[116:119], v[76:79], v[32:35], v[116:119]
    ds_read_b64_tr_b16 v[96:97], v17 offset:15392
    ds_read_b64_tr_b16 v[98:99], v17 offset:16672
    s_waitcnt lgkmcnt(8)
    v_mfma_f32_16x16x32_bf16 v[120:123], v[80:83], v[32:35], v[120:123]
    ds_read_b64_tr_b16 v[100:101], v17 offset:15424
    ds_read_b64_tr_b16 v[102:103], v17 offset:16704
    s_waitcnt lgkmcnt(8)
    v_mfma_f32_16x16x32_bf16 v[124:127], v[84:87], v[32:35], v[124:127]
    ds_read_b64_tr_b16 v[104:105], v17 offset:15456
    ds_read_b64_tr_b16 v[106:107], v17 offset:16736
    s_waitcnt lgkmcnt(8)
    v_mfma_f32_16x16x32_bf16 v[128:131], v[88:91], v[32:35], v[128:131]
    ds_read_b64_tr_b16 v[108:109], v17 offset:15488
    ds_read_b64_tr_b16 v[110:111], v17 offset:16768
    s_waitcnt vmcnt(9)
    s_waitcnt lgkmcnt(8)
    v_mfma_f32_16x16x32_bf16 v[112:115], v[92:95], v[36:39], v[112:115]
    ds_read_b64_tr_b16 v[72:73], v17 offset:20480
    ds_read_b64_tr_b16 v[74:75], v17 offset:21760
    s_add_u32 s33, s38, 25600
    buffer_load_dwordx4 v[28:31], v13, s[44:47], s33 offen sc1
    s_waitcnt lgkmcnt(8)
    v_mfma_f32_16x16x32_bf16 v[116:119], v[96:99], v[36:39], v[116:119]
    ds_read_b64_tr_b16 v[76:77], v17 offset:20512
    ds_read_b64_tr_b16 v[78:79], v17 offset:21792
    s_waitcnt lgkmcnt(8)
    v_mfma_f32_16x16x32_bf16 v[120:123], v[100:103], v[36:39], v[120:123]
    ds_read_b64_tr_b16 v[80:81], v17 offset:20544
    ds_read_b64_tr_b16 v[82:83], v17 offset:21824
    s_waitcnt lgkmcnt(8)
    v_mfma_f32_16x16x32_bf16 v[124:127], v[104:107], v[36:39], v[124:127]
    ds_read_b64_tr_b16 v[84:85], v17 offset:20576
    ds_read_b64_tr_b16 v[86:87], v17 offset:21856
    s_waitcnt lgkmcnt(8)
    v_mfma_f32_16x16x32_bf16 v[128:131], v[108:111], v[36:39], v[128:131]
    ds_read_b64_tr_b16 v[88:89], v17 offset:20608
    ds_read_b64_tr_b16 v[90:91], v17 offset:21888
    s_waitcnt vmcnt(9)
    s_waitcnt lgkmcnt(8)
    v_mfma_f32_16x16x32_bf16 v[112:115], v[72:75], v[40:43], v[112:115]
    ds_read_b64_tr_b16 v[92:93], v17 offset:25600
    ds_read_b64_tr_b16 v[94:95], v17 offset:26880
    s_add_u32 s33, s38, 26624
    buffer_load_dwordx4 v[32:35], v13, s[44:47], s33 offen sc1
    s_waitcnt lgkmcnt(8)
    v_mfma_f32_16x16x32_bf16 v[116:119], v[76:79], v[40:43], v[116:119]
    ds_read_b64_tr_b16 v[96:97], v17 offset:25632
    ds_read_b64_tr_b16 v[98:99], v17 offset:26912
    s_waitcnt lgkmcnt(8)
    v_mfma_f32_16x16x32_bf16 v[120:123], v[80:83], v[40:43], v[120:123]
    ds_read_b64_tr_b16 v[100:101], v17 offset:25664
    ds_read_b64_tr_b16 v[102:103], v17 offset:26944
    s_waitcnt lgkmcnt(8)
    v_mfma_f32_16x16x32_bf16 v[124:127], v[84:87], v[40:43], v[124:127]
    ds_read_b64_tr_b16 v[104:105], v17 offset:25696
    ds_read_b64_tr_b16 v[106:107], v17 offset:26976
    s_waitcnt lgkmcnt(8)
    v_mfma_f32_16x16x32_bf16 v[128:131], v[88:91], v[40:43], v[128:131]
    ds_read_b64_tr_b16 v[108:109], v17 offset:25728
    ds_read_b64_tr_b16 v[110:111], v17 offset:27008
    s_waitcnt vmcnt(9)
    s_waitcnt lgkmcnt(8)
    v_mfma_f32_16x16x32_bf16 v[112:115], v[92:95], v[44:47], v[112:115]
    s_barrier
    ds_read_b64_tr_b16 v[72:73], v17 offset:45056
    ds_read_b64_tr_b16 v[74:75], v17 offset:46336
    s_add_u32 s33, s38, 27648
    buffer_load_dwordx4 v[36:39], v13, s[44:47], s33 offen sc1
    s_waitcnt lgkmcnt(8)
    v_mfma_f32_16x16x32_bf16 v[116:119], v[96:99], v[44:47], v[116:119]
    ds_read_b64_tr_b16 v[76:77], v17 offset:45088
    ds_read_b64_tr_b16 v[78:79], v17 offset:46368
    s_waitcnt lgkmcnt(8)
    v_mfma_f32_16x16x32_bf16 v[120:123], v[100:103], v[44:47], v[120:123]
    ds_read_b64_tr_b16 v[80:81], v17 offset:45120
    ds_read_b64_tr_b16 v[82:83], v17 offset:46400
    s_waitcnt lgkmcnt(8)
    v_mfma_f32_16x16x32_bf16 v[124:127], v[104:107], v[44:47], v[124:127]
    ds_read_b64_tr_b16 v[84:85], v17 offset:45152
    ds_read_b64_tr_b16 v[86:87], v17 offset:46432
    s_waitcnt lgkmcnt(8)
    v_mfma_f32_16x16x32_bf16 v[128:131], v[108:111], v[44:47], v[128:131]
    ds_read_b64_tr_b16 v[88:89], v17 offset:45184
    ds_read_b64_tr_b16 v[90:91], v17 offset:46464
    s_waitcnt vmcnt(9)
    s_waitcnt lgkmcnt(8)
    v_mfma_f32_16x16x32_bf16 v[112:115], v[72:75], v[48:51], v[112:115]
    ds_read_b64_tr_b16 v[92:93], v17 offset:50176
    ds_read_b64_tr_b16 v[94:95], v17 offset:51456
    s_add_u32 s33, s38, 28672
    buffer_load_dwordx4 v[40:43], v13, s[44:47], s33 offen sc1
    s_waitcnt lgkmcnt(8)
    v_mfma_f32_16x16x32_bf16 v[116:119], v[76:79], v[48:51], v[116:119]
    ds_read_b64_tr_b16 v[96:97], v17 offset:50208
    ds_read_b64_tr_b16 v[98:99], v17 offset:51488
    s_waitcnt lgkmcnt(8)
    v_mfma_f32_16x16x32_bf16 v[120:123], v[80:83], v[48:51], v[120:123]
    ds_read_b64_tr_b16 v[100:101], v17 offset:50240
    ds_read_b64_tr_b16 v[102:103], v17 offset:51520
    s_waitcnt lgkmcnt(8)
    v_mfma_f32_16x16x32_bf16 v[124:127], v[84:87], v[48:51], v[124:127]
    ds_read_b64_tr_b16 v[104:105], v17 offset:50272
    ds_read_b64_tr_b16 v[106:107], v17 offset:51552
    s_waitcnt lgkmcnt(8)
    v_mfma_f32_16x16x32_bf16 v[128:131], v[88:91], v[48:51], v[128:131]
    ds_read_b64_tr_b16 v[108:109], v17 offset:50304
    ds_read_b64_tr_b16 v[110:111], v17 offset:51584
    s_waitcnt vmcnt(9)
    s_waitcnt lgkmcnt(8)
    v_mfma_f32_16x16x32_bf16 v[112:115], v[92:95], v[52:55], v[112:115]
    ds_read_b64_tr_b16 v[72:73], v17 offset:55296
    ds_read_b64_tr_b16 v[74:75], v17 offset:56576
    s_add_u32 s33, s38, 29696
    buffer_load_dwordx4 v[44:47], v13, s[44:47], s33 offen sc1
    s_waitcnt lgkmcnt(8)
    v_mfma_f32_16x16x32_bf16 v[116:119], v[96:99], v[52:55], v[116:119]
    ds_read_b64_tr_b16 v[76:77], v17 offset:55328
    ds_read_b64_tr_b16 v[78:79], v17 offset:56608
    s_waitcnt lgkmcnt(8)
    v_mfma_f32_16x16x32_bf16 v[120:123], v[100:103], v[52:55], v[120:123]
    ds_read_b64_tr_b16 v[80:81], v17 offset:55360
    ds_read_b64_tr_b16 v[82:83], v17 offset:56640
    s_waitcnt lgkmcnt(8)
    v_mfma_f32_16x16x32_bf16 v[124:127], v[104:107], v[52:55], v[124:127]
    ds_read_b64_tr_b16 v[84:85], v17 offset:55392
    ds_read_b64_tr_b16 v[86:87], v17 offset:56672
    s_waitcnt lgkmcnt(8)
    v_mfma_f32_16x16x32_bf16 v[128:131], v[108:111], v[52:55], v[128:131]
    ds_read_b64_tr_b16 v[88:89], v17 offset:55424
    ds_read_b64_tr_b16 v[90:91], v17 offset:56704
    s_waitcnt vmcnt(9)
    s_waitcnt lgkmcnt(8)
    v_mfma_f32_16x16x32_bf16 v[112:115], v[72:75], v[56:59], v[112:115]
    s_barrier
    ds_read_b64_tr_b16 v[92:93], v17 offset:60416
    ds_read_b64_tr_b16 v[94:95], v17 offset:61696
    s_add_u32 s33, s38, 30720
    buffer_load_dwordx4 v[48:51], v13, s[44:47], s33 offen sc1
    s_waitcnt lgkmcnt(8)
    v_mfma_f32_16x16x32_bf16 v[116:119], v[76:79], v[56:59], v[116:119]
    ds_read_b64_tr_b16 v[96:97], v17 offset:60448
    ds_read_b64_tr_b16 v[98:99], v17 offset:61728
    s_waitcnt lgkmcnt(8)
    v_mfma_f32_16x16x32_bf16 v[120:123], v[80:83], v[56:59], v[120:123]
    ds_read_b64_tr_b16 v[100:101], v17 offset:60480
    ds_read_b64_tr_b16 v[102:103], v17 offset:61760
    s_waitcnt lgkmcnt(8)
    v_mfma_f32_16x16x32_bf16 v[124:127], v[84:87], v[56:59], v[124:127]
    ds_read_b64_tr_b16 v[104:105], v17 offset:60512
    ds_read_b64_tr_b16 v[106:107], v17 offset:61792
    s_waitcnt lgkmcnt(8)
    v_mfma_f32_16x16x32_bf16 v[128:131], v[88:91], v[56:59], v[128:131]
    ds_read_b64_tr_b16 v[108:109], v17 offset:60544
    ds_read_b64_tr_b16 v[110:111], v17 offset:61824
    s_waitcnt vmcnt(9)
    s_waitcnt lgkmcnt(8)
    v_mfma_f32_16x16x32_bf16 v[112:115], v[92:95], v[60:63], v[112:115]
    ds_read_b64_tr_b16 v[72:73], v18 offset:0
    ds_read_b64_tr_b16 v[74:75], v18 offset:1280
    s_add_u32 s33, s38, 31744
    buffer_load_dwordx4 v[52:55], v13, s[44:47], s33 offen sc1
    s_waitcnt lgkmcnt(8)
    v_mfma_f32_16x16x32_bf16 v[116:119], v[96:99], v[60:63], v[116:119]
    ds_read_b64_tr_b16 v[76:77], v18 offset:32
    ds_read_b64_tr_b16 v[78:79], v18 offset:1312
    s_waitcnt lgkmcnt(8)
    v_mfma_f32_16x16x32_bf16 v[120:123], v[100:103], v[60:63], v[120:123]
    ds_read_b64_tr_b16 v[80:81], v18 offset:64
    ds_read_b64_tr_b16 v[82:83], v18 offset:1344
    s_waitcnt lgkmcnt(8)
    v_mfma_f32_16x16x32_bf16 v[124:127], v[104:107], v[60:63], v[124:127]
    ds_read_b64_tr_b16 v[84:85], v18 offset:96
    ds_read_b64_tr_b16 v[86:87], v18 offset:1376
    s_waitcnt lgkmcnt(8)
    v_mfma_f32_16x16x32_bf16 v[128:131], v[108:111], v[60:63], v[128:131]
    ds_read_b64_tr_b16 v[88:89], v18 offset:128
    ds_read_b64_tr_b16 v[90:91], v18 offset:1408
    s_waitcnt vmcnt(9)
    s_waitcnt lgkmcnt(8)
    v_mfma_f32_16x16x32_bf16 v[112:115], v[72:75], v[64:67], v[112:115]
    ds_read_b64_tr_b16 v[92:93], v18 offset:5120
    ds_read_b64_tr_b16 v[94:95], v18 offset:6400
    s_add_u32 s33, s38, 32768
    buffer_load_dwordx4 v[56:59], v13, s[44:47], s33 offen sc1
    s_waitcnt lgkmcnt(8)
    v_mfma_f32_16x16x32_bf16 v[116:119], v[76:79], v[64:67], v[116:119]
    ds_read_b64_tr_b16 v[96:97], v18 offset:5152
    ds_read_b64_tr_b16 v[98:99], v18 offset:6432
    s_waitcnt lgkmcnt(8)
    v_mfma_f32_16x16x32_bf16 v[120:123], v[80:83], v[64:67], v[120:123]
    ds_read_b64_tr_b16 v[100:101], v18 offset:5184
    ds_read_b64_tr_b16 v[102:103], v18 offset:6464
    s_waitcnt lgkmcnt(8)
    v_mfma_f32_16x16x32_bf16 v[124:127], v[84:87], v[64:67], v[124:127]
    ds_read_b64_tr_b16 v[104:105], v18 offset:5216
    ds_read_b64_tr_b16 v[106:107], v18 offset:6496
    s_waitcnt lgkmcnt(8)
    v_mfma_f32_16x16x32_bf16 v[128:131], v[88:91], v[64:67], v[128:131]
    ds_read_b64_tr_b16 v[108:109], v18 offset:5248
    ds_read_b64_tr_b16 v[110:111], v18 offset:6528
    s_waitcnt vmcnt(9)
    s_waitcnt lgkmcnt(8)
    v_mfma_f32_16x16x32_bf16 v[112:115], v[92:95], v[68:71], v[112:115]
    s_barrier
    ds_read_b64_tr_b16 v[72:73], v18 offset:10240
    ds_read_b64_tr_b16 v[74:75], v18 offset:11520
    s_add_u32 s33, s38, 33792
    buffer_load_dwordx4 v[60:63], v13, s[44:47], s33 offen sc1
    s_waitcnt lgkmcnt(8)
    v_mfma_f32_16x16x32_bf16 v[116:119], v[96:99], v[68:71], v[116:119]
    ds_read_b64_tr_b16 v[76:77], v18 offset:10272
    ds_read_b64_tr_b16 v[78:79], v18 offset:11552
    s_waitcnt lgkmcnt(8)
    v_mfma_f32_16x16x32_bf16 v[120:123], v[100:103], v[68:71], v[120:123]
    ds_read_b64_tr_b16 v[80:81], v18 offset:10304
    ds_read_b64_tr_b16 v[82:83], v18 offset:11584
    s_waitcnt lgkmcnt(8)
    v_mfma_f32_16x16x32_bf16 v[124:127], v[104:107], v[68:71], v[124:127]
    ds_read_b64_tr_b16 v[84:85], v18 offset:10336
    ds_read_b64_tr_b16 v[86:87], v18 offset:11616
    s_waitcnt lgkmcnt(8)
    v_mfma_f32_16x16x32_bf16 v[128:131], v[108:111], v[68:71], v[128:131]
    ds_read_b64_tr_b16 v[88:89], v18 offset:10368
    ds_read_b64_tr_b16 v[90:91], v18 offset:11648
    s_waitcnt vmcnt(9)
    s_waitcnt lgkmcnt(8)
    v_mfma_f32_16x16x32_bf16 v[112:115], v[72:75], v[24:27], v[112:115]
    ds_read_b64_tr_b16 v[92:93], v18 offset:15360
    ds_read_b64_tr_b16 v[94:95], v18 offset:16640
    s_add_u32 s33, s38, 34816
    buffer_load_dwordx4 v[64:67], v13, s[44:47], s33 offen sc1
    s_waitcnt lgkmcnt(8)
    v_mfma_f32_16x16x32_bf16 v[116:119], v[76:79], v[24:27], v[116:119]
    ds_read_b64_tr_b16 v[96:97], v18 offset:15392
    ds_read_b64_tr_b16 v[98:99], v18 offset:16672
    s_waitcnt lgkmcnt(8)
    v_mfma_f32_16x16x32_bf16 v[120:123], v[80:83], v[24:27], v[120:123]
    ds_read_b64_tr_b16 v[100:101], v18 offset:15424
    ds_read_b64_tr_b16 v[102:103], v18 offset:16704
    s_waitcnt lgkmcnt(8)
    v_mfma_f32_16x16x32_bf16 v[124:127], v[84:87], v[24:27], v[124:127]
    ds_read_b64_tr_b16 v[104:105], v18 offset:15456
    ds_read_b64_tr_b16 v[106:107], v18 offset:16736
    s_waitcnt lgkmcnt(8)
    v_mfma_f32_16x16x32_bf16 v[128:131], v[88:91], v[24:27], v[128:131]
    ds_read_b64_tr_b16 v[108:109], v18 offset:15488
    ds_read_b64_tr_b16 v[110:111], v18 offset:16768
    s_waitcnt vmcnt(9)
    s_waitcnt lgkmcnt(8)
    v_mfma_f32_16x16x32_bf16 v[112:115], v[92:95], v[28:31], v[112:115]
    ds_read_b64_tr_b16 v[72:73], v18 offset:20480
    ds_read_b64_tr_b16 v[74:75], v18 offset:21760
    s_add_u32 s33, s38, 35840
    buffer_load_dwordx4 v[68:71], v13, s[44:47], s33 offen sc1
    s_waitcnt lgkmcnt(8)
    v_mfma_f32_16x16x32_bf16 v[116:119], v[96:99], v[28:31], v[116:119]
    ds_read_b64_tr_b16 v[76:77], v18 offset:20512
    ds_read_b64_tr_b16 v[78:79], v18 offset:21792
    s_waitcnt lgkmcnt(8)
    v_mfma_f32_16x16x32_bf16 v[120:123], v[100:103], v[28:31], v[120:123]
    ds_read_b64_tr_b16 v[80:81], v18 offset:20544
    ds_read_b64_tr_b16 v[82:83], v18 offset:21824
    s_waitcnt lgkmcnt(8)
    v_mfma_f32_16x16x32_bf16 v[124:127], v[104:107], v[28:31], v[124:127]
    ds_read_b64_tr_b16 v[84:85], v18 offset:20576
    ds_read_b64_tr_b16 v[86:87], v18 offset:21856
    s_waitcnt lgkmcnt(8)
    v_mfma_f32_16x16x32_bf16 v[128:131], v[108:111], v[28:31], v[128:131]
    ds_read_b64_tr_b16 v[88:89], v18 offset:20608
    ds_read_b64_tr_b16 v[90:91], v18 offset:21888
    s_waitcnt vmcnt(9)
    s_waitcnt lgkmcnt(8)
    v_mfma_f32_16x16x32_bf16 v[112:115], v[72:75], v[32:35], v[112:115]
    s_barrier
    ds_read_b64_tr_b16 v[92:93], v18 offset:28672
    ds_read_b64_tr_b16 v[94:95], v18 offset:29952
    s_add_u32 s33, s38, 36864
    buffer_load_dwordx4 v[24:27], v13, s[44:47], s33 offen sc1
    s_waitcnt lgkmcnt(8)
    v_mfma_f32_16x16x32_bf16 v[116:119], v[76:79], v[32:35], v[116:119]
    ds_read_b64_tr_b16 v[96:97], v18 offset:28704
    ds_read_b64_tr_b16 v[98:99], v18 offset:29984
    s_waitcnt lgkmcnt(8)
    v_mfma_f32_16x16x32_bf16 v[120:123], v[80:83], v[32:35], v[120:123]
    ds_read_b64_tr_b16 v[100:101], v18 offset:28736
    ds_read_b64_tr_b16 v[102:103], v18 offset:30016
    s_waitcnt lgkmcnt(8)
    v_mfma_f32_16x16x32_bf16 v[124:127], v[84:87], v[32:35], v[124:127]
    ds_read_b64_tr_b16 v[104:105], v18 offset:28768
    ds_read_b64_tr_b16 v[106:107], v18 offset:30048
    s_waitcnt lgkmcnt(8)
    v_mfma_f32_16x16x32_bf16 v[128:131], v[88:91], v[32:35], v[128:131]
    ds_read_b64_tr_b16 v[108:109], v18 offset:28800
    ds_read_b64_tr_b16 v[110:111], v18 offset:30080
    s_waitcnt vmcnt(9)
    s_waitcnt lgkmcnt(8)
    v_mfma_f32_16x16x32_bf16 v[112:115], v[92:95], v[36:39], v[112:115]
    ds_read_b64_tr_b16 v[72:73], v18 offset:33792
    ds_read_b64_tr_b16 v[74:75], v18 offset:35072
    s_add_u32 s33, s38, 37888
    buffer_load_dwordx4 v[28:31], v13, s[44:47], s33 offen sc1
    s_waitcnt lgkmcnt(8)
    v_mfma_f32_16x16x32_bf16 v[116:119], v[96:99], v[36:39], v[116:119]
    ds_read_b64_tr_b16 v[76:77], v18 offset:33824
    ds_read_b64_tr_b16 v[78:79], v18 offset:35104
    s_waitcnt lgkmcnt(8)
    v_mfma_f32_16x16x32_bf16 v[120:123], v[100:103], v[36:39], v[120:123]
    ds_read_b64_tr_b16 v[80:81], v18 offset:33856
    ds_read_b64_tr_b16 v[82:83], v18 offset:35136
    s_waitcnt lgkmcnt(8)
    v_mfma_f32_16x16x32_bf16 v[124:127], v[104:107], v[36:39], v[124:127]
    ds_read_b64_tr_b16 v[84:85], v18 offset:33888
    ds_read_b64_tr_b16 v[86:87], v18 offset:35168
    s_waitcnt lgkmcnt(8)
    v_mfma_f32_16x16x32_bf16 v[128:131], v[108:111], v[36:39], v[128:131]
    ds_read_b64_tr_b16 v[88:89], v18 offset:33920
    ds_read_b64_tr_b16 v[90:91], v18 offset:35200
    s_waitcnt vmcnt(9)
    s_waitcnt lgkmcnt(8)
    v_mfma_f32_16x16x32_bf16 v[112:115], v[72:75], v[40:43], v[112:115]
    ds_read_b64_tr_b16 v[92:93], v18 offset:38912
    ds_read_b64_tr_b16 v[94:95], v18 offset:40192
    s_add_u32 s33, s38, 38912
    buffer_load_dwordx4 v[32:35], v13, s[44:47], s33 offen sc1
    s_waitcnt lgkmcnt(8)
    v_mfma_f32_16x16x32_bf16 v[116:119], v[76:79], v[40:43], v[116:119]
    ds_read_b64_tr_b16 v[96:97], v18 offset:38944
    ds_read_b64_tr_b16 v[98:99], v18 offset:40224
    s_waitcnt lgkmcnt(8)
    v_mfma_f32_16x16x32_bf16 v[120:123], v[80:83], v[40:43], v[120:123]
    ds_read_b64_tr_b16 v[100:101], v18 offset:38976
    ds_read_b64_tr_b16 v[102:103], v18 offset:40256
    s_waitcnt lgkmcnt(8)
    v_mfma_f32_16x16x32_bf16 v[124:127], v[84:87], v[40:43], v[124:127]
    ds_read_b64_tr_b16 v[104:105], v18 offset:39008
    ds_read_b64_tr_b16 v[106:107], v18 offset:40288
    s_waitcnt lgkmcnt(8)
    v_mfma_f32_16x16x32_bf16 v[128:131], v[88:91], v[40:43], v[128:131]
    ds_read_b64_tr_b16 v[108:109], v18 offset:39040
    ds_read_b64_tr_b16 v[110:111], v18 offset:40320
    s_waitcnt vmcnt(9)
    s_waitcnt lgkmcnt(8)
    v_mfma_f32_16x16x32_bf16 v[112:115], v[92:95], v[44:47], v[112:115]
    s_barrier
    ds_read_b64_tr_b16 v[72:73], v18 offset:44032
    ds_read_b64_tr_b16 v[74:75], v18 offset:45312
    s_add_u32 s33, s38, 39936
    buffer_load_dwordx4 v[36:39], v13, s[44:47], s33 offen sc1
    s_waitcnt lgkmcnt(8)
    v_mfma_f32_16x16x32_bf16 v[116:119], v[96:99], v[44:47], v[116:119]
    ds_read_b64_tr_b16 v[76:77], v18 offset:44064
    ds_read_b64_tr_b16 v[78:79], v18 offset:45344
    s_waitcnt lgkmcnt(8)
    v_mfma_f32_16x16x32_bf16 v[120:123], v[100:103], v[44:47], v[120:123]
    ds_read_b64_tr_b16 v[80:81], v18 offset:44096
    ds_read_b64_tr_b16 v[82:83], v18 offset:45376
    s_waitcnt lgkmcnt(8)
    v_mfma_f32_16x16x32_bf16 v[124:127], v[104:107], v[44:47], v[124:127]
    ds_read_b64_tr_b16 v[84:85], v18 offset:44128
    ds_read_b64_tr_b16 v[86:87], v18 offset:45408
    s_waitcnt lgkmcnt(8)
    v_mfma_f32_16x16x32_bf16 v[128:131], v[108:111], v[44:47], v[128:131]
    ds_read_b64_tr_b16 v[88:89], v18 offset:44160
    ds_read_b64_tr_b16 v[90:91], v18 offset:45440
    s_waitcnt vmcnt(9)
    s_waitcnt lgkmcnt(8)
    v_mfma_f32_16x16x32_bf16 v[112:115], v[72:75], v[48:51], v[112:115]
    ds_read_b64_tr_b16 v[92:93], v18 offset:49152
    ds_read_b64_tr_b16 v[94:95], v18 offset:50432
    s_add_u32 s33, s38, 40960
    buffer_load_dwordx4 v[40:43], v13, s[44:47], s33 offen sc1
    s_waitcnt lgkmcnt(8)
    v_mfma_f32_16x16x32_bf16 v[116:119], v[76:79], v[48:51], v[116:119]
    ds_read_b64_tr_b16 v[96:97], v18 offset:49184
    ds_read_b64_tr_b16 v[98:99], v18 offset:50464
    s_waitcnt lgkmcnt(8)
    v_mfma_f32_16x16x32_bf16 v[120:123], v[80:83], v[48:51], v[120:123]
    ds_read_b64_tr_b16 v[100:101], v18 offset:49216
    ds_read_b64_tr_b16 v[102:103], v18 offset:50496
    s_waitcnt lgkmcnt(8)
    v_mfma_f32_16x16x32_bf16 v[124:127], v[84:87], v[48:51], v[124:127]
    ds_read_b64_tr_b16 v[104:105], v18 offset:49248
    ds_read_b64_tr_b16 v[106:107], v18 offset:50528
    s_waitcnt lgkmcnt(8)
    v_mfma_f32_16x16x32_bf16 v[128:131], v[88:91], v[48:51], v[128:131]
    ds_read_b64_tr_b16 v[108:109], v18 offset:49280
    ds_read_b64_tr_b16 v[110:111], v18 offset:50560
    s_waitcnt vmcnt(9)
    s_waitcnt lgkmcnt(8)
    v_mfma_f32_16x16x32_bf16 v[112:115], v[92:95], v[52:55], v[112:115]
    ds_read_b64_tr_b16 v[72:73], v18 offset:54272
    ds_read_b64_tr_b16 v[74:75], v18 offset:55552
    s_add_u32 s33, s38, 41984
    buffer_load_dwordx4 v[44:47], v13, s[44:47], s33 offen sc1
    s_waitcnt lgkmcnt(8)
    v_mfma_f32_16x16x32_bf16 v[116:119], v[96:99], v[52:55], v[116:119]
    ds_read_b64_tr_b16 v[76:77], v18 offset:54304
    ds_read_b64_tr_b16 v[78:79], v18 offset:55584
    s_waitcnt lgkmcnt(8)
    v_mfma_f32_16x16x32_bf16 v[120:123], v[100:103], v[52:55], v[120:123]
    ds_read_b64_tr_b16 v[80:81], v18 offset:54336
    ds_read_b64_tr_b16 v[82:83], v18 offset:55616
    s_waitcnt lgkmcnt(8)
    v_mfma_f32_16x16x32_bf16 v[124:127], v[104:107], v[52:55], v[124:127]
    ds_read_b64_tr_b16 v[84:85], v18 offset:54368
    ds_read_b64_tr_b16 v[86:87], v18 offset:55648
    s_waitcnt lgkmcnt(8)
    v_mfma_f32_16x16x32_bf16 v[128:131], v[108:111], v[52:55], v[128:131]
    ds_read_b64_tr_b16 v[88:89], v18 offset:54400
    ds_read_b64_tr_b16 v[90:91], v18 offset:55680
    s_waitcnt vmcnt(9)
    s_waitcnt lgkmcnt(8)
    v_mfma_f32_16x16x32_bf16 v[112:115], v[72:75], v[56:59], v[112:115]
    s_barrier
    ds_read_b64_tr_b16 v[92:93], v18 offset:59392
    ds_read_b64_tr_b16 v[94:95], v18 offset:60672
    s_add_u32 s33, s38, 43008
    buffer_load_dwordx4 v[48:51], v13, s[44:47], s33 offen sc1
    s_waitcnt lgkmcnt(8)
    v_mfma_f32_16x16x32_bf16 v[116:119], v[76:79], v[56:59], v[116:119]
    ds_read_b64_tr_b16 v[96:97], v18 offset:59424
    ds_read_b64_tr_b16 v[98:99], v18 offset:60704
    s_waitcnt lgkmcnt(8)
    v_mfma_f32_16x16x32_bf16 v[120:123], v[80:83], v[56:59], v[120:123]
    ds_read_b64_tr_b16 v[100:101], v18 offset:59456
    ds_read_b64_tr_b16 v[102:103], v18 offset:60736
    s_waitcnt lgkmcnt(8)
    v_mfma_f32_16x16x32_bf16 v[124:127], v[84:87], v[56:59], v[124:127]
    ds_read_b64_tr_b16 v[104:105], v18 offset:59488
    ds_read_b64_tr_b16 v[106:107], v18 offset:60768
    s_waitcnt lgkmcnt(8)
    v_mfma_f32_16x16x32_bf16 v[128:131], v[88:91], v[56:59], v[128:131]
    ds_read_b64_tr_b16 v[108:109], v18 offset:59520
    ds_read_b64_tr_b16 v[110:111], v18 offset:60800
    s_waitcnt vmcnt(9)
    s_waitcnt lgkmcnt(8)
    v_mfma_f32_16x16x32_bf16 v[112:115], v[92:95], v[60:63], v[112:115]
    ds_read_b64_tr_b16 v[72:73], v18 offset:64512
    ds_read_b64_tr_b16 v[74:75], v19 offset:256
    s_add_u32 s33, s38, 44032
    buffer_load_dwordx4 v[52:55], v13, s[44:47], s33 offen sc1
    s_waitcnt lgkmcnt(8)
    v_mfma_f32_16x16x32_bf16 v[116:119], v[96:99], v[60:63], v[116:119]
    ds_read_b64_tr_b16 v[76:77], v18 offset:64544
    ds_read_b64_tr_b16 v[78:79], v19 offset:288
    s_waitcnt lgkmcnt(8)
    v_mfma_f32_16x16x32_bf16 v[120:123], v[100:103], v[60:63], v[120:123]
    ds_read_b64_tr_b16 v[80:81], v18 offset:64576
    ds_read_b64_tr_b16 v[82:83], v19 offset:320
    s_waitcnt lgkmcnt(8)
    v_mfma_f32_16x16x32_bf16 v[124:127], v[104:107], v[60:63], v[124:127]
    ds_read_b64_tr_b16 v[84:85], v18 offset:64608
    ds_read_b64_tr_b16 v[86:87], v19 offset:352
    s_waitcnt lgkmcnt(8)
    v_mfma_f32_16x16x32_bf16 v[128:131], v[108:111], v[60:63], v[128:131]
    ds_read_b64_tr_b16 v[88:89], v18 offset:64640
    ds_read_b64_tr_b16 v[90:91], v19 offset:384
    s_waitcnt vmcnt(9)
    s_waitcnt lgkmcnt(8)
    v_mfma_f32_16x16x32_bf16 v[112:115], v[72:75], v[64:67], v[112:115]
    ds_read_b64_tr_b16 v[92:93], v19 offset:4096
    ds_read_b64_tr_b16 v[94:95], v19 offset:5376
    s_add_u32 s33, s38, 45056
    buffer_load_dwordx4 v[56:59], v13, s[44:47], s33 offen sc1
    s_waitcnt lgkmcnt(8)
    v_mfma_f32_16x16x32_bf16 v[116:119], v[76:79], v[64:67], v[116:119]
    ds_read_b64_tr_b16 v[96:97], v19 offset:4128
    ds_read_b64_tr_b16 v[98:99], v19 offset:5408
    s_waitcnt lgkmcnt(8)
    v_mfma_f32_16x16x32_bf16 v[120:123], v[80:83], v[64:67], v[120:123]
    ds_read_b64_tr_b16 v[100:101], v19 offset:4160
    ds_read_b64_tr_b16 v[102:103], v19 offset:5440
    s_waitcnt lgkmcnt(8)
    v_mfma_f32_16x16x32_bf16 v[124:127], v[84:87], v[64:67], v[124:127]
    ds_read_b64_tr_b16 v[104:105], v19 offset:4192
    ds_read_b64_tr_b16 v[106:107], v19 offset:5472
    s_waitcnt lgkmcnt(8)
    v_mfma_f32_16x16x32_bf16 v[128:131], v[88:91], v[64:67], v[128:131]
    ds_read_b64_tr_b16 v[108:109], v19 offset:4224
    ds_read_b64_tr_b16 v[110:111], v19 offset:5504
    s_waitcnt vmcnt(9)
    s_waitcnt lgkmcnt(8)
    v_mfma_f32_16x16x32_bf16 v[112:115], v[92:95], v[68:71], v[112:115]
    s_barrier
    ds_read_b64_tr_b16 v[72:73], v19 offset:9216
    ds_read_b64_tr_b16 v[74:75], v19 offset:10496
    s_add_u32 s33, s38, 46080
    buffer_load_dwordx4 v[60:63], v13, s[44:47], s33 offen sc1
    s_waitcnt lgkmcnt(8)
    v_mfma_f32_16x16x32_bf16 v[116:119], v[96:99], v[68:71], v[116:119]
    ds_read_b64_tr_b16 v[76:77], v19 offset:9248
    ds_read_b64_tr_b16 v[78:79], v19 offset:10528
    s_waitcnt lgkmcnt(8)
    v_mfma_f32_16x16x32_bf16 v[120:123], v[100:103], v[68:71], v[120:123]
    ds_read_b64_tr_b16 v[80:81], v19 offset:9280
    ds_read_b64_tr_b16 v[82:83], v19 offset:10560
    s_waitcnt lgkmcnt(8)
    v_mfma_f32_16x16x32_bf16 v[124:127], v[104:107], v[68:71], v[124:127]
    ds_read_b64_tr_b16 v[84:85], v19 offset:9312
    ds_read_b64_tr_b16 v[86:87], v19 offset:10592
    s_waitcnt lgkmcnt(8)
    v_mfma_f32_16x16x32_bf16 v[128:131], v[108:111], v[68:71], v[128:131]
    ds_read_b64_tr_b16 v[88:89], v19 offset:9344
    ds_read_b64_tr_b16 v[90:91], v19 offset:10624
    s_waitcnt vmcnt(9)
    s_waitcnt lgkmcnt(8)
    v_mfma_f32_16x16x32_bf16 v[112:115], v[72:75], v[24:27], v[112:115]
    ds_read_b64_tr_b16 v[92:93], v19 offset:14336
    ds_read_b64_tr_b16 v[94:95], v19 offset:15616
    s_add_u32 s33, s38, 47104
    buffer_load_dwordx4 v[64:67], v13, s[44:47], s33 offen sc1
    s_waitcnt lgkmcnt(8)
    v_mfma_f32_16x16x32_bf16 v[116:119], v[76:79], v[24:27], v[116:119]
    ds_read_b64_tr_b16 v[96:97], v19 offset:14368
    ds_read_b64_tr_b16 v[98:99], v19 offset:15648
    s_waitcnt lgkmcnt(8)
    v_mfma_f32_16x16x32_bf16 v[120:123], v[80:83], v[24:27], v[120:123]
    ds_read_b64_tr_b16 v[100:101], v19 offset:14400
    ds_read_b64_tr_b16 v[102:103], v19 offset:15680
    s_waitcnt lgkmcnt(8)
    v_mfma_f32_16x16x32_bf16 v[124:127], v[84:87], v[24:27], v[124:127]
    ds_read_b64_tr_b16 v[104:105], v19 offset:14432
    ds_read_b64_tr_b16 v[106:107], v19 offset:15712
    s_waitcnt lgkmcnt(8)
    v_mfma_f32_16x16x32_bf16 v[128:131], v[88:91], v[24:27], v[128:131]
    ds_read_b64_tr_b16 v[108:109], v19 offset:14464
    ds_read_b64_tr_b16 v[110:111], v19 offset:15744
    s_waitcnt vmcnt(9)
    s_waitcnt lgkmcnt(8)
    v_mfma_f32_16x16x32_bf16 v[112:115], v[92:95], v[28:31], v[112:115]
    ds_read_b64_tr_b16 v[72:73], v19 offset:19456
    ds_read_b64_tr_b16 v[74:75], v19 offset:20736
    s_add_u32 s33, s38, 48128
    buffer_load_dwordx4 v[68:71], v13, s[44:47], s33 offen sc1
    s_waitcnt lgkmcnt(8)
    v_mfma_f32_16x16x32_bf16 v[116:119], v[96:99], v[28:31], v[116:119]
    ds_read_b64_tr_b16 v[76:77], v19 offset:19488
    ds_read_b64_tr_b16 v[78:79], v19 offset:20768
    s_waitcnt lgkmcnt(8)
    v_mfma_f32_16x16x32_bf16 v[120:123], v[100:103], v[28:31], v[120:123]
    ds_read_b64_tr_b16 v[80:81], v19 offset:19520
    ds_read_b64_tr_b16 v[82:83], v19 offset:20800
    s_waitcnt lgkmcnt(8)
    v_mfma_f32_16x16x32_bf16 v[124:127], v[104:107], v[28:31], v[124:127]
    ds_read_b64_tr_b16 v[84:85], v19 offset:19552
    ds_read_b64_tr_b16 v[86:87], v19 offset:20832
    s_waitcnt lgkmcnt(8)
    v_mfma_f32_16x16x32_bf16 v[128:131], v[108:111], v[28:31], v[128:131]
    ds_read_b64_tr_b16 v[88:89], v19 offset:19584
    ds_read_b64_tr_b16 v[90:91], v19 offset:20864
    s_waitcnt vmcnt(9)
    s_waitcnt lgkmcnt(8)
    v_mfma_f32_16x16x32_bf16 v[112:115], v[72:75], v[32:35], v[112:115]
    s_barrier
    ds_read_b64_tr_b16 v[92:93], v17 offset:0
    ds_read_b64_tr_b16 v[94:95], v17 offset:1280
    s_add_u32 s33, s38, 49152
    buffer_load_dwordx4 v[24:27], v13, s[44:47], s33 offen sc1
    s_waitcnt lgkmcnt(8)
    v_mfma_f32_16x16x32_bf16 v[116:119], v[76:79], v[32:35], v[116:119]
    ds_read_b64_tr_b16 v[96:97], v17 offset:32
    ds_read_b64_tr_b16 v[98:99], v17 offset:1312
    s_waitcnt lgkmcnt(8)
    v_mfma_f32_16x16x32_bf16 v[120:123], v[80:83], v[32:35], v[120:123]
    ds_read_b64_tr_b16 v[100:101], v17 offset:64
    ds_read_b64_tr_b16 v[102:103], v17 offset:1344
    s_waitcnt lgkmcnt(8)
    v_mfma_f32_16x16x32_bf16 v[124:127], v[84:87], v[32:35], v[124:127]
    ds_read_b64_tr_b16 v[104:105], v17 offset:96
    ds_read_b64_tr_b16 v[106:107], v17 offset:1376
    s_waitcnt lgkmcnt(8)
    v_mfma_f32_16x16x32_bf16 v[128:131], v[88:91], v[32:35], v[128:131]
    ds_read_b64_tr_b16 v[108:109], v17 offset:128
    ds_read_b64_tr_b16 v[110:111], v17 offset:1408
    s_waitcnt vmcnt(9)
    s_waitcnt lgkmcnt(8)
    v_mfma_f32_16x16x32_bf16 v[112:115], v[92:95], v[36:39], v[112:115]
    ds_read_b64_tr_b16 v[72:73], v17 offset:5120
    ds_read_b64_tr_b16 v[74:75], v17 offset:6400
    s_add_u32 s33, s38, 50176
    buffer_load_dwordx4 v[28:31], v13, s[44:47], s33 offen sc1
    s_waitcnt lgkmcnt(8)
    v_mfma_f32_16x16x32_bf16 v[116:119], v[96:99], v[36:39], v[116:119]
    ds_read_b64_tr_b16 v[76:77], v17 offset:5152
    ds_read_b64_tr_b16 v[78:79], v17 offset:6432
    s_waitcnt lgkmcnt(8)
    v_mfma_f32_16x16x32_bf16 v[120:123], v[100:103], v[36:39], v[120:123]
    ds_read_b64_tr_b16 v[80:81], v17 offset:5184
    ds_read_b64_tr_b16 v[82:83], v17 offset:6464
    s_waitcnt lgkmcnt(8)
    v_mfma_f32_16x16x32_bf16 v[124:127], v[104:107], v[36:39], v[124:127]
    ds_read_b64_tr_b16 v[84:85], v17 offset:5216
    ds_read_b64_tr_b16 v[86:87], v17 offset:6496
    s_waitcnt lgkmcnt(8)
    v_mfma_f32_16x16x32_bf16 v[128:131], v[108:111], v[36:39], v[128:131]
    ds_read_b64_tr_b16 v[88:89], v17 offset:5248
    ds_read_b64_tr_b16 v[90:91], v17 offset:6528
    s_waitcnt vmcnt(9)
    s_waitcnt lgkmcnt(8)
    v_mfma_f32_16x16x32_bf16 v[112:115], v[72:75], v[40:43], v[112:115]
    ds_read_b64_tr_b16 v[92:93], v17 offset:10240
    ds_read_b64_tr_b16 v[94:95], v17 offset:11520
    s_add_u32 s33, s38, 51200
    buffer_load_dwordx4 v[32:35], v13, s[44:47], s33 offen sc1
    s_waitcnt lgkmcnt(8)
    v_mfma_f32_16x16x32_bf16 v[116:119], v[76:79], v[40:43], v[116:119]
    ds_read_b64_tr_b16 v[96:97], v17 offset:10272
    ds_read_b64_tr_b16 v[98:99], v17 offset:11552
    s_waitcnt lgkmcnt(8)
    v_mfma_f32_16x16x32_bf16 v[120:123], v[80:83], v[40:43], v[120:123]
    ds_read_b64_tr_b16 v[100:101], v17 offset:10304
    ds_read_b64_tr_b16 v[102:103], v17 offset:11584
    s_waitcnt lgkmcnt(8)
    v_mfma_f32_16x16x32_bf16 v[124:127], v[84:87], v[40:43], v[124:127]
    ds_read_b64_tr_b16 v[104:105], v17 offset:10336
    ds_read_b64_tr_b16 v[106:107], v17 offset:11616
    s_waitcnt lgkmcnt(8)
    v_mfma_f32_16x16x32_bf16 v[128:131], v[88:91], v[40:43], v[128:131]
    ds_read_b64_tr_b16 v[108:109], v17 offset:10368
    ds_read_b64_tr_b16 v[110:111], v17 offset:11648
    s_waitcnt vmcnt(9)
    s_waitcnt lgkmcnt(8)
    v_mfma_f32_16x16x32_bf16 v[112:115], v[92:95], v[44:47], v[112:115]
    s_barrier
    ds_read_b64_tr_b16 v[72:73], v17 offset:15360
    ds_read_b64_tr_b16 v[74:75], v17 offset:16640
    s_add_u32 s33, s38, 52224
    buffer_load_dwordx4 v[36:39], v13, s[44:47], s33 offen sc1
    s_waitcnt lgkmcnt(8)
    v_mfma_f32_16x16x32_bf16 v[116:119], v[96:99], v[44:47], v[116:119]
    ds_read_b64_tr_b16 v[76:77], v17 offset:15392
    ds_read_b64_tr_b16 v[78:79], v17 offset:16672
    s_waitcnt lgkmcnt(8)
    v_mfma_f32_16x16x32_bf16 v[120:123], v[100:103], v[44:47], v[120:123]
    ds_read_b64_tr_b16 v[80:81], v17 offset:15424
    ds_read_b64_tr_b16 v[82:83], v17 offset:16704
    s_waitcnt lgkmcnt(8)
    v_mfma_f32_16x16x32_bf16 v[124:127], v[104:107], v[44:47], v[124:127]
    ds_read_b64_tr_b16 v[84:85], v17 offset:15456
    ds_read_b64_tr_b16 v[86:87], v17 offset:16736
    s_waitcnt lgkmcnt(8)
    v_mfma_f32_16x16x32_bf16 v[128:131], v[108:111], v[44:47], v[128:131]
    ds_read_b64_tr_b16 v[88:89], v17 offset:15488
    ds_read_b64_tr_b16 v[90:91], v17 offset:16768
    s_waitcnt vmcnt(9)
    s_waitcnt lgkmcnt(8)
    v_mfma_f32_16x16x32_bf16 v[112:115], v[72:75], v[48:51], v[112:115]
    ds_read_b64_tr_b16 v[92:93], v17 offset:20480
    ds_read_b64_tr_b16 v[94:95], v17 offset:21760
    s_add_u32 s33, s38, 53248
    buffer_load_dwordx4 v[40:43], v13, s[44:47], s33 offen sc1
    s_waitcnt lgkmcnt(8)
    v_mfma_f32_16x16x32_bf16 v[116:119], v[76:79], v[48:51], v[116:119]
    ds_read_b64_tr_b16 v[96:97], v17 offset:20512
    ds_read_b64_tr_b16 v[98:99], v17 offset:21792
    s_waitcnt lgkmcnt(8)
    v_mfma_f32_16x16x32_bf16 v[120:123], v[80:83], v[48:51], v[120:123]
    ds_read_b64_tr_b16 v[100:101], v17 offset:20544
    ds_read_b64_tr_b16 v[102:103], v17 offset:21824
    s_waitcnt lgkmcnt(8)
    v_mfma_f32_16x16x32_bf16 v[124:127], v[84:87], v[48:51], v[124:127]
    ds_read_b64_tr_b16 v[104:105], v17 offset:20576
    ds_read_b64_tr_b16 v[106:107], v17 offset:21856
    s_waitcnt lgkmcnt(8)
    v_mfma_f32_16x16x32_bf16 v[128:131], v[88:91], v[48:51], v[128:131]
    ds_read_b64_tr_b16 v[108:109], v17 offset:20608
    ds_read_b64_tr_b16 v[110:111], v17 offset:21888
    s_waitcnt vmcnt(9)
    s_waitcnt lgkmcnt(8)
    v_mfma_f32_16x16x32_bf16 v[112:115], v[92:95], v[52:55], v[112:115]
    ds_read_b64_tr_b16 v[72:73], v17 offset:25600
    ds_read_b64_tr_b16 v[74:75], v17 offset:26880
    s_add_u32 s33, s38, 54272
    buffer_load_dwordx4 v[44:47], v13, s[44:47], s33 offen sc1
    s_waitcnt lgkmcnt(8)
    v_mfma_f32_16x16x32_bf16 v[116:119], v[96:99], v[52:55], v[116:119]
    ds_read_b64_tr_b16 v[76:77], v17 offset:25632
    ds_read_b64_tr_b16 v[78:79], v17 offset:26912
    s_waitcnt lgkmcnt(8)
    v_mfma_f32_16x16x32_bf16 v[120:123], v[100:103], v[52:55], v[120:123]
    ds_read_b64_tr_b16 v[80:81], v17 offset:25664
    ds_read_b64_tr_b16 v[82:83], v17 offset:26944
    s_waitcnt lgkmcnt(8)
    v_mfma_f32_16x16x32_bf16 v[124:127], v[104:107], v[52:55], v[124:127]
    ds_read_b64_tr_b16 v[84:85], v17 offset:25696
    ds_read_b64_tr_b16 v[86:87], v17 offset:26976
    s_waitcnt lgkmcnt(8)
    v_mfma_f32_16x16x32_bf16 v[128:131], v[108:111], v[52:55], v[128:131]
    ds_read_b64_tr_b16 v[88:89], v17 offset:25728
    ds_read_b64_tr_b16 v[90:91], v17 offset:27008
    s_waitcnt vmcnt(9)
    s_waitcnt lgkmcnt(8)
    v_mfma_f32_16x16x32_bf16 v[112:115], v[72:75], v[56:59], v[112:115]
    s_barrier
    ds_read_b64_tr_b16 v[92:93], v17 offset:45056
    ds_read_b64_tr_b16 v[94:95], v17 offset:46336
    s_waitcnt lgkmcnt(8)
    v_mfma_f32_16x16x32_bf16 v[116:119], v[76:79], v[56:59], v[116:119]
    ds_read_b64_tr_b16 v[96:97], v17 offset:45088
    ds_read_b64_tr_b16 v[98:99], v17 offset:46368
    s_waitcnt lgkmcnt(8)
    v_mfma_f32_16x16x32_bf16 v[120:123], v[80:83], v[56:59], v[120:123]
    ds_read_b64_tr_b16 v[100:101], v17 offset:45120
    ds_read_b64_tr_b16 v[102:103], v17 offset:46400
    s_waitcnt lgkmcnt(8)
    v_mfma_f32_16x16x32_bf16 v[124:127], v[84:87], v[56:59], v[124:127]
    ds_read_b64_tr_b16 v[104:105], v17 offset:45152
    ds_read_b64_tr_b16 v[106:107], v17 offset:46432
    s_waitcnt lgkmcnt(8)
    v_mfma_f32_16x16x32_bf16 v[128:131], v[88:91], v[56:59], v[128:131]
    ds_read_b64_tr_b16 v[108:109], v17 offset:45184
    ds_read_b64_tr_b16 v[110:111], v17 offset:46464
    s_waitcnt vmcnt(8)
    s_waitcnt lgkmcnt(8)
    v_mfma_f32_16x16x32_bf16 v[112:115], v[92:95], v[60:63], v[112:115]
    ds_read_b64_tr_b16 v[72:73], v17 offset:50176
    ds_read_b64_tr_b16 v[74:75], v17 offset:51456
    s_waitcnt lgkmcnt(8)
    v_mfma_f32_16x16x32_bf16 v[116:119], v[96:99], v[60:63], v[116:119]
    ds_read_b64_tr_b16 v[76:77], v17 offset:50208
    ds_read_b64_tr_b16 v[78:79], v17 offset:51488
    s_waitcnt lgkmcnt(8)
    v_mfma_f32_16x16x32_bf16 v[120:123], v[100:103], v[60:63], v[120:123]
    ds_read_b64_tr_b16 v[80:81], v17 offset:50240
    ds_read_b64_tr_b16 v[82:83], v17 offset:51520
    s_waitcnt lgkmcnt(8)
    v_mfma_f32_16x16x32_bf16 v[124:127], v[104:107], v[60:63], v[124:127]
    ds_read_b64_tr_b16 v[84:85], v17 offset:50272
    ds_read_b64_tr_b16 v[86:87], v17 offset:51552
    s_waitcnt lgkmcnt(8)
    v_mfma_f32_16x16x32_bf16 v[128:131], v[108:111], v[60:63], v[128:131]
    ds_read_b64_tr_b16 v[88:89], v17 offset:50304
    ds_read_b64_tr_b16 v[90:91], v17 offset:51584
    s_waitcnt vmcnt(7)
    s_waitcnt lgkmcnt(8)
    v_mfma_f32_16x16x32_bf16 v[112:115], v[72:75], v[64:67], v[112:115]
    ds_read_b64_tr_b16 v[92:93], v17 offset:55296
    ds_read_b64_tr_b16 v[94:95], v17 offset:56576
    s_waitcnt lgkmcnt(8)
    v_mfma_f32_16x16x32_bf16 v[116:119], v[76:79], v[64:67], v[116:119]
    ds_read_b64_tr_b16 v[96:97], v17 offset:55328
    ds_read_b64_tr_b16 v[98:99], v17 offset:56608
    s_waitcnt lgkmcnt(8)
    v_mfma_f32_16x16x32_bf16 v[120:123], v[80:83], v[64:67], v[120:123]
    ds_read_b64_tr_b16 v[100:101], v17 offset:55360
    ds_read_b64_tr_b16 v[102:103], v17 offset:56640
    s_waitcnt lgkmcnt(8)
    v_mfma_f32_16x16x32_bf16 v[124:127], v[84:87], v[64:67], v[124:127]
    ds_read_b64_tr_b16 v[104:105], v17 offset:55392
    ds_read_b64_tr_b16 v[106:107], v17 offset:56672
    s_waitcnt lgkmcnt(8)
    v_mfma_f32_16x16x32_bf16 v[128:131], v[88:91], v[64:67], v[128:131]
    ds_read_b64_tr_b16 v[108:109], v17 offset:55424
    ds_read_b64_tr_b16 v[110:111], v17 offset:56704
    s_waitcnt vmcnt(6)
    s_waitcnt lgkmcnt(8)
    v_mfma_f32_16x16x32_bf16 v[112:115], v[92:95], v[68:71], v[112:115]
    s_barrier
    ds_read_b64_tr_b16 v[72:73], v17 offset:60416
    ds_read_b64_tr_b16 v[74:75], v17 offset:61696
    s_waitcnt lgkmcnt(8)
    v_mfma_f32_16x16x32_bf16 v[116:119], v[96:99], v[68:71], v[116:119]
    ds_read_b64_tr_b16 v[76:77], v17 offset:60448
    ds_read_b64_tr_b16 v[78:79], v17 offset:61728
    s_waitcnt lgkmcnt(8)
    v_mfma_f32_16x16x32_bf16 v[120:123], v[100:103], v[68:71], v[120:123]
    ds_read_b64_tr_b16 v[80:81], v17 offset:60480
    ds_read_b64_tr_b16 v[82:83], v17 offset:61760
    s_waitcnt lgkmcnt(8)
    v_mfma_f32_16x16x32_bf16 v[124:127], v[104:107], v[68:71], v[124:127]
    ds_read_b64_tr_b16 v[84:85], v17 offset:60512
    ds_read_b64_tr_b16 v[86:87], v17 offset:61792
    s_waitcnt lgkmcnt(8)
    v_mfma_f32_16x16x32_bf16 v[128:131], v[108:111], v[68:71], v[128:131]
    ds_read_b64_tr_b16 v[88:89], v17 offset:60544
    ds_read_b64_tr_b16 v[90:91], v17 offset:61824
    s_waitcnt vmcnt(5)
    s_waitcnt lgkmcnt(8)
    v_mfma_f32_16x16x32_bf16 v[112:115], v[72:75], v[24:27], v[112:115]
    ds_read_b64_tr_b16 v[92:93], v18 offset:0
    ds_read_b64_tr_b16 v[94:95], v18 offset:1280
    s_waitcnt lgkmcnt(8)
    v_mfma_f32_16x16x32_bf16 v[116:119], v[76:79], v[24:27], v[116:119]
    ds_read_b64_tr_b16 v[96:97], v18 offset:32
    ds_read_b64_tr_b16 v[98:99], v18 offset:1312
    s_waitcnt lgkmcnt(8)
    v_mfma_f32_16x16x32_bf16 v[120:123], v[80:83], v[24:27], v[120:123]
    ds_read_b64_tr_b16 v[100:101], v18 offset:64
    ds_read_b64_tr_b16 v[102:103], v18 offset:1344
    s_waitcnt lgkmcnt(8)
    v_mfma_f32_16x16x32_bf16 v[124:127], v[84:87], v[24:27], v[124:127]
    ds_read_b64_tr_b16 v[104:105], v18 offset:96
    ds_read_b64_tr_b16 v[106:107], v18 offset:1376
    s_waitcnt lgkmcnt(8)
    v_mfma_f32_16x16x32_bf16 v[128:131], v[88:91], v[24:27], v[128:131]
    ds_read_b64_tr_b16 v[108:109], v18 offset:128
    ds_read_b64_tr_b16 v[110:111], v18 offset:1408
    s_waitcnt vmcnt(4)
    s_waitcnt lgkmcnt(8)
    v_mfma_f32_16x16x32_bf16 v[112:115], v[92:95], v[28:31], v[112:115]
    ds_read_b64_tr_b16 v[72:73], v18 offset:5120
    ds_read_b64_tr_b16 v[74:75], v18 offset:6400
    s_waitcnt lgkmcnt(8)
    v_mfma_f32_16x16x32_bf16 v[116:119], v[96:99], v[28:31], v[116:119]
    ds_read_b64_tr_b16 v[76:77], v18 offset:5152
    ds_read_b64_tr_b16 v[78:79], v18 offset:6432
    s_waitcnt lgkmcnt(8)
    v_mfma_f32_16x16x32_bf16 v[120:123], v[100:103], v[28:31], v[120:123]
    ds_read_b64_tr_b16 v[80:81], v18 offset:5184
    ds_read_b64_tr_b16 v[82:83], v18 offset:6464
    s_waitcnt lgkmcnt(8)
    v_mfma_f32_16x16x32_bf16 v[124:127], v[104:107], v[28:31], v[124:127]
    ds_read_b64_tr_b16 v[84:85], v18 offset:5216
    ds_read_b64_tr_b16 v[86:87], v18 offset:6496
    s_waitcnt lgkmcnt(8)
    v_mfma_f32_16x16x32_bf16 v[128:131], v[108:111], v[28:31], v[128:131]
    ds_read_b64_tr_b16 v[88:89], v18 offset:5248
    ds_read_b64_tr_b16 v[90:91], v18 offset:6528
    s_waitcnt vmcnt(3)
    s_waitcnt lgkmcnt(8)
    v_mfma_f32_16x16x32_bf16 v[112:115], v[72:75], v[32:35], v[112:115]
    s_barrier
    ds_read_b64_tr_b16 v[92:93], v18 offset:10240
    ds_read_b64_tr_b16 v[94:95], v18 offset:11520
    s_waitcnt lgkmcnt(8)
    v_mfma_f32_16x16x32_bf16 v[116:119], v[76:79], v[32:35], v[116:119]
    ds_read_b64_tr_b16 v[96:97], v18 offset:10272
    ds_read_b64_tr_b16 v[98:99], v18 offset:11552
    s_waitcnt lgkmcnt(8)
    v_mfma_f32_16x16x32_bf16 v[120:123], v[80:83], v[32:35], v[120:123]
    ds_read_b64_tr_b16 v[100:101], v18 offset:10304
    ds_read_b64_tr_b16 v[102:103], v18 offset:11584
    s_waitcnt lgkmcnt(8)
    v_mfma_f32_16x16x32_bf16 v[124:127], v[84:87], v[32:35], v[124:127]
    ds_read_b64_tr_b16 v[104:105], v18 offset:10336
    ds_read_b64_tr_b16 v[106:107], v18 offset:11616
    s_waitcnt lgkmcnt(8)
    v_mfma_f32_16x16x32_bf16 v[128:131], v[88:91], v[32:35], v[128:131]
    ds_read_b64_tr_b16 v[108:109], v18 offset:10368
    ds_read_b64_tr_b16 v[110:111], v18 offset:11648
    s_waitcnt vmcnt(2)
    s_waitcnt lgkmcnt(8)
    v_mfma_f32_16x16x32_bf16 v[112:115], v[92:95], v[36:39], v[112:115]
    ds_read_b64_tr_b16 v[72:73], v18 offset:15360
    ds_read_b64_tr_b16 v[74:75], v18 offset:16640
    s_waitcnt lgkmcnt(8)
    v_mfma_f32_16x16x32_bf16 v[116:119], v[96:99], v[36:39], v[116:119]
    ds_read_b64_tr_b16 v[76:77], v18 offset:15392
    ds_read_b64_tr_b16 v[78:79], v18 offset:16672
    s_waitcnt lgkmcnt(8)
    v_mfma_f32_16x16x32_bf16 v[120:123], v[100:103], v[36:39], v[120:123]
    ds_read_b64_tr_b16 v[80:81], v18 offset:15424
    ds_read_b64_tr_b16 v[82:83], v18 offset:16704
    s_waitcnt lgkmcnt(8)
    v_mfma_f32_16x16x32_bf16 v[124:127], v[104:107], v[36:39], v[124:127]
    ds_read_b64_tr_b16 v[84:85], v18 offset:15456
    ds_read_b64_tr_b16 v[86:87], v18 offset:16736
    s_waitcnt lgkmcnt(8)
    v_mfma_f32_16x16x32_bf16 v[128:131], v[108:111], v[36:39], v[128:131]
    ds_read_b64_tr_b16 v[88:89], v18 offset:15488
    ds_read_b64_tr_b16 v[90:91], v18 offset:16768
    s_waitcnt vmcnt(1)
    s_waitcnt lgkmcnt(8)
    v_mfma_f32_16x16x32_bf16 v[112:115], v[72:75], v[40:43], v[112:115]
    ds_read_b64_tr_b16 v[92:93], v18 offset:20480
    ds_read_b64_tr_b16 v[94:95], v18 offset:21760
    s_waitcnt lgkmcnt(8)
    v_mfma_f32_16x16x32_bf16 v[116:119], v[76:79], v[40:43], v[116:119]
    ds_read_b64_tr_b16 v[96:97], v18 offset:20512
    ds_read_b64_tr_b16 v[98:99], v18 offset:21792
    s_waitcnt lgkmcnt(8)
    v_mfma_f32_16x16x32_bf16 v[120:123], v[80:83], v[40:43], v[120:123]
    ds_read_b64_tr_b16 v[100:101], v18 offset:20544
    ds_read_b64_tr_b16 v[102:103], v18 offset:21824
    s_waitcnt lgkmcnt(8)
    v_mfma_f32_16x16x32_bf16 v[124:127], v[84:87], v[40:43], v[124:127]
    ds_read_b64_tr_b16 v[104:105], v18 offset:20576
    ds_read_b64_tr_b16 v[106:107], v18 offset:21856
    s_waitcnt lgkmcnt(8)
    v_mfma_f32_16x16x32_bf16 v[128:131], v[88:91], v[40:43], v[128:131]
    ds_read_b64_tr_b16 v[108:109], v18 offset:20608
    ds_read_b64_tr_b16 v[110:111], v18 offset:21888
    s_waitcnt vmcnt(0)
    s_waitcnt lgkmcnt(8)
    v_mfma_f32_16x16x32_bf16 v[112:115], v[92:95], v[44:47], v[112:115]
    s_waitcnt lgkmcnt(6)
    v_mfma_f32_16x16x32_bf16 v[116:119], v[96:99], v[44:47], v[116:119]
    s_waitcnt lgkmcnt(4)
    v_mfma_f32_16x16x32_bf16 v[120:123], v[100:103], v[44:47], v[120:123]
    s_waitcnt lgkmcnt(2)
    v_mfma_f32_16x16x32_bf16 v[124:127], v[104:107], v[44:47], v[124:127]
    s_waitcnt lgkmcnt(0)
    v_mfma_f32_16x16x32_bf16 v[128:131], v[108:111], v[44:47], v[128:131]
    v_lshlrev_b32 v144, 16, v132
    v_and_b32 v145, 0xffff0000, v132
    v_lshlrev_b32 v146, 16, v133
    v_and_b32 v147, 0xffff0000, v133
    v_add_f32 v112, v112, v144
    v_add_f32 v113, v113, v145
    v_add_f32 v114, v114, v146
    v_add_f32 v115, v115, v147
    v_cvt_pk_bf16_f32 v112, v112, v113
    v_cvt_pk_bf16_f32 v113, v114, v115
    ds_write_b64 v21, v[112:113] offset:0
    v_lshlrev_b32 v144, 16, v134
    v_and_b32 v145, 0xffff0000, v134
    v_lshlrev_b32 v146, 16, v135
    v_and_b32 v147, 0xffff0000, v135
    v_add_f32 v116, v116, v144
    v_add_f32 v117, v117, v145
    v_add_f32 v118, v118, v146
    v_add_f32 v119, v119, v147
    v_cvt_pk_bf16_f32 v116, v116, v117
    v_cvt_pk_bf16_f32 v117, v118, v119
    ds_write_b64 v21, v[116:117] offset:32
    v_lshlrev_b32 v144, 16, v136
    v_and_b32 v145, 0xffff0000, v136
    v_lshlrev_b32 v146, 16, v137
    v_and_b32 v147, 0xffff0000, v137
    v_add_f32 v120, v120, v144
    v_add_f32 v121, v121, v145
    v_add_f32 v122, v122, v146
    v_add_f32 v123, v123, v147
    v_cvt_pk_bf16_f32 v120, v120, v121
    v_cvt_pk_bf16_f32 v121, v122, v123
    ds_write_b64 v21, v[120:121] offset:64
    v_lshlrev_b32 v144, 16, v138
    v_and_b32 v145, 0xffff0000, v138
    v_lshlrev_b32 v146, 16, v139
    v_and_b32 v147, 0xffff0000, v139
    v_add_f32 v124, v124, v144
    v_add_f32 v125, v125, v145
    v_add_f32 v126, v126, v146
    v_add_f32 v127, v127, v147
    v_cvt_pk_bf16_f32 v124, v124, v125
    v_cvt_pk_bf16_f32 v125, v126, v127
    ds_write_b64 v21, v[124:125] offset:96
    v_lshlrev_b32 v144, 16, v140
    v_and_b32 v145, 0xffff0000, v140
    v_lshlrev_b32 v146, 16, v141
    v_and_b32 v147, 0xffff0000, v141
    v_add_f32 v128, v128, v144
    v_add_f32 v129, v129, v145
    v_add_f32 v130, v130, v146
    v_add_f32 v131, v131, v147
    v_cvt_pk_bf16_f32 v128, v128, v129
    v_cvt_pk_bf16_f32 v129, v130, v131
    ds_write_b64 v21, v[128:129] offset:128
    s_waitcnt lgkmcnt(0)
    ds_read_b128 v[144:147], v22 offset:0
    ds_read_b128 v[148:151], v22 offset:1024
    s_mov_b32 exec_hi, 0
    ds_read_b128 v[152:155], v22 offset:2048
    s_mov_b64 exec, -1
    s_waitcnt lgkmcnt(2)
    buffer_store_dwordx4 v[144:147], v14, s[48:51], s42 offen
    s_waitcnt lgkmcnt(1)
    buffer_store_dwordx4 v[148:151], v15, s[48:51], s42 offen
    s_waitcnt lgkmcnt(0)
    s_mov_b32 exec_hi, 0
    buffer_store_dwordx4 v[152:155], v16, s[48:51], s42 offen
    s_mov_b64 exec, -1
    s_branch sequential_preLN__sliding_block__geglu_ffn__prompt_kernel_p5_join64
    s_nop 0
sequential_preLN__sliding_block__geglu_ffn__prompt_kernel_p5_r62:
    s_sub_u32 s78, s3, 4
    s_mul_i32 s77, s78, 3840
    s_and_b32 s76, s26, 7
    s_mul_i32 s76, s76, 276480
    s_add_u32 s76, s76, s77
    s_add_u32 s80, s22, 0x1488000
    s_addc_u32 s81, s23, 0
    s_and_b32 s81, s81, 0xffff
    s_mov_b32 s82, 0x21c000
    s_mov_b32 s83, 0x20000
    s_add_u32 m0, s77, 0
    s_add_u32 s33, s76, 61440
    buffer_load_dwordx4 v13, s[80:83], s33 offen sc1 lds
    s_add_u32 m0, s77, 1024
    s_add_u32 s33, s76, 62464
    buffer_load_dwordx4 v13, s[80:83], s33 offen sc1 lds
    s_add_u32 m0, s77, 2048
    s_add_u32 s33, s76, 63488
    buffer_load_dwordx4 v13, s[80:83], s33 offen sc1 lds
    s_add_u32 m0, s77, 3072
    s_add_u32 s33, s76, 64512
    s_mov_b32 exec_hi, 0xffff
    buffer_load_dwordx4 v13, s[80:83], s33 offen sc1 lds
    s_mov_b64 exec, -1
    s_add_u32 m0, s77, 15360
    s_add_u32 s33, s76, 76800
    buffer_load_dwordx4 v13, s[80:83], s33 offen sc1 lds
    s_add_u32 m0, s77, 16384
    s_add_u32 s33, s76, 77824
    buffer_load_dwordx4 v13, s[80:83], s33 offen sc1 lds
    s_add_u32 m0, s77, 17408
    s_add_u32 s33, s76, 78848
    buffer_load_dwordx4 v13, s[80:83], s33 offen sc1 lds
    s_add_u32 m0, s77, 18432
    s_add_u32 s33, s76, 79872
    s_mov_b32 exec_hi, 0xffff
    buffer_load_dwordx4 v13, s[80:83], s33 offen sc1 lds
    s_mov_b64 exec, -1
    s_add_u32 m0, s77, 45056
    s_add_u32 s33, s76, 92160
    buffer_load_dwordx4 v13, s[80:83], s33 offen sc1 lds
    s_add_u32 m0, s77, 46080
    s_add_u32 s33, s76, 93184
    buffer_load_dwordx4 v13, s[80:83], s33 offen sc1 lds
    s_add_u32 m0, s77, 47104
    s_add_u32 s33, s76, 94208
    buffer_load_dwordx4 v13, s[80:83], s33 offen sc1 lds
    s_add_u32 m0, s77, 48128
    s_add_u32 s33, s76, 95232
    s_mov_b32 exec_hi, 0xffff
    buffer_load_dwordx4 v13, s[80:83], s33 offen sc1 lds
    s_mov_b64 exec, -1
    s_add_u32 m0, s77, 60416
    s_add_u32 s33, s76, 107520
    buffer_load_dwordx4 v13, s[80:83], s33 offen sc1 lds
    s_add_u32 m0, s77, 61440
    s_add_u32 s33, s76, 108544
    buffer_load_dwordx4 v13, s[80:83], s33 offen sc1 lds
    s_add_u32 m0, s77, 62464
    s_add_u32 s33, s76, 109568
    buffer_load_dwordx4 v13, s[80:83], s33 offen sc1 lds
    s_add_u32 m0, s77, 63488
    s_add_u32 s33, s76, 110592
    s_mov_b32 exec_hi, 0xffff
    buffer_load_dwordx4 v13, s[80:83], s33 offen sc1 lds
    s_mov_b64 exec, -1
    s_add_u32 m0, s77, 75776
    s_add_u32 s33, s76, 122880
    buffer_load_dwordx4 v13, s[80:83], s33 offen sc1 lds
    s_add_u32 m0, s77, 76800
    s_add_u32 s33, s76, 123904
    buffer_load_dwordx4 v13, s[80:83], s33 offen sc1 lds
    s_add_u32 m0, s77, 77824
    s_add_u32 s33, s76, 124928
    buffer_load_dwordx4 v13, s[80:83], s33 offen sc1 lds
    s_add_u32 m0, s77, 78848
    s_add_u32 s33, s76, 125952
    s_mov_b32 exec_hi, 0xffff
    buffer_load_dwordx4 v13, s[80:83], s33 offen sc1 lds
    s_mov_b64 exec, -1
    s_barrier
    s_waitcnt vmcnt(16)
    s_barrier
    s_add_u32 m0, s77, 94208
    s_add_u32 s33, s76, 138240
    buffer_load_dwordx4 v13, s[80:83], s33 offen sc1 lds
    s_add_u32 m0, s77, 95232
    s_add_u32 s33, s76, 139264
    buffer_load_dwordx4 v13, s[80:83], s33 offen sc1 lds
    s_add_u32 m0, s77, 96256
    s_add_u32 s33, s76, 140288
    buffer_load_dwordx4 v13, s[80:83], s33 offen sc1 lds
    s_add_u32 m0, s77, 97280
    s_add_u32 s33, s76, 141312
    s_mov_b32 exec_hi, 0xffff
    buffer_load_dwordx4 v13, s[80:83], s33 offen sc1 lds
    s_mov_b64 exec, -1
    s_waitcnt vmcnt(16)
    s_barrier
    s_add_u32 m0, s77, 109568
    s_add_u32 s33, s76, 153600
    buffer_load_dwordx4 v13, s[80:83], s33 offen sc1 lds
    s_add_u32 m0, s77, 110592
    s_add_u32 s33, s76, 154624
    buffer_load_dwordx4 v13, s[80:83], s33 offen sc1 lds
    s_add_u32 m0, s77, 111616
    s_add_u32 s33, s76, 155648
    buffer_load_dwordx4 v13, s[80:83], s33 offen sc1 lds
    s_add_u32 m0, s77, 112640
    s_add_u32 s33, s76, 156672
    s_mov_b32 exec_hi, 0xffff
    buffer_load_dwordx4 v13, s[80:83], s33 offen sc1 lds
    s_mov_b64 exec, -1
    s_waitcnt vmcnt(16)
    s_barrier
    s_add_u32 m0, s77, 124928
    s_add_u32 s33, s76, 168960
    buffer_load_dwordx4 v13, s[80:83], s33 offen sc1 lds
    s_add_u32 m0, s77, 125952
    s_add_u32 s33, s76, 169984
    buffer_load_dwordx4 v13, s[80:83], s33 offen sc1 lds
    s_add_u32 m0, s77, 126976
    s_add_u32 s33, s76, 171008
    buffer_load_dwordx4 v13, s[80:83], s33 offen sc1 lds
    s_add_u32 m0, s77, 128000
    s_add_u32 s33, s76, 172032
    s_mov_b32 exec_hi, 0xffff
    buffer_load_dwordx4 v13, s[80:83], s33 offen sc1 lds
    s_mov_b64 exec, -1
    s_waitcnt vmcnt(16)
    s_barrier
    s_add_u32 m0, s77, 140288
    s_add_u32 s33, s76, 184320
    buffer_load_dwordx4 v13, s[80:83], s33 offen sc1 lds
    s_add_u32 m0, s77, 141312
    s_add_u32 s33, s76, 185344
    buffer_load_dwordx4 v13, s[80:83], s33 offen sc1 lds
    s_add_u32 m0, s77, 142336
    s_add_u32 s33, s76, 186368
    buffer_load_dwordx4 v13, s[80:83], s33 offen sc1 lds
    s_add_u32 m0, s77, 143360
    s_add_u32 s33, s76, 187392
    s_mov_b32 exec_hi, 0xffff
    buffer_load_dwordx4 v13, s[80:83], s33 offen sc1 lds
    s_mov_b64 exec, -1
    s_waitcnt vmcnt(16)
    s_barrier
    s_add_u32 m0, s77, 0
    s_add_u32 s33, s76, 199680
    buffer_load_dwordx4 v13, s[80:83], s33 offen sc1 lds
    s_add_u32 m0, s77, 1024
    s_add_u32 s33, s76, 200704
    buffer_load_dwordx4 v13, s[80:83], s33 offen sc1 lds
    s_add_u32 m0, s77, 2048
    s_add_u32 s33, s76, 201728
    buffer_load_dwordx4 v13, s[80:83], s33 offen sc1 lds
    s_add_u32 m0, s77, 3072
    s_add_u32 s33, s76, 202752
    s_mov_b32 exec_hi, 0xffff
    buffer_load_dwordx4 v13, s[80:83], s33 offen sc1 lds
    s_mov_b64 exec, -1
    s_waitcnt vmcnt(16)
    s_barrier
    s_add_u32 m0, s77, 15360
    s_add_u32 s33, s76, 215040
    buffer_load_dwordx4 v13, s[80:83], s33 offen sc1 lds
    s_add_u32 m0, s77, 16384
    s_add_u32 s33, s76, 216064
    buffer_load_dwordx4 v13, s[80:83], s33 offen sc1 lds
    s_add_u32 m0, s77, 17408
    s_add_u32 s33, s76, 217088
    buffer_load_dwordx4 v13, s[80:83], s33 offen sc1 lds
    s_add_u32 m0, s77, 18432
    s_add_u32 s33, s76, 218112
    s_mov_b32 exec_hi, 0xffff
    buffer_load_dwordx4 v13, s[80:83], s33 offen sc1 lds
    s_mov_b64 exec, -1
    s_waitcnt vmcnt(16)
    s_barrier
    s_add_u32 m0, s77, 45056
    s_add_u32 s33, s76, 230400
    buffer_load_dwordx4 v13, s[80:83], s33 offen sc1 lds
    s_add_u32 m0, s77, 46080
    s_add_u32 s33, s76, 231424
    buffer_load_dwordx4 v13, s[80:83], s33 offen sc1 lds
    s_add_u32 m0, s77, 47104
    s_add_u32 s33, s76, 232448
    buffer_load_dwordx4 v13, s[80:83], s33 offen sc1 lds
    s_add_u32 m0, s77, 48128
    s_add_u32 s33, s76, 233472
    s_mov_b32 exec_hi, 0xffff
    buffer_load_dwordx4 v13, s[80:83], s33 offen sc1 lds
    s_mov_b64 exec, -1
    s_waitcnt vmcnt(16)
    s_barrier
    s_add_u32 m0, s77, 60416
    s_add_u32 s33, s76, 245760
    buffer_load_dwordx4 v13, s[80:83], s33 offen sc1 lds
    s_add_u32 m0, s77, 61440
    s_add_u32 s33, s76, 246784
    buffer_load_dwordx4 v13, s[80:83], s33 offen sc1 lds
    s_add_u32 m0, s77, 62464
    s_add_u32 s33, s76, 247808
    buffer_load_dwordx4 v13, s[80:83], s33 offen sc1 lds
    s_add_u32 m0, s77, 63488
    s_add_u32 s33, s76, 248832
    s_mov_b32 exec_hi, 0xffff
    buffer_load_dwordx4 v13, s[80:83], s33 offen sc1 lds
    s_mov_b64 exec, -1
    s_waitcnt vmcnt(16)
    s_barrier
    s_add_u32 m0, s77, 75776
    s_add_u32 s33, s76, 261120
    buffer_load_dwordx4 v13, s[80:83], s33 offen sc1 lds
    s_add_u32 m0, s77, 76800
    s_add_u32 s33, s76, 262144
    buffer_load_dwordx4 v13, s[80:83], s33 offen sc1 lds
    s_add_u32 m0, s77, 77824
    s_add_u32 s33, s76, 263168
    buffer_load_dwordx4 v13, s[80:83], s33 offen sc1 lds
    s_add_u32 m0, s77, 78848
    s_add_u32 s33, s76, 264192
    s_mov_b32 exec_hi, 0xffff
    buffer_load_dwordx4 v13, s[80:83], s33 offen sc1 lds
    s_mov_b64 exec, -1
    s_waitcnt vmcnt(16)
    s_barrier
    s_waitcnt vmcnt(12)
    s_barrier
    s_waitcnt vmcnt(8)
    s_barrier
    s_waitcnt vmcnt(4)
    s_barrier
    s_waitcnt vmcnt(0)
    s_barrier
    s_branch sequential_preLN__sliding_block__geglu_ffn__prompt_kernel_p5_join64
    s_nop 0
sequential_preLN__sliding_block__geglu_ffn__prompt_kernel_p5_r63:
    s_cmp_lg_u32 s3, 11
    s_cbranch_scc1 sequential_preLN__sliding_block__geglu_ffn__prompt_kernel_nopoll65
    s_lshl_b32 s37, s25, 12
    s_add_u32 s37, s37, 131072
    s_mov_b32 s30, 0x7ffffff
    s_mov_b32 s31, 0
    s_mov_b32 s32, 0x40000
    v_lshlrev_b32 v8, 7, v1
    s_mov_b64 exec, s[30:31]
    s_nop 3
sequential_preLN__sliding_block__geglu_ffn__prompt_kernel_poll66:
    buffer_load_dword v4, v8, s[92:95], s37 offen sc1
    s_waitcnt vmcnt(0)
    v_xor_b32 v4, s24, v4
    v_cmp_ne_u32 vcc, 0, v4
    s_nop 0
    s_and_b64 s[28:29], vcc, s[30:31]
    s_cbranch_scc0 sequential_preLN__sliding_block__geglu_ffn__prompt_kernel_pdone67
    s_sub_u32 s32, s32, 1
    s_cbranch_scc1 sequential_preLN__sliding_block__geglu_ffn__prompt_kernel_pdone67
    s_sleep 1
    s_branch sequential_preLN__sliding_block__geglu_ffn__prompt_kernel_poll66
    s_nop 0
sequential_preLN__sliding_block__geglu_ffn__prompt_kernel_pdone67:
    s_mov_b64 exec, -1
    s_nop 0
sequential_preLN__sliding_block__geglu_ffn__prompt_kernel_nopoll65:
    s_barrier
    s_lshl_b32 s33, s2, 4
    s_add_u32 s33, s33, s3
    s_cmp_lg_u32 s33, 11
    s_cbranch_scc1 sequential_preLN__sliding_block__geglu_ffn__prompt_kernel_noclr68
    s_mov_b32 s44, s20
    s_and_b32 s45, s21, 0xffff
    s_mov_b32 s46, 0x100
    s_mov_b32 s47, 0x20000
    v_mov_b32 v5, 0
    s_mov_b64 exec, 1
    buffer_store_dword v5, v5, s[44:47], 0 offen sc1
    s_mov_b64 exec, -1
    s_nop 1
sequential_preLN__sliding_block__geglu_ffn__prompt_kernel_noclr68:
    s_barrier
    s_barrier
    s_barrier
    s_barrier
    s_barrier
    s_barrier
    s_barrier
    s_barrier
    s_barrier
    s_barrier
    s_barrier
    s_barrier
    s_barrier
    s_barrier
    s_mov_b64 exec, -1
    s_nop 0
sequential_preLN__sliding_block__geglu_ffn__prompt_kernel_p5_join64:
sequential_preLN__sliding_block__geglu_ffn__prompt_kernel_end:
    s_endpgm

.section .rodata,"a"
.p2align 6
.amdhsa_kernel sequential_preLN__sliding_block__geglu_ffn__prompt_kernel
  .amdhsa_next_free_vgpr 167
  .amdhsa_next_free_sgpr 98
  .amdhsa_accum_offset 168
  .amdhsa_group_segment_fixed_size 0
  .amdhsa_kernarg_size 80
  .amdhsa_user_sgpr_count 2
  .amdhsa_user_sgpr_kernarg_segment_ptr 1
  .amdhsa_system_sgpr_workgroup_id_x 1
.end_amdhsa_kernel
```
